```python
import torch

def _softmax(x, axis=-1):
    return torch.softmax(x, dim=axis)
def _gelu(x):
    return torch.nn.functional.gelu(x, approximate="tanh")
def _silu(x):
    return torch.nn.functional.silu(x)
def _sigmoid(x):
    return torch.sigmoid(x)
def _layernorm(x, axis=-1, eps=1e-5):
    m = x.mean(dim=axis, keepdim=True)
    v = x.var(dim=axis, keepdim=True, unbiased=False)
    return (x - m) / torch.sqrt(v + eps)
def _scatter_add(tgt, idx, src, axis=0):
    return tgt.clone().index_add_(axis, idx, src)
def _segment_sum(src, seg, n):
    out = torch.zeros((n,) + src.shape[1:], dtype=src.dtype)
    return out.index_add_(0, seg, src)
def _pad(x, pw):
    flat = tuple(v for pair in reversed(pw) for v in pair)
    return torch.nn.functional.pad(x, flat)

kernel_name = 'sequential_preLN__mha_block__swiglu_ffn__prompt'

def setup_inputs():

    _w = (lambda a: (lambda t: t.to(torch.bfloat16) if t.is_floating_point() else t)(torch.as_tensor(a)))
    def _A_setup():
        B, S, D, H = 1, 2048, 640, 32
        return {
            "x": _w((lambda *s: torch.randn(*s, dtype=torch.bfloat16) * 0.05)(B, S, D)),
            "wqkv": _w((lambda *s: torch.randn(*s, dtype=torch.bfloat16) * 0.05)(D, 3 * D)),
            "wo": _w((lambda *s: torch.randn(*s, dtype=torch.bfloat16) * 0.05)(D, D)),
        }
    _A_in = _A_setup()

    def _B_setup():
        B, S, D, F = 1, 2048, 640, 1728
        return {
            "x": _w((lambda *s: torch.randn(*s, dtype=torch.bfloat16) * 0.05)(B, S, D)),
            "w_gate": _w((lambda *s: torch.randn(*s, dtype=torch.bfloat16) * 0.05)(D, F)),
            "w_up": _w((lambda *s: torch.randn(*s, dtype=torch.bfloat16) * 0.05)(D, F)),
            "w_down": _w((lambda *s: torch.randn(*s, dtype=torch.bfloat16) * 0.05)(F, D)),
        }
    _B_in = _B_setup()

    return {
        "A_x": _A_in["x"],
        "A_wqkv": _A_in["wqkv"],
        "A_wo": _A_in["wo"],
        "B_x": _B_in["x"],
        "B_w_gate": _B_in["w_gate"],
        "B_w_up": _B_in["w_up"],
        "B_w_down": _B_in["w_down"],
    }

def reference(A_x, A_wqkv, A_wo, B_x, B_w_gate, B_w_up, B_w_down):
    def _A_ref(x, wqkv, wo):
        B, S, D = x.shape
        H = 32
        Dh = D // H
        qkv = (lambda x, *d: x.permute(*d))((x @ wqkv).reshape(B, S, 3, H, Dh), 2, 0, 3, 1, 4)
        q, k, v = qkv[0], qkv[1], qkv[2]
        scores = torch.einsum("bhqd,bhkd->bhqk", q, k) * (Dh ** -0.5)
        p = _softmax(scores, axis=-1)
        o = torch.einsum("bhqk,bhkd->bhqd", p, v)
        return (lambda x, *d: x.permute(*d))(o, 0, 2, 1, 3).reshape(B, S, D) @ wo

    def _B_ref(x, w_gate, w_up, w_down):
        g = _silu(x @ w_gate)
        u = x @ w_up
        return (g * u) @ w_down

    x = A_x
    h = x + _A_ref(_layernorm(x, axis=-1), A_wqkv, A_wo)
    h2 = h + _B_ref(_layernorm(h, axis=-1), B_w_gate, B_w_up, B_w_down)
    return h2
```

```asm
; @launch kernel=qkv_kernel grid=(256,1,1) block=(384,1,1) lds=140288
; @launch kernel=attn_kernel grid=(256,1,1) block=(640,1,1) lds=157696
; @launch kernel=oproj_kernel grid=(256,1,1) block=(384,1,1) lds=145408
; @launch kernel=gateup_kernel grid=(256,1,1) block=(384,1,1) lds=146432
; @launch kernel=down_kernel grid=(256,1,1) block=(384,1,1) lds=145408
.amdgcn_target "amdgcn-amd-amdhsa--gfx950"
.text
.globl qkv_kernel
.p2align 8
.type qkv_kernel,@function
qkv_kernel:
  s_and_b32 s20, s2, 7
  s_lshr_b32 s21, s2, 3
  s_and_b32 s16, s20, 1
  s_lshl_b32 s16, s16, 3
  s_lshr_b32 s17, s21, 2
  s_add_u32 s16, s16, s17
  s_cmp_ge_u32 s2, 256
  s_cbranch_scc1 L_qkv_end
  s_load_dwordx2 s[4:5], s[0:1], 0
  s_load_dwordx2 s[8:9], s[0:1], 8
  s_load_dwordx2 s[12:13], s[0:1], 72
  v_lshrrev_b32 v1, 6, v0
  v_and_b32 v2, 63, v0
  s_lshr_b32 s17, s20, 1
  v_readfirstlane_b32 s3, v1
  s_lshl_b32 s17, s17, 2
  s_and_b32 s22, s21, 3
  s_add_u32 s17, s17, s22
  v_lshlrev_b32 v3, 4, v2
  v_and_b32 v4, 15, v2
  v_lshrrev_b32 v5, 4, v2
  s_mov_b32 s6, 2621440
  s_mov_b32 s7, 0x00020000
  s_mov_b32 s10, 2457600
  s_mov_b32 s11, 0x00020000
  s_mov_b32 s14, 32751616
  s_mov_b32 s15, 0x00020000
  s_cmp_ge_u32 s16, 15
  s_cbranch_scc1 L_qkv_end
  s_cmp_eq_u32 s3, 4
  s_cbranch_scc0 L_qkv_loadX_else
  v_lshrrev_b32 v6, 3, v2
  v_and_b32 v7, 7, v2
  v_xor_b32 v7, v7, v6
  s_lshl_b32 s21, s17, 7
  v_add_u32 v6, s21, v6
  v_mul_u32_u24 v6, 1280, v6
  v_lshl_add_u32 v8, v7, 4, v6
  s_waitcnt lgkmcnt(0)
  s_and_b32 s5, s5, 0xffff
  s_mov_b32 m0, 0
  s_mov_b32 s26, 0
  buffer_load_dwordx4 v8, s[4:7], s26 offen lds
  s_mov_b32 m0, 1024
  s_mov_b32 s26, 10240
  buffer_load_dwordx4 v8, s[4:7], s26 offen lds
  s_mov_b32 m0, 2048
  s_mov_b32 s26, 20480
  buffer_load_dwordx4 v8, s[4:7], s26 offen lds
  s_mov_b32 m0, 3072
  s_mov_b32 s26, 30720
  buffer_load_dwordx4 v8, s[4:7], s26 offen lds
  s_mov_b32 m0, 4096
  s_mov_b32 s26, 40960
  buffer_load_dwordx4 v8, s[4:7], s26 offen lds
  s_mov_b32 m0, 5120
  s_mov_b32 s26, 51200
  buffer_load_dwordx4 v8, s[4:7], s26 offen lds
  s_mov_b32 m0, 6144
  s_mov_b32 s26, 61440
  buffer_load_dwordx4 v8, s[4:7], s26 offen lds
  s_mov_b32 m0, 7168
  s_mov_b32 s26, 71680
  buffer_load_dwordx4 v8, s[4:7], s26 offen lds
  s_mov_b32 m0, 8192
  s_mov_b32 s26, 81920
  buffer_load_dwordx4 v8, s[4:7], s26 offen lds
  s_mov_b32 m0, 9216
  s_mov_b32 s26, 92160
  buffer_load_dwordx4 v8, s[4:7], s26 offen lds
  s_mov_b32 m0, 10240
  s_mov_b32 s26, 102400
  buffer_load_dwordx4 v8, s[4:7], s26 offen lds
  s_mov_b32 m0, 11264
  s_mov_b32 s26, 112640
  buffer_load_dwordx4 v8, s[4:7], s26 offen lds
  s_mov_b32 m0, 12288
  s_mov_b32 s26, 122880
  buffer_load_dwordx4 v8, s[4:7], s26 offen lds
  s_mov_b32 m0, 13312
  s_mov_b32 s26, 133120
  buffer_load_dwordx4 v8, s[4:7], s26 offen lds
  s_mov_b32 m0, 14336
  s_mov_b32 s26, 143360
  buffer_load_dwordx4 v8, s[4:7], s26 offen lds
  s_mov_b32 m0, 15360
  s_mov_b32 s26, 153600
  buffer_load_dwordx4 v8, s[4:7], s26 offen lds
  s_mov_b32 m0, 32768
  s_mov_b32 s26, 128
  buffer_load_dwordx4 v8, s[4:7], s26 offen lds
  s_mov_b32 m0, 33792
  s_mov_b32 s26, 10368
  buffer_load_dwordx4 v8, s[4:7], s26 offen lds
  s_mov_b32 m0, 34816
  s_mov_b32 s26, 20608
  buffer_load_dwordx4 v8, s[4:7], s26 offen lds
  s_mov_b32 m0, 35840
  s_mov_b32 s26, 30848
  buffer_load_dwordx4 v8, s[4:7], s26 offen lds
  s_mov_b32 m0, 36864
  s_mov_b32 s26, 41088
  buffer_load_dwordx4 v8, s[4:7], s26 offen lds
  s_mov_b32 m0, 37888
  s_mov_b32 s26, 51328
  buffer_load_dwordx4 v8, s[4:7], s26 offen lds
  s_mov_b32 m0, 38912
  s_mov_b32 s26, 61568
  buffer_load_dwordx4 v8, s[4:7], s26 offen lds
  s_mov_b32 m0, 39936
  s_mov_b32 s26, 71808
  buffer_load_dwordx4 v8, s[4:7], s26 offen lds
  s_mov_b32 m0, 40960
  s_mov_b32 s26, 82048
  buffer_load_dwordx4 v8, s[4:7], s26 offen lds
  s_mov_b32 m0, 41984
  s_mov_b32 s26, 92288
  buffer_load_dwordx4 v8, s[4:7], s26 offen lds
  s_mov_b32 m0, 43008
  s_mov_b32 s26, 102528
  buffer_load_dwordx4 v8, s[4:7], s26 offen lds
  s_mov_b32 m0, 44032
  s_mov_b32 s26, 112768
  buffer_load_dwordx4 v8, s[4:7], s26 offen lds
  s_mov_b32 m0, 45056
  s_mov_b32 s26, 123008
  buffer_load_dwordx4 v8, s[4:7], s26 offen lds
  s_mov_b32 m0, 46080
  s_mov_b32 s26, 133248
  buffer_load_dwordx4 v8, s[4:7], s26 offen lds
  s_mov_b32 m0, 47104
  s_mov_b32 s26, 143488
  buffer_load_dwordx4 v8, s[4:7], s26 offen lds
  s_mov_b32 m0, 48128
  s_mov_b32 s26, 153728
  buffer_load_dwordx4 v8, s[4:7], s26 offen lds
  s_waitcnt vmcnt(16)
  s_barrier
  s_mov_b32 m0, 65536
  s_mov_b32 s26, 256
  buffer_load_dwordx4 v8, s[4:7], s26 offen lds
  s_mov_b32 m0, 66560
  s_mov_b32 s26, 10496
  buffer_load_dwordx4 v8, s[4:7], s26 offen lds
  s_mov_b32 m0, 67584
  s_mov_b32 s26, 20736
  buffer_load_dwordx4 v8, s[4:7], s26 offen lds
  s_mov_b32 m0, 68608
  s_mov_b32 s26, 30976
  buffer_load_dwordx4 v8, s[4:7], s26 offen lds
  s_mov_b32 m0, 69632
  s_mov_b32 s26, 41216
  buffer_load_dwordx4 v8, s[4:7], s26 offen lds
  s_mov_b32 m0, 70656
  s_mov_b32 s26, 51456
  buffer_load_dwordx4 v8, s[4:7], s26 offen lds
  s_mov_b32 m0, 71680
  s_mov_b32 s26, 61696
  buffer_load_dwordx4 v8, s[4:7], s26 offen lds
  s_mov_b32 m0, 72704
  s_mov_b32 s26, 71936
  buffer_load_dwordx4 v8, s[4:7], s26 offen lds
  s_mov_b32 m0, 73728
  s_mov_b32 s26, 82176
  buffer_load_dwordx4 v8, s[4:7], s26 offen lds
  s_mov_b32 m0, 74752
  s_mov_b32 s26, 92416
  buffer_load_dwordx4 v8, s[4:7], s26 offen lds
  s_mov_b32 m0, 75776
  s_mov_b32 s26, 102656
  buffer_load_dwordx4 v8, s[4:7], s26 offen lds
  s_mov_b32 m0, 76800
  s_mov_b32 s26, 112896
  buffer_load_dwordx4 v8, s[4:7], s26 offen lds
  s_mov_b32 m0, 77824
  s_mov_b32 s26, 123136
  buffer_load_dwordx4 v8, s[4:7], s26 offen lds
  s_mov_b32 m0, 78848
  s_mov_b32 s26, 133376
  buffer_load_dwordx4 v8, s[4:7], s26 offen lds
  s_mov_b32 m0, 79872
  s_mov_b32 s26, 143616
  buffer_load_dwordx4 v8, s[4:7], s26 offen lds
  s_mov_b32 m0, 80896
  s_mov_b32 s26, 153856
  buffer_load_dwordx4 v8, s[4:7], s26 offen lds
  s_mov_b32 m0, 98304
  s_mov_b32 s26, 384
  buffer_load_dwordx4 v8, s[4:7], s26 offen lds
  s_mov_b32 m0, 99328
  s_mov_b32 s26, 10624
  buffer_load_dwordx4 v8, s[4:7], s26 offen lds
  s_mov_b32 m0, 100352
  s_mov_b32 s26, 20864
  buffer_load_dwordx4 v8, s[4:7], s26 offen lds
  s_mov_b32 m0, 101376
  s_mov_b32 s26, 31104
  buffer_load_dwordx4 v8, s[4:7], s26 offen lds
  s_mov_b32 m0, 102400
  s_mov_b32 s26, 41344
  buffer_load_dwordx4 v8, s[4:7], s26 offen lds
  s_mov_b32 m0, 103424
  s_mov_b32 s26, 51584
  buffer_load_dwordx4 v8, s[4:7], s26 offen lds
  s_mov_b32 m0, 104448
  s_mov_b32 s26, 61824
  buffer_load_dwordx4 v8, s[4:7], s26 offen lds
  s_mov_b32 m0, 105472
  s_mov_b32 s26, 72064
  buffer_load_dwordx4 v8, s[4:7], s26 offen lds
  s_mov_b32 m0, 106496
  s_mov_b32 s26, 82304
  buffer_load_dwordx4 v8, s[4:7], s26 offen lds
  s_mov_b32 m0, 107520
  s_mov_b32 s26, 92544
  buffer_load_dwordx4 v8, s[4:7], s26 offen lds
  s_mov_b32 m0, 108544
  s_mov_b32 s26, 102784
  buffer_load_dwordx4 v8, s[4:7], s26 offen lds
  s_mov_b32 m0, 109568
  s_mov_b32 s26, 113024
  buffer_load_dwordx4 v8, s[4:7], s26 offen lds
  s_mov_b32 m0, 110592
  s_mov_b32 s26, 123264
  buffer_load_dwordx4 v8, s[4:7], s26 offen lds
  s_mov_b32 m0, 111616
  s_mov_b32 s26, 133504
  buffer_load_dwordx4 v8, s[4:7], s26 offen lds
  s_mov_b32 m0, 112640
  s_mov_b32 s26, 143744
  buffer_load_dwordx4 v8, s[4:7], s26 offen lds
  s_mov_b32 m0, 113664
  s_mov_b32 s26, 153984
  buffer_load_dwordx4 v8, s[4:7], s26 offen lds
  s_waitcnt vmcnt(32)
  s_barrier
  s_mov_b32 m0, 0
  s_mov_b32 s26, 512
  buffer_load_dwordx4 v8, s[4:7], s26 offen lds
  s_mov_b32 m0, 1024
  s_mov_b32 s26, 10752
  buffer_load_dwordx4 v8, s[4:7], s26 offen lds
  s_mov_b32 m0, 2048
  s_mov_b32 s26, 20992
  buffer_load_dwordx4 v8, s[4:7], s26 offen lds
  s_mov_b32 m0, 3072
  s_mov_b32 s26, 31232
  buffer_load_dwordx4 v8, s[4:7], s26 offen lds
  s_mov_b32 m0, 4096
  s_mov_b32 s26, 41472
  buffer_load_dwordx4 v8, s[4:7], s26 offen lds
  s_mov_b32 m0, 5120
  s_mov_b32 s26, 51712
  buffer_load_dwordx4 v8, s[4:7], s26 offen lds
  s_mov_b32 m0, 6144
  s_mov_b32 s26, 61952
  buffer_load_dwordx4 v8, s[4:7], s26 offen lds
  s_mov_b32 m0, 7168
  s_mov_b32 s26, 72192
  buffer_load_dwordx4 v8, s[4:7], s26 offen lds
  s_mov_b32 m0, 8192
  s_mov_b32 s26, 82432
  buffer_load_dwordx4 v8, s[4:7], s26 offen lds
  s_mov_b32 m0, 9216
  s_mov_b32 s26, 92672
  buffer_load_dwordx4 v8, s[4:7], s26 offen lds
  s_mov_b32 m0, 10240
  s_mov_b32 s26, 102912
  buffer_load_dwordx4 v8, s[4:7], s26 offen lds
  s_mov_b32 m0, 11264
  s_mov_b32 s26, 113152
  buffer_load_dwordx4 v8, s[4:7], s26 offen lds
  s_mov_b32 m0, 12288
  s_mov_b32 s26, 123392
  buffer_load_dwordx4 v8, s[4:7], s26 offen lds
  s_mov_b32 m0, 13312
  s_mov_b32 s26, 133632
  buffer_load_dwordx4 v8, s[4:7], s26 offen lds
  s_mov_b32 m0, 14336
  s_mov_b32 s26, 143872
  buffer_load_dwordx4 v8, s[4:7], s26 offen lds
  s_mov_b32 m0, 15360
  s_mov_b32 s26, 154112
  buffer_load_dwordx4 v8, s[4:7], s26 offen lds
  s_waitcnt vmcnt(32)
  s_barrier
  s_mov_b32 m0, 32768
  s_mov_b32 s26, 640
  buffer_load_dwordx4 v8, s[4:7], s26 offen lds
  s_mov_b32 m0, 33792
  s_mov_b32 s26, 10880
  buffer_load_dwordx4 v8, s[4:7], s26 offen lds
  s_mov_b32 m0, 34816
  s_mov_b32 s26, 21120
  buffer_load_dwordx4 v8, s[4:7], s26 offen lds
  s_mov_b32 m0, 35840
  s_mov_b32 s26, 31360
  buffer_load_dwordx4 v8, s[4:7], s26 offen lds
  s_mov_b32 m0, 36864
  s_mov_b32 s26, 41600
  buffer_load_dwordx4 v8, s[4:7], s26 offen lds
  s_mov_b32 m0, 37888
  s_mov_b32 s26, 51840
  buffer_load_dwordx4 v8, s[4:7], s26 offen lds
  s_mov_b32 m0, 38912
  s_mov_b32 s26, 62080
  buffer_load_dwordx4 v8, s[4:7], s26 offen lds
  s_mov_b32 m0, 39936
  s_mov_b32 s26, 72320
  buffer_load_dwordx4 v8, s[4:7], s26 offen lds
  s_mov_b32 m0, 40960
  s_mov_b32 s26, 82560
  buffer_load_dwordx4 v8, s[4:7], s26 offen lds
  s_mov_b32 m0, 41984
  s_mov_b32 s26, 92800
  buffer_load_dwordx4 v8, s[4:7], s26 offen lds
  s_mov_b32 m0, 43008
  s_mov_b32 s26, 103040
  buffer_load_dwordx4 v8, s[4:7], s26 offen lds
  s_mov_b32 m0, 44032
  s_mov_b32 s26, 113280
  buffer_load_dwordx4 v8, s[4:7], s26 offen lds
  s_mov_b32 m0, 45056
  s_mov_b32 s26, 123520
  buffer_load_dwordx4 v8, s[4:7], s26 offen lds
  s_mov_b32 m0, 46080
  s_mov_b32 s26, 133760
  buffer_load_dwordx4 v8, s[4:7], s26 offen lds
  s_mov_b32 m0, 47104
  s_mov_b32 s26, 144000
  buffer_load_dwordx4 v8, s[4:7], s26 offen lds
  s_mov_b32 m0, 48128
  s_mov_b32 s26, 154240
  buffer_load_dwordx4 v8, s[4:7], s26 offen lds
  s_waitcnt vmcnt(32)
  s_barrier
  s_mov_b32 m0, 65536
  s_mov_b32 s26, 768
  buffer_load_dwordx4 v8, s[4:7], s26 offen lds
  s_mov_b32 m0, 66560
  s_mov_b32 s26, 11008
  buffer_load_dwordx4 v8, s[4:7], s26 offen lds
  s_mov_b32 m0, 67584
  s_mov_b32 s26, 21248
  buffer_load_dwordx4 v8, s[4:7], s26 offen lds
  s_mov_b32 m0, 68608
  s_mov_b32 s26, 31488
  buffer_load_dwordx4 v8, s[4:7], s26 offen lds
  s_mov_b32 m0, 69632
  s_mov_b32 s26, 41728
  buffer_load_dwordx4 v8, s[4:7], s26 offen lds
  s_mov_b32 m0, 70656
  s_mov_b32 s26, 51968
  buffer_load_dwordx4 v8, s[4:7], s26 offen lds
  s_mov_b32 m0, 71680
  s_mov_b32 s26, 62208
  buffer_load_dwordx4 v8, s[4:7], s26 offen lds
  s_mov_b32 m0, 72704
  s_mov_b32 s26, 72448
  buffer_load_dwordx4 v8, s[4:7], s26 offen lds
  s_mov_b32 m0, 73728
  s_mov_b32 s26, 82688
  buffer_load_dwordx4 v8, s[4:7], s26 offen lds
  s_mov_b32 m0, 74752
  s_mov_b32 s26, 92928
  buffer_load_dwordx4 v8, s[4:7], s26 offen lds
  s_mov_b32 m0, 75776
  s_mov_b32 s26, 103168
  buffer_load_dwordx4 v8, s[4:7], s26 offen lds
  s_mov_b32 m0, 76800
  s_mov_b32 s26, 113408
  buffer_load_dwordx4 v8, s[4:7], s26 offen lds
  s_mov_b32 m0, 77824
  s_mov_b32 s26, 123648
  buffer_load_dwordx4 v8, s[4:7], s26 offen lds
  s_mov_b32 m0, 78848
  s_mov_b32 s26, 133888
  buffer_load_dwordx4 v8, s[4:7], s26 offen lds
  s_mov_b32 m0, 79872
  s_mov_b32 s26, 144128
  buffer_load_dwordx4 v8, s[4:7], s26 offen lds
  s_mov_b32 m0, 80896
  s_mov_b32 s26, 154368
  buffer_load_dwordx4 v8, s[4:7], s26 offen lds
  s_waitcnt vmcnt(32)
  s_barrier
  s_mov_b32 m0, 98304
  s_mov_b32 s26, 896
  buffer_load_dwordx4 v8, s[4:7], s26 offen lds
  s_mov_b32 m0, 99328
  s_mov_b32 s26, 11136
  buffer_load_dwordx4 v8, s[4:7], s26 offen lds
  s_mov_b32 m0, 100352
  s_mov_b32 s26, 21376
  buffer_load_dwordx4 v8, s[4:7], s26 offen lds
  s_mov_b32 m0, 101376
  s_mov_b32 s26, 31616
  buffer_load_dwordx4 v8, s[4:7], s26 offen lds
  s_mov_b32 m0, 102400
  s_mov_b32 s26, 41856
  buffer_load_dwordx4 v8, s[4:7], s26 offen lds
  s_mov_b32 m0, 103424
  s_mov_b32 s26, 52096
  buffer_load_dwordx4 v8, s[4:7], s26 offen lds
  s_mov_b32 m0, 104448
  s_mov_b32 s26, 62336
  buffer_load_dwordx4 v8, s[4:7], s26 offen lds
  s_mov_b32 m0, 105472
  s_mov_b32 s26, 72576
  buffer_load_dwordx4 v8, s[4:7], s26 offen lds
  s_mov_b32 m0, 106496
  s_mov_b32 s26, 82816
  buffer_load_dwordx4 v8, s[4:7], s26 offen lds
  s_mov_b32 m0, 107520
  s_mov_b32 s26, 93056
  buffer_load_dwordx4 v8, s[4:7], s26 offen lds
  s_mov_b32 m0, 108544
  s_mov_b32 s26, 103296
  buffer_load_dwordx4 v8, s[4:7], s26 offen lds
  s_mov_b32 m0, 109568
  s_mov_b32 s26, 113536
  buffer_load_dwordx4 v8, s[4:7], s26 offen lds
  s_mov_b32 m0, 110592
  s_mov_b32 s26, 123776
  buffer_load_dwordx4 v8, s[4:7], s26 offen lds
  s_mov_b32 m0, 111616
  s_mov_b32 s26, 134016
  buffer_load_dwordx4 v8, s[4:7], s26 offen lds
  s_mov_b32 m0, 112640
  s_mov_b32 s26, 144256
  buffer_load_dwordx4 v8, s[4:7], s26 offen lds
  s_mov_b32 m0, 113664
  s_mov_b32 s26, 154496
  buffer_load_dwordx4 v8, s[4:7], s26 offen lds
  s_waitcnt vmcnt(32)
  s_barrier
  s_mov_b32 m0, 0
  s_mov_b32 s26, 1024
  buffer_load_dwordx4 v8, s[4:7], s26 offen lds
  s_mov_b32 m0, 1024
  s_mov_b32 s26, 11264
  buffer_load_dwordx4 v8, s[4:7], s26 offen lds
  s_mov_b32 m0, 2048
  s_mov_b32 s26, 21504
  buffer_load_dwordx4 v8, s[4:7], s26 offen lds
  s_mov_b32 m0, 3072
  s_mov_b32 s26, 31744
  buffer_load_dwordx4 v8, s[4:7], s26 offen lds
  s_mov_b32 m0, 4096
  s_mov_b32 s26, 41984
  buffer_load_dwordx4 v8, s[4:7], s26 offen lds
  s_mov_b32 m0, 5120
  s_mov_b32 s26, 52224
  buffer_load_dwordx4 v8, s[4:7], s26 offen lds
  s_mov_b32 m0, 6144
  s_mov_b32 s26, 62464
  buffer_load_dwordx4 v8, s[4:7], s26 offen lds
  s_mov_b32 m0, 7168
  s_mov_b32 s26, 72704
  buffer_load_dwordx4 v8, s[4:7], s26 offen lds
  s_mov_b32 m0, 8192
  s_mov_b32 s26, 82944
  buffer_load_dwordx4 v8, s[4:7], s26 offen lds
  s_mov_b32 m0, 9216
  s_mov_b32 s26, 93184
  buffer_load_dwordx4 v8, s[4:7], s26 offen lds
  s_mov_b32 m0, 10240
  s_mov_b32 s26, 103424
  buffer_load_dwordx4 v8, s[4:7], s26 offen lds
  s_mov_b32 m0, 11264
  s_mov_b32 s26, 113664
  buffer_load_dwordx4 v8, s[4:7], s26 offen lds
  s_mov_b32 m0, 12288
  s_mov_b32 s26, 123904
  buffer_load_dwordx4 v8, s[4:7], s26 offen lds
  s_mov_b32 m0, 13312
  s_mov_b32 s26, 134144
  buffer_load_dwordx4 v8, s[4:7], s26 offen lds
  s_mov_b32 m0, 14336
  s_mov_b32 s26, 144384
  buffer_load_dwordx4 v8, s[4:7], s26 offen lds
  s_mov_b32 m0, 15360
  s_mov_b32 s26, 154624
  buffer_load_dwordx4 v8, s[4:7], s26 offen lds
  s_waitcnt vmcnt(32)
  s_barrier
  s_mov_b32 m0, 32768
  s_mov_b32 s26, 1152
  buffer_load_dwordx4 v8, s[4:7], s26 offen lds
  s_mov_b32 m0, 33792
  s_mov_b32 s26, 11392
  buffer_load_dwordx4 v8, s[4:7], s26 offen lds
  s_mov_b32 m0, 34816
  s_mov_b32 s26, 21632
  buffer_load_dwordx4 v8, s[4:7], s26 offen lds
  s_mov_b32 m0, 35840
  s_mov_b32 s26, 31872
  buffer_load_dwordx4 v8, s[4:7], s26 offen lds
  s_mov_b32 m0, 36864
  s_mov_b32 s26, 42112
  buffer_load_dwordx4 v8, s[4:7], s26 offen lds
  s_mov_b32 m0, 37888
  s_mov_b32 s26, 52352
  buffer_load_dwordx4 v8, s[4:7], s26 offen lds
  s_mov_b32 m0, 38912
  s_mov_b32 s26, 62592
  buffer_load_dwordx4 v8, s[4:7], s26 offen lds
  s_mov_b32 m0, 39936
  s_mov_b32 s26, 72832
  buffer_load_dwordx4 v8, s[4:7], s26 offen lds
  s_mov_b32 m0, 40960
  s_mov_b32 s26, 83072
  buffer_load_dwordx4 v8, s[4:7], s26 offen lds
  s_mov_b32 m0, 41984
  s_mov_b32 s26, 93312
  buffer_load_dwordx4 v8, s[4:7], s26 offen lds
  s_mov_b32 m0, 43008
  s_mov_b32 s26, 103552
  buffer_load_dwordx4 v8, s[4:7], s26 offen lds
  s_mov_b32 m0, 44032
  s_mov_b32 s26, 113792
  buffer_load_dwordx4 v8, s[4:7], s26 offen lds
  s_mov_b32 m0, 45056
  s_mov_b32 s26, 124032
  buffer_load_dwordx4 v8, s[4:7], s26 offen lds
  s_mov_b32 m0, 46080
  s_mov_b32 s26, 134272
  buffer_load_dwordx4 v8, s[4:7], s26 offen lds
  s_mov_b32 m0, 47104
  s_mov_b32 s26, 144512
  buffer_load_dwordx4 v8, s[4:7], s26 offen lds
  s_mov_b32 m0, 48128
  s_mov_b32 s26, 154752
  buffer_load_dwordx4 v8, s[4:7], s26 offen lds
  s_waitcnt vmcnt(32)
  s_barrier
  s_waitcnt vmcnt(16)
  s_barrier
  s_waitcnt vmcnt(0)
  s_barrier
  s_endpgm
L_qkv_loadX_else:
  s_cmp_eq_u32 s3, 5
  s_cbranch_scc0 L_qkv_loadW_else
  v_lshrrev_b32 v6, 4, v2
  v_and_b32 v7, 15, v2
  v_lshlrev_b32 v9, 1, v6
  v_xor_b32 v10, v7, v9
  v_xor_b32 v11, 8, v10
  v_mul_u32_u24 v6, 3840, v6
  v_lshl_add_u32 v8, v10, 4, v6
  v_lshl_add_u32 v9, v11, 4, v6
  s_lshl_b32 s24, s16, 8
  s_waitcnt lgkmcnt(0)
  s_and_b32 s9, s9, 0xffff
  s_mov_b32 m0, 16384
  s_add_u32 s26, s24, 0
  buffer_load_dwordx4 v8, s[8:11], s26 offen lds
  s_mov_b32 m0, 17408
  s_add_u32 s26, s24, 30720
  buffer_load_dwordx4 v9, s[8:11], s26 offen lds
  s_mov_b32 m0, 18432
  s_add_u32 s26, s24, 61440
  buffer_load_dwordx4 v8, s[8:11], s26 offen lds
  s_mov_b32 m0, 19456
  s_add_u32 s26, s24, 92160
  buffer_load_dwordx4 v9, s[8:11], s26 offen lds
  s_mov_b32 m0, 20480
  s_add_u32 s26, s24, 15360
  buffer_load_dwordx4 v8, s[8:11], s26 offen lds
  s_mov_b32 m0, 21504
  s_add_u32 s26, s24, 46080
  buffer_load_dwordx4 v9, s[8:11], s26 offen lds
  s_mov_b32 m0, 22528
  s_add_u32 s26, s24, 76800
  buffer_load_dwordx4 v8, s[8:11], s26 offen lds
  s_mov_b32 m0, 23552
  s_add_u32 s26, s24, 107520
  buffer_load_dwordx4 v9, s[8:11], s26 offen lds
  s_mov_b32 m0, 24576
  s_add_u32 s26, s24, 122880
  buffer_load_dwordx4 v8, s[8:11], s26 offen lds
  s_mov_b32 m0, 25600
  s_add_u32 s26, s24, 153600
  buffer_load_dwordx4 v9, s[8:11], s26 offen lds
  s_mov_b32 m0, 26624
  s_add_u32 s26, s24, 184320
  buffer_load_dwordx4 v8, s[8:11], s26 offen lds
  s_mov_b32 m0, 27648
  s_add_u32 s26, s24, 215040
  buffer_load_dwordx4 v9, s[8:11], s26 offen lds
  s_mov_b32 m0, 28672
  s_add_u32 s26, s24, 138240
  buffer_load_dwordx4 v8, s[8:11], s26 offen lds
  s_mov_b32 m0, 29696
  s_add_u32 s26, s24, 168960
  buffer_load_dwordx4 v9, s[8:11], s26 offen lds
  s_mov_b32 m0, 30720
  s_add_u32 s26, s24, 199680
  buffer_load_dwordx4 v8, s[8:11], s26 offen lds
  s_mov_b32 m0, 31744
  s_add_u32 s26, s24, 230400
  buffer_load_dwordx4 v9, s[8:11], s26 offen lds
  s_mov_b32 m0, 49152
  s_add_u32 s26, s24, 245760
  buffer_load_dwordx4 v8, s[8:11], s26 offen lds
  s_mov_b32 m0, 50176
  s_add_u32 s26, s24, 276480
  buffer_load_dwordx4 v9, s[8:11], s26 offen lds
  s_mov_b32 m0, 51200
  s_add_u32 s26, s24, 307200
  buffer_load_dwordx4 v8, s[8:11], s26 offen lds
  s_mov_b32 m0, 52224
  s_add_u32 s26, s24, 337920
  buffer_load_dwordx4 v9, s[8:11], s26 offen lds
  s_mov_b32 m0, 53248
  s_add_u32 s26, s24, 261120
  buffer_load_dwordx4 v8, s[8:11], s26 offen lds
  s_mov_b32 m0, 54272
  s_add_u32 s26, s24, 291840
  buffer_load_dwordx4 v9, s[8:11], s26 offen lds
  s_mov_b32 m0, 55296
  s_add_u32 s26, s24, 322560
  buffer_load_dwordx4 v8, s[8:11], s26 offen lds
  s_mov_b32 m0, 56320
  s_add_u32 s26, s24, 353280
  buffer_load_dwordx4 v9, s[8:11], s26 offen lds
  s_mov_b32 m0, 57344
  s_add_u32 s26, s24, 368640
  buffer_load_dwordx4 v8, s[8:11], s26 offen lds
  s_mov_b32 m0, 58368
  s_add_u32 s26, s24, 399360
  buffer_load_dwordx4 v9, s[8:11], s26 offen lds
  s_mov_b32 m0, 59392
  s_add_u32 s26, s24, 430080
  buffer_load_dwordx4 v8, s[8:11], s26 offen lds
  s_mov_b32 m0, 60416
  s_add_u32 s26, s24, 460800
  buffer_load_dwordx4 v9, s[8:11], s26 offen lds
  s_mov_b32 m0, 61440
  s_add_u32 s26, s24, 384000
  buffer_load_dwordx4 v8, s[8:11], s26 offen lds
  s_mov_b32 m0, 62464
  s_add_u32 s26, s24, 414720
  buffer_load_dwordx4 v9, s[8:11], s26 offen lds
  s_mov_b32 m0, 63488
  s_add_u32 s26, s24, 445440
  buffer_load_dwordx4 v8, s[8:11], s26 offen lds
  s_mov_b32 m0, 64512
  s_add_u32 s26, s24, 476160
  buffer_load_dwordx4 v9, s[8:11], s26 offen lds
  s_waitcnt vmcnt(16)
  s_barrier
  s_mov_b32 m0, 81920
  s_add_u32 s26, s24, 491520
  buffer_load_dwordx4 v8, s[8:11], s26 offen lds
  s_mov_b32 m0, 82944
  s_add_u32 s26, s24, 522240
  buffer_load_dwordx4 v9, s[8:11], s26 offen lds
  s_mov_b32 m0, 83968
  s_add_u32 s26, s24, 552960
  buffer_load_dwordx4 v8, s[8:11], s26 offen lds
  s_mov_b32 m0, 84992
  s_add_u32 s26, s24, 583680
  buffer_load_dwordx4 v9, s[8:11], s26 offen lds
  s_mov_b32 m0, 86016
  s_add_u32 s26, s24, 506880
  buffer_load_dwordx4 v8, s[8:11], s26 offen lds
  s_mov_b32 m0, 87040
  s_add_u32 s26, s24, 537600
  buffer_load_dwordx4 v9, s[8:11], s26 offen lds
  s_mov_b32 m0, 88064
  s_add_u32 s26, s24, 568320
  buffer_load_dwordx4 v8, s[8:11], s26 offen lds
  s_mov_b32 m0, 89088
  s_add_u32 s26, s24, 599040
  buffer_load_dwordx4 v9, s[8:11], s26 offen lds
  s_mov_b32 m0, 90112
  s_add_u32 s26, s24, 614400
  buffer_load_dwordx4 v8, s[8:11], s26 offen lds
  s_mov_b32 m0, 91136
  s_add_u32 s26, s24, 645120
  buffer_load_dwordx4 v9, s[8:11], s26 offen lds
  s_mov_b32 m0, 92160
  s_add_u32 s26, s24, 675840
  buffer_load_dwordx4 v8, s[8:11], s26 offen lds
  s_mov_b32 m0, 93184
  s_add_u32 s26, s24, 706560
  buffer_load_dwordx4 v9, s[8:11], s26 offen lds
  s_mov_b32 m0, 94208
  s_add_u32 s26, s24, 629760
  buffer_load_dwordx4 v8, s[8:11], s26 offen lds
  s_mov_b32 m0, 95232
  s_add_u32 s26, s24, 660480
  buffer_load_dwordx4 v9, s[8:11], s26 offen lds
  s_mov_b32 m0, 96256
  s_add_u32 s26, s24, 691200
  buffer_load_dwordx4 v8, s[8:11], s26 offen lds
  s_mov_b32 m0, 97280
  s_add_u32 s26, s24, 721920
  buffer_load_dwordx4 v9, s[8:11], s26 offen lds
  s_mov_b32 m0, 114688
  s_add_u32 s26, s24, 737280
  buffer_load_dwordx4 v8, s[8:11], s26 offen lds
  s_mov_b32 m0, 115712
  s_add_u32 s26, s24, 768000
  buffer_load_dwordx4 v9, s[8:11], s26 offen lds
  s_mov_b32 m0, 116736
  s_add_u32 s26, s24, 798720
  buffer_load_dwordx4 v8, s[8:11], s26 offen lds
  s_mov_b32 m0, 117760
  s_add_u32 s26, s24, 829440
  buffer_load_dwordx4 v9, s[8:11], s26 offen lds
  s_mov_b32 m0, 118784
  s_add_u32 s26, s24, 752640
  buffer_load_dwordx4 v8, s[8:11], s26 offen lds
  s_mov_b32 m0, 119808
  s_add_u32 s26, s24, 783360
  buffer_load_dwordx4 v9, s[8:11], s26 offen lds
  s_mov_b32 m0, 120832
  s_add_u32 s26, s24, 814080
  buffer_load_dwordx4 v8, s[8:11], s26 offen lds
  s_mov_b32 m0, 121856
  s_add_u32 s26, s24, 844800
  buffer_load_dwordx4 v9, s[8:11], s26 offen lds
  s_mov_b32 m0, 122880
  s_add_u32 s26, s24, 860160
  buffer_load_dwordx4 v8, s[8:11], s26 offen lds
  s_mov_b32 m0, 123904
  s_add_u32 s26, s24, 890880
  buffer_load_dwordx4 v9, s[8:11], s26 offen lds
  s_mov_b32 m0, 124928
  s_add_u32 s26, s24, 921600
  buffer_load_dwordx4 v8, s[8:11], s26 offen lds
  s_mov_b32 m0, 125952
  s_add_u32 s26, s24, 952320
  buffer_load_dwordx4 v9, s[8:11], s26 offen lds
  s_mov_b32 m0, 126976
  s_add_u32 s26, s24, 875520
  buffer_load_dwordx4 v8, s[8:11], s26 offen lds
  s_mov_b32 m0, 128000
  s_add_u32 s26, s24, 906240
  buffer_load_dwordx4 v9, s[8:11], s26 offen lds
  s_mov_b32 m0, 129024
  s_add_u32 s26, s24, 936960
  buffer_load_dwordx4 v8, s[8:11], s26 offen lds
  s_mov_b32 m0, 130048
  s_add_u32 s26, s24, 967680
  buffer_load_dwordx4 v9, s[8:11], s26 offen lds
  s_waitcnt vmcnt(32)
  s_barrier
  s_mov_b32 m0, 16384
  s_add_u32 s26, s24, 983040
  buffer_load_dwordx4 v8, s[8:11], s26 offen lds
  s_mov_b32 m0, 17408
  s_add_u32 s26, s24, 1013760
  buffer_load_dwordx4 v9, s[8:11], s26 offen lds
  s_mov_b32 m0, 18432
  s_add_u32 s26, s24, 1044480
  buffer_load_dwordx4 v8, s[8:11], s26 offen lds
  s_mov_b32 m0, 19456
  s_add_u32 s26, s24, 1075200
  buffer_load_dwordx4 v9, s[8:11], s26 offen lds
  s_mov_b32 m0, 20480
  s_add_u32 s26, s24, 998400
  buffer_load_dwordx4 v8, s[8:11], s26 offen lds
  s_mov_b32 m0, 21504
  s_add_u32 s26, s24, 1029120
  buffer_load_dwordx4 v9, s[8:11], s26 offen lds
  s_mov_b32 m0, 22528
  s_add_u32 s26, s24, 1059840
  buffer_load_dwordx4 v8, s[8:11], s26 offen lds
  s_mov_b32 m0, 23552
  s_add_u32 s26, s24, 1090560
  buffer_load_dwordx4 v9, s[8:11], s26 offen lds
  s_mov_b32 m0, 24576
  s_add_u32 s26, s24, 1105920
  buffer_load_dwordx4 v8, s[8:11], s26 offen lds
  s_mov_b32 m0, 25600
  s_add_u32 s26, s24, 1136640
  buffer_load_dwordx4 v9, s[8:11], s26 offen lds
  s_mov_b32 m0, 26624
  s_add_u32 s26, s24, 1167360
  buffer_load_dwordx4 v8, s[8:11], s26 offen lds
  s_mov_b32 m0, 27648
  s_add_u32 s26, s24, 1198080
  buffer_load_dwordx4 v9, s[8:11], s26 offen lds
  s_mov_b32 m0, 28672
  s_add_u32 s26, s24, 1121280
  buffer_load_dwordx4 v8, s[8:11], s26 offen lds
  s_mov_b32 m0, 29696
  s_add_u32 s26, s24, 1152000
  buffer_load_dwordx4 v9, s[8:11], s26 offen lds
  s_mov_b32 m0, 30720
  s_add_u32 s26, s24, 1182720
  buffer_load_dwordx4 v8, s[8:11], s26 offen lds
  s_mov_b32 m0, 31744
  s_add_u32 s26, s24, 1213440
  buffer_load_dwordx4 v9, s[8:11], s26 offen lds
  s_waitcnt vmcnt(32)
  s_barrier
  s_mov_b32 m0, 49152
  s_add_u32 s26, s24, 1228800
  buffer_load_dwordx4 v8, s[8:11], s26 offen lds
  s_mov_b32 m0, 50176
  s_add_u32 s26, s24, 1259520
  buffer_load_dwordx4 v9, s[8:11], s26 offen lds
  s_mov_b32 m0, 51200
  s_add_u32 s26, s24, 1290240
  buffer_load_dwordx4 v8, s[8:11], s26 offen lds
  s_mov_b32 m0, 52224
  s_add_u32 s26, s24, 1320960
  buffer_load_dwordx4 v9, s[8:11], s26 offen lds
  s_mov_b32 m0, 53248
  s_add_u32 s26, s24, 1244160
  buffer_load_dwordx4 v8, s[8:11], s26 offen lds
  s_mov_b32 m0, 54272
  s_add_u32 s26, s24, 1274880
  buffer_load_dwordx4 v9, s[8:11], s26 offen lds
  s_mov_b32 m0, 55296
  s_add_u32 s26, s24, 1305600
  buffer_load_dwordx4 v8, s[8:11], s26 offen lds
  s_mov_b32 m0, 56320
  s_add_u32 s26, s24, 1336320
  buffer_load_dwordx4 v9, s[8:11], s26 offen lds
  s_mov_b32 m0, 57344
  s_add_u32 s26, s24, 1351680
  buffer_load_dwordx4 v8, s[8:11], s26 offen lds
  s_mov_b32 m0, 58368
  s_add_u32 s26, s24, 1382400
  buffer_load_dwordx4 v9, s[8:11], s26 offen lds
  s_mov_b32 m0, 59392
  s_add_u32 s26, s24, 1413120
  buffer_load_dwordx4 v8, s[8:11], s26 offen lds
  s_mov_b32 m0, 60416
  s_add_u32 s26, s24, 1443840
  buffer_load_dwordx4 v9, s[8:11], s26 offen lds
  s_mov_b32 m0, 61440
  s_add_u32 s26, s24, 1367040
  buffer_load_dwordx4 v8, s[8:11], s26 offen lds
  s_mov_b32 m0, 62464
  s_add_u32 s26, s24, 1397760
  buffer_load_dwordx4 v9, s[8:11], s26 offen lds
  s_mov_b32 m0, 63488
  s_add_u32 s26, s24, 1428480
  buffer_load_dwordx4 v8, s[8:11], s26 offen lds
  s_mov_b32 m0, 64512
  s_add_u32 s26, s24, 1459200
  buffer_load_dwordx4 v9, s[8:11], s26 offen lds
  s_waitcnt vmcnt(32)
  s_barrier
  s_mov_b32 m0, 81920
  s_add_u32 s26, s24, 1474560
  buffer_load_dwordx4 v8, s[8:11], s26 offen lds
  s_mov_b32 m0, 82944
  s_add_u32 s26, s24, 1505280
  buffer_load_dwordx4 v9, s[8:11], s26 offen lds
  s_mov_b32 m0, 83968
  s_add_u32 s26, s24, 1536000
  buffer_load_dwordx4 v8, s[8:11], s26 offen lds
  s_mov_b32 m0, 84992
  s_add_u32 s26, s24, 1566720
  buffer_load_dwordx4 v9, s[8:11], s26 offen lds
  s_mov_b32 m0, 86016
  s_add_u32 s26, s24, 1489920
  buffer_load_dwordx4 v8, s[8:11], s26 offen lds
  s_mov_b32 m0, 87040
  s_add_u32 s26, s24, 1520640
  buffer_load_dwordx4 v9, s[8:11], s26 offen lds
  s_mov_b32 m0, 88064
  s_add_u32 s26, s24, 1551360
  buffer_load_dwordx4 v8, s[8:11], s26 offen lds
  s_mov_b32 m0, 89088
  s_add_u32 s26, s24, 1582080
  buffer_load_dwordx4 v9, s[8:11], s26 offen lds
  s_mov_b32 m0, 90112
  s_add_u32 s26, s24, 1597440
  buffer_load_dwordx4 v8, s[8:11], s26 offen lds
  s_mov_b32 m0, 91136
  s_add_u32 s26, s24, 1628160
  buffer_load_dwordx4 v9, s[8:11], s26 offen lds
  s_mov_b32 m0, 92160
  s_add_u32 s26, s24, 1658880
  buffer_load_dwordx4 v8, s[8:11], s26 offen lds
  s_mov_b32 m0, 93184
  s_add_u32 s26, s24, 1689600
  buffer_load_dwordx4 v9, s[8:11], s26 offen lds
  s_mov_b32 m0, 94208
  s_add_u32 s26, s24, 1612800
  buffer_load_dwordx4 v8, s[8:11], s26 offen lds
  s_mov_b32 m0, 95232
  s_add_u32 s26, s24, 1643520
  buffer_load_dwordx4 v9, s[8:11], s26 offen lds
  s_mov_b32 m0, 96256
  s_add_u32 s26, s24, 1674240
  buffer_load_dwordx4 v8, s[8:11], s26 offen lds
  s_mov_b32 m0, 97280
  s_add_u32 s26, s24, 1704960
  buffer_load_dwordx4 v9, s[8:11], s26 offen lds
  s_waitcnt vmcnt(32)
  s_barrier
  s_mov_b32 m0, 114688
  s_add_u32 s26, s24, 1720320
  buffer_load_dwordx4 v8, s[8:11], s26 offen lds
  s_mov_b32 m0, 115712
  s_add_u32 s26, s24, 1751040
  buffer_load_dwordx4 v9, s[8:11], s26 offen lds
  s_mov_b32 m0, 116736
  s_add_u32 s26, s24, 1781760
  buffer_load_dwordx4 v8, s[8:11], s26 offen lds
  s_mov_b32 m0, 117760
  s_add_u32 s26, s24, 1812480
  buffer_load_dwordx4 v9, s[8:11], s26 offen lds
  s_mov_b32 m0, 118784
  s_add_u32 s26, s24, 1735680
  buffer_load_dwordx4 v8, s[8:11], s26 offen lds
  s_mov_b32 m0, 119808
  s_add_u32 s26, s24, 1766400
  buffer_load_dwordx4 v9, s[8:11], s26 offen lds
  s_mov_b32 m0, 120832
  s_add_u32 s26, s24, 1797120
  buffer_load_dwordx4 v8, s[8:11], s26 offen lds
  s_mov_b32 m0, 121856
  s_add_u32 s26, s24, 1827840
  buffer_load_dwordx4 v9, s[8:11], s26 offen lds
  s_mov_b32 m0, 122880
  s_add_u32 s26, s24, 1843200
  buffer_load_dwordx4 v8, s[8:11], s26 offen lds
  s_mov_b32 m0, 123904
  s_add_u32 s26, s24, 1873920
  buffer_load_dwordx4 v9, s[8:11], s26 offen lds
  s_mov_b32 m0, 124928
  s_add_u32 s26, s24, 1904640
  buffer_load_dwordx4 v8, s[8:11], s26 offen lds
  s_mov_b32 m0, 125952
  s_add_u32 s26, s24, 1935360
  buffer_load_dwordx4 v9, s[8:11], s26 offen lds
  s_mov_b32 m0, 126976
  s_add_u32 s26, s24, 1858560
  buffer_load_dwordx4 v8, s[8:11], s26 offen lds
  s_mov_b32 m0, 128000
  s_add_u32 s26, s24, 1889280
  buffer_load_dwordx4 v9, s[8:11], s26 offen lds
  s_mov_b32 m0, 129024
  s_add_u32 s26, s24, 1920000
  buffer_load_dwordx4 v8, s[8:11], s26 offen lds
  s_mov_b32 m0, 130048
  s_add_u32 s26, s24, 1950720
  buffer_load_dwordx4 v9, s[8:11], s26 offen lds
  s_waitcnt vmcnt(32)
  s_barrier
  s_mov_b32 m0, 16384
  s_add_u32 s26, s24, 1966080
  buffer_load_dwordx4 v8, s[8:11], s26 offen lds
  s_mov_b32 m0, 17408
  s_add_u32 s26, s24, 1996800
  buffer_load_dwordx4 v9, s[8:11], s26 offen lds
  s_mov_b32 m0, 18432
  s_add_u32 s26, s24, 2027520
  buffer_load_dwordx4 v8, s[8:11], s26 offen lds
  s_mov_b32 m0, 19456
  s_add_u32 s26, s24, 2058240
  buffer_load_dwordx4 v9, s[8:11], s26 offen lds
  s_mov_b32 m0, 20480
  s_add_u32 s26, s24, 1981440
  buffer_load_dwordx4 v8, s[8:11], s26 offen lds
  s_mov_b32 m0, 21504
  s_add_u32 s26, s24, 2012160
  buffer_load_dwordx4 v9, s[8:11], s26 offen lds
  s_mov_b32 m0, 22528
  s_add_u32 s26, s24, 2042880
  buffer_load_dwordx4 v8, s[8:11], s26 offen lds
  s_mov_b32 m0, 23552
  s_add_u32 s26, s24, 2073600
  buffer_load_dwordx4 v9, s[8:11], s26 offen lds
  s_mov_b32 m0, 24576
  s_add_u32 s26, s24, 2088960
  buffer_load_dwordx4 v8, s[8:11], s26 offen lds
  s_mov_b32 m0, 25600
  s_add_u32 s26, s24, 2119680
  buffer_load_dwordx4 v9, s[8:11], s26 offen lds
  s_mov_b32 m0, 26624
  s_add_u32 s26, s24, 2150400
  buffer_load_dwordx4 v8, s[8:11], s26 offen lds
  s_mov_b32 m0, 27648
  s_add_u32 s26, s24, 2181120
  buffer_load_dwordx4 v9, s[8:11], s26 offen lds
  s_mov_b32 m0, 28672
  s_add_u32 s26, s24, 2104320
  buffer_load_dwordx4 v8, s[8:11], s26 offen lds
  s_mov_b32 m0, 29696
  s_add_u32 s26, s24, 2135040
  buffer_load_dwordx4 v9, s[8:11], s26 offen lds
  s_mov_b32 m0, 30720
  s_add_u32 s26, s24, 2165760
  buffer_load_dwordx4 v8, s[8:11], s26 offen lds
  s_mov_b32 m0, 31744
  s_add_u32 s26, s24, 2196480
  buffer_load_dwordx4 v9, s[8:11], s26 offen lds
  s_waitcnt vmcnt(32)
  s_barrier
  s_mov_b32 m0, 49152
  s_add_u32 s26, s24, 2211840
  buffer_load_dwordx4 v8, s[8:11], s26 offen lds
  s_mov_b32 m0, 50176
  s_add_u32 s26, s24, 2242560
  buffer_load_dwordx4 v9, s[8:11], s26 offen lds
  s_mov_b32 m0, 51200
  s_add_u32 s26, s24, 2273280
  buffer_load_dwordx4 v8, s[8:11], s26 offen lds
  s_mov_b32 m0, 52224
  s_add_u32 s26, s24, 2304000
  buffer_load_dwordx4 v9, s[8:11], s26 offen lds
  s_mov_b32 m0, 53248
  s_add_u32 s26, s24, 2227200
  buffer_load_dwordx4 v8, s[8:11], s26 offen lds
  s_mov_b32 m0, 54272
  s_add_u32 s26, s24, 2257920
  buffer_load_dwordx4 v9, s[8:11], s26 offen lds
  s_mov_b32 m0, 55296
  s_add_u32 s26, s24, 2288640
  buffer_load_dwordx4 v8, s[8:11], s26 offen lds
  s_mov_b32 m0, 56320
  s_add_u32 s26, s24, 2319360
  buffer_load_dwordx4 v9, s[8:11], s26 offen lds
  s_mov_b32 m0, 57344
  s_add_u32 s26, s24, 2334720
  buffer_load_dwordx4 v8, s[8:11], s26 offen lds
  s_mov_b32 m0, 58368
  s_add_u32 s26, s24, 2365440
  buffer_load_dwordx4 v9, s[8:11], s26 offen lds
  s_mov_b32 m0, 59392
  s_add_u32 s26, s24, 2396160
  buffer_load_dwordx4 v8, s[8:11], s26 offen lds
  s_mov_b32 m0, 60416
  s_add_u32 s26, s24, 2426880
  buffer_load_dwordx4 v9, s[8:11], s26 offen lds
  s_mov_b32 m0, 61440
  s_add_u32 s26, s24, 2350080
  buffer_load_dwordx4 v8, s[8:11], s26 offen lds
  s_mov_b32 m0, 62464
  s_add_u32 s26, s24, 2380800
  buffer_load_dwordx4 v9, s[8:11], s26 offen lds
  s_mov_b32 m0, 63488
  s_add_u32 s26, s24, 2411520
  buffer_load_dwordx4 v8, s[8:11], s26 offen lds
  s_mov_b32 m0, 64512
  s_add_u32 s26, s24, 2442240
  buffer_load_dwordx4 v9, s[8:11], s26 offen lds
  s_waitcnt vmcnt(32)
  s_barrier
  s_waitcnt vmcnt(16)
  s_barrier
  s_waitcnt vmcnt(0)
  s_barrier
  s_lshr_b32 s58, s2, 3
  s_cmp_lg_u32 s58, 0
  s_cbranch_scc1 L_qkv_kernel_cpf_1
  s_getpc_b64 s[58:59]
L_qkv_kernel_pc_2:
  s_add_u32 s58, s58, attn_kernel-L_qkv_kernel_pc_2
  s_addc_u32 s59, s59, 0
  global_load_dwordx4 v[64:67], v3, s[58:59] offset:0
  global_load_dwordx4 v[68:71], v3, s[58:59] offset:1024
  global_load_dwordx4 v[72:75], v3, s[58:59] offset:2048
  global_load_dwordx4 v[76:79], v3, s[58:59] offset:3072
  s_add_u32 s58, s58, 4096
  s_addc_u32 s59, s59, 0
  global_load_dwordx4 v[80:83], v3, s[58:59] offset:0
  global_load_dwordx4 v[84:87], v3, s[58:59] offset:1024
  global_load_dwordx4 v[88:91], v3, s[58:59] offset:2048
  global_load_dwordx4 v[92:95], v3, s[58:59] offset:3072
  s_add_u32 s58, s58, 4096
  s_addc_u32 s59, s59, 0
  global_load_dwordx4 v[64:67], v3, s[58:59] offset:0
  global_load_dwordx4 v[68:71], v3, s[58:59] offset:1024
  global_load_dwordx4 v[72:75], v3, s[58:59] offset:2048
  global_load_dwordx4 v[76:79], v3, s[58:59] offset:3072
  s_add_u32 s58, s58, 4096
  s_addc_u32 s59, s59, 0
  global_load_dwordx4 v[80:83], v3, s[58:59] offset:0
  global_load_dwordx4 v[84:87], v3, s[58:59] offset:1024
L_qkv_kernel_cpf_1:
  s_endpgm
L_qkv_loadW_else:
  s_and_b32 s18, s3, 1
  s_lshr_b32 s19, s3, 1
  v_and_b32 v6, 7, v4
  v_xor_b32 v7, v5, v6
  v_xor_b32 v6, 4, v7
  v_lshlrev_b32 v7, 4, v7
  v_lshlrev_b32 v6, 4, v6
  v_lshl_add_u32 v7, v4, 7, v7
  v_lshl_add_u32 v6, v4, 7, v6
  s_lshl_b32 s24, s18, 13
  s_lshl_b32 s25, s19, 12
  s_add_u32 s26, s24, s25
  s_xor_b32 s25, s25, 4096
  s_add_u32 s27, s24, s25
  v_add_u32 v160, s26, v7
  v_add_u32 v161, s26, v6
  v_add_u32 v162, s27, v7
  v_add_u32 v163, s27, v6
  v_bfe_u32 v6, v2, 2, 2
  v_lshl_add_u32 v6, v5, 2, v6
  v_and_b32 v7, 7, v6
  v_and_b32 v176, 3, v2
  v_lshlrev_b32 v176, 3, v176
  v_lshl_add_u32 v176, v6, 8, v176
  v_add_u32 v176, 16384, v176
  s_lshl_b32 s24, s19, 2
  s_lshl_b32 s28, s18, 1
  s_add_u32 s44, s28, 0
  s_and_b32 s44, s44, 3
  s_add_u32 s25, s24, s44
  v_xor_b32 v177, s25, v7
  v_lshl_add_u32 v164, v177, 5, v176
  s_add_u32 s45, s28, 1
  s_and_b32 s45, s45, 3
  s_add_u32 s25, s24, s45
  v_xor_b32 v177, s25, v7
  v_lshl_add_u32 v165, v177, 5, v176
  s_add_u32 s46, s28, 2
  s_and_b32 s46, s46, 3
  s_add_u32 s25, s24, s46
  v_xor_b32 v177, s25, v7
  v_lshl_add_u32 v166, v177, 5, v176
  s_add_u32 s47, s28, 3
  s_and_b32 s47, s47, 3
  s_add_u32 s25, s24, s47
  v_xor_b32 v177, s25, v7
  v_lshl_add_u32 v167, v177, 5, v176
  v_mov_b32 v8, 0
  v_mov_b32 v9, 0
  v_mov_b32 v10, 0
  v_mov_b32 v11, 0
  v_mov_b32 v12, 0
  v_mov_b32 v13, 0
  v_mov_b32 v14, 0
  v_mov_b32 v15, 0
  v_mov_b32 v16, 0
  v_mov_b32 v17, 0
  v_mov_b32 v18, 0
  v_mov_b32 v19, 0
  v_mov_b32 v20, 0
  v_mov_b32 v21, 0
  v_mov_b32 v22, 0
  v_mov_b32 v23, 0
  v_mov_b32 v24, 0
  v_mov_b32 v25, 0
  v_mov_b32 v26, 0
  v_mov_b32 v27, 0
  v_mov_b32 v28, 0
  v_mov_b32 v29, 0
  v_mov_b32 v30, 0
  v_mov_b32 v31, 0
  v_mov_b32 v32, 0
  v_mov_b32 v33, 0
  v_mov_b32 v34, 0
  v_mov_b32 v35, 0
  v_mov_b32 v36, 0
  v_mov_b32 v37, 0
  v_mov_b32 v38, 0
  v_mov_b32 v39, 0
  v_mov_b32 v40, 0
  v_mov_b32 v41, 0
  v_mov_b32 v42, 0
  v_mov_b32 v43, 0
  v_mov_b32 v44, 0
  v_mov_b32 v45, 0
  v_mov_b32 v46, 0
  v_mov_b32 v47, 0
  v_mov_b32 v48, 0
  v_mov_b32 v49, 0
  v_mov_b32 v50, 0
  v_mov_b32 v51, 0
  v_mov_b32 v52, 0
  v_mov_b32 v53, 0
  v_mov_b32 v54, 0
  v_mov_b32 v55, 0
  v_mov_b32 v56, 0
  v_mov_b32 v57, 0
  v_mov_b32 v58, 0
  v_mov_b32 v59, 0
  v_mov_b32 v60, 0
  v_mov_b32 v61, 0
  v_mov_b32 v62, 0
  v_mov_b32 v63, 0
  v_mov_b32 v64, 0
  v_mov_b32 v65, 0
  v_mov_b32 v66, 0
  v_mov_b32 v67, 0
  v_mov_b32 v68, 0
  v_mov_b32 v69, 0
  v_mov_b32 v70, 0
  v_mov_b32 v71, 0
  v_mov_b32 v72, 0
  v_mov_b32 v73, 0
  v_mov_b32 v74, 0
  v_mov_b32 v75, 0
  v_mov_b32 v76, 0
  v_mov_b32 v77, 0
  v_mov_b32 v78, 0
  v_mov_b32 v79, 0
  v_mov_b32 v80, 0
  v_mov_b32 v81, 0
  v_mov_b32 v82, 0
  v_mov_b32 v83, 0
  v_mov_b32 v84, 0
  v_mov_b32 v85, 0
  v_mov_b32 v86, 0
  v_mov_b32 v87, 0
  v_mov_b32 v128, 0
  v_mov_b32 v129, 0
  v_mov_b32 v130, 0
  v_mov_b32 v131, 0
  v_mov_b32 v132, 0
  v_mov_b32 v133, 0
  v_mov_b32 v134, 0
  v_mov_b32 v135, 0
  v_mov_b32 v136, 0
  v_mov_b32 v137, 0
  v_mov_b32 v138, 0
  v_mov_b32 v139, 0
  v_mov_b32 v140, 0
  v_mov_b32 v141, 0
  v_mov_b32 v142, 0
  v_mov_b32 v143, 0
  v_mov_b32 v144, 0
  v_mov_b32 v145, 0
  v_mov_b32 v146, 0
  v_mov_b32 v147, 0
  v_mov_b32 v148, 0
  v_mov_b32 v149, 0
  v_mov_b32 v150, 0
  v_mov_b32 v151, 0
  v_mov_b32 v152, 0
  v_mov_b32 v153, 0
  v_mov_b32 v154, 0
  v_mov_b32 v155, 0
  v_mov_b32 v156, 0
  v_mov_b32 v157, 0
  v_mov_b32 v158, 0
  v_mov_b32 v159, 0
  v_mov_b32 v184, 0
  v_mov_b32 v185, 0
  v_mov_b32 v186, 0
  v_mov_b32 v187, 0
  v_mov_b32 v188, 0
  v_mov_b32 v189, 0
  v_mov_b32 v190, 0
  v_mov_b32 v191, 0
  v_mov_b32 v192, 0
  v_mov_b32 v193, 0
  v_mov_b32 v194, 0
  v_mov_b32 v195, 0
  v_mov_b32 v196, 0
  v_mov_b32 v197, 0
  v_mov_b32 v198, 0
  v_mov_b32 v199, 0
  v_mov_b32 v88, 1065369472
  v_mov_b32 v89, 1065369472
  v_mov_b32 v90, 1065369472
  v_mov_b32 v91, 1065369472
  s_lshl_b32 s35, s17, 2
  s_lshl_b32 s24, s18, 1
  s_add_u32 s35, s35, s24
  s_add_u32 s30, s35, s19
  s_xor_b32 s24, s19, 1
  s_add_u32 s31, s35, s24
  s_lshl_b32 s24, s18, 8
  s_lshl_b32 s25, s19, 7
  s_add_u32 s32, s24, s25
  s_add_u32 s32, s32, 131072
  s_xor_b32 s25, s25, 128
  s_add_u32 s33, s24, s25
  s_add_u32 s33, s33, 131072
  s_cmp_ge_u32 s16, 10
  s_cbranch_scc1 L_qkv_vA
  s_mov_b32 s36, 1.0
  s_mov_b32 s37, 2880
  s_mov_b32 s38, 13336576
  s_sub_u32 s39, s16, 5
  s_cmp_lt_u32 s16, 5
  s_cselect_b32 s36, 1051011932, s36
  s_cselect_b32 s37, 1536, s37
  s_cselect_b32 s38, 10190848, s38
  s_cselect_b32 s39, s16, s39
  s_lshl_b32 s40, s37, 6
  s_mul_i32 s41, s30, s37
  s_add_u32 s41, s41, s38
  s_mul_i32 s42, s31, s37
  s_add_u32 s42, s42, s38
  s_lshl_b32 s39, s39, 5
  s_lshl_b32 s24, s19, 4
  s_add_u32 s39, s39, s24
  s_lshl_b32 s24, s44, 2
  s_add_u32 s24, s24, s39
  v_add_u32 v176, s24, v5
  v_mul_u32_u24 v177, 205, v176
  v_lshrrev_b32 v177, 10, v177
  v_mul_u32_u24 v178, 5, v177
  v_sub_u32 v178, v176, v178
  v_lshrrev_b32 v179, 1, v178
  v_lshlrev_b32 v179, 9, v179
  v_and_b32 v180, 1, v178
  v_lshl_add_u32 v179, v180, 3, v179
  v_cmp_eq_u32 vcc, 4, v178
  v_mov_b32 v180, 4
  v_mov_b32 v181, 3
  v_cndmask_b32 v180, v180, v181, vcc
  v_mul_lo_u32 v177, v177, s40
  v_add_u32 v179, v179, v177
  v_lshlrev_b32 v181, v180, v4
  v_add_u32 v168, v181, v179
  v_lshlrev_b32 v182, v180, 16
  v_add_u32 v169, v182, v168
  s_lshl_b32 s24, s45, 2
  s_add_u32 s24, s24, s39
  v_add_u32 v176, s24, v5
  v_mul_u32_u24 v177, 205, v176
  v_lshrrev_b32 v177, 10, v177
  v_mul_u32_u24 v178, 5, v177
  v_sub_u32 v178, v176, v178
  v_lshrrev_b32 v179, 1, v178
  v_lshlrev_b32 v179, 9, v179
  v_and_b32 v180, 1, v178
  v_lshl_add_u32 v179, v180, 3, v179
  v_cmp_eq_u32 vcc, 4, v178
  v_mov_b32 v180, 4
  v_mov_b32 v181, 3
  v_cndmask_b32 v180, v180, v181, vcc
  v_mul_lo_u32 v177, v177, s40
  v_add_u32 v179, v179, v177
  v_lshlrev_b32 v181, v180, v4
  v_add_u32 v170, v181, v179
  v_lshlrev_b32 v182, v180, 16
  v_add_u32 v171, v182, v170
  s_lshl_b32 s24, s46, 2
  s_add_u32 s24, s24, s39
  v_add_u32 v176, s24, v5
  v_mul_u32_u24 v177, 205, v176
  v_lshrrev_b32 v177, 10, v177
  v_mul_u32_u24 v178, 5, v177
  v_sub_u32 v178, v176, v178
  v_lshrrev_b32 v179, 1, v178
  v_lshlrev_b32 v179, 9, v179
  v_and_b32 v180, 1, v178
  v_lshl_add_u32 v179, v180, 3, v179
  v_cmp_eq_u32 vcc, 4, v178
  v_mov_b32 v180, 4
  v_mov_b32 v181, 3
  v_cndmask_b32 v180, v180, v181, vcc
  v_mul_lo_u32 v177, v177, s40
  v_add_u32 v179, v179, v177
  v_lshlrev_b32 v181, v180, v4
  v_add_u32 v172, v181, v179
  v_lshlrev_b32 v182, v180, 16
  v_add_u32 v173, v182, v172
  s_lshl_b32 s24, s47, 2
  s_add_u32 s24, s24, s39
  v_add_u32 v176, s24, v5
  v_mul_u32_u24 v177, 205, v176
  v_lshrrev_b32 v177, 10, v177
  v_mul_u32_u24 v178, 5, v177
  v_sub_u32 v178, v176, v178
  v_lshrrev_b32 v179, 1, v178
  v_lshlrev_b32 v179, 9, v179
  v_and_b32 v180, 1, v178
  v_lshl_add_u32 v179, v180, 3, v179
  v_cmp_eq_u32 vcc, 4, v178
  v_mov_b32 v180, 4
  v_mov_b32 v181, 3
  v_cndmask_b32 v180, v180, v181, vcc
  v_mul_lo_u32 v177, v177, s40
  v_add_u32 v179, v179, v177
  v_lshlrev_b32 v181, v180, v4
  v_add_u32 v174, v181, v179
  v_lshlrev_b32 v182, v180, 16
  v_add_u32 v175, v182, v174
  s_waitcnt lgkmcnt(0)
  s_and_b32 s13, s13, 0xffff
  s_cmp_ge_u32 s16, 8
  s_cbranch_scc1 L_qkv_noconst
  s_lshl_b32 s24, s16, 2
  s_mul_i32 s24, s24, 184320
  s_lshl_b32 s25, s17, 2
  s_add_u32 s25, s25, s3
  s_mul_i32 s25, s25, 2880
  s_add_u32 s24, s24, s25
  s_add_u32 s24, s24, 13336576
  s_mov_b32 s43, 184320
  v_and_b32 v176, 31, v2
  v_lshrrev_b32 v177, 5, v2
  v_mul_lo_u32 v177, v177, s43
  v_lshl_add_u32 v177, v176, 3, v177
  v_add_u32 v177, 1280, v177
  v_add_u32 v178, 368640, v177
  v_mov_b32 v180, 1065369472
  v_mov_b32 v181, 0
  buffer_store_dwordx2 v[180:181], v177, s[12:15], s24 offen
  buffer_store_dwordx2 v[180:181], v178, s[12:15], s24 offen
  v_and_b32 v176, 3, v2
  v_bfe_u32 v177, v2, 2, 2
  v_mul_lo_u32 v177, v177, s43
  v_lshrrev_b32 v178, 1, v176
  v_mul_u32_u24 v178, 672, v178
  v_and_b32 v179, 1, v176
  v_mul_u32_u24 v179, 336, v179
  v_add3_u32 v177, v177, v178, v179
  v_add_u32 v177, 1856, v177
  buffer_store_dwordx4 v[88:91], v177, s[12:15], s24 offen
L_qkv_noconst:
  s_mov_b32 s26, 0
L_qkv_loopB:
  s_barrier
  ds_read_b128 v[96:99], v160 offset:0
  ds_read_b128 v[100:103], v160 offset:2048
  ds_read_b128 v[104:107], v162 offset:0
  ds_read_b128 v[108:111], v162 offset:2048
  v_mfma_f32_16x16x32_bf16 v[8:11], v[144:147], v[128:131], v[8:11]
  ds_read_b64_tr_b16 v[112:113], v164 offset:0
  v_mfma_f32_16x16x32_bf16 v[12:15], v[144:147], v[132:135], v[12:15]
  ds_read_b64_tr_b16 v[114:115], v164 offset:4096
  v_mfma_f32_16x16x32_bf16 v[16:19], v[144:147], v[136:139], v[16:19]
  ds_read_b64_tr_b16 v[116:117], v165 offset:0
  v_mfma_f32_16x16x32_bf16 v[20:23], v[144:147], v[140:143], v[20:23]
  ds_read_b64_tr_b16 v[118:119], v165 offset:4096
  v_mfma_f32_16x16x32_bf16 v[72:75], v[144:147], v[88:91], v[72:75]
  ds_read_b64_tr_b16 v[120:121], v166 offset:0
  v_mfma_f32_16x16x32_bf16 v[184:187], v[88:91], v[128:131], v[184:187]
  ds_read_b64_tr_b16 v[122:123], v166 offset:4096
  v_mfma_f32_16x16x32_bf16 v[192:195], v[128:131], v[128:131], v[192:195]
  ds_read_b64_tr_b16 v[124:125], v167 offset:0
  v_mfma_f32_16x16x32_bf16 v[24:27], v[148:151], v[128:131], v[24:27]
  ds_read_b64_tr_b16 v[126:127], v167 offset:4096
  v_mfma_f32_16x16x32_bf16 v[28:31], v[148:151], v[132:135], v[28:31]
  v_mfma_f32_16x16x32_bf16 v[32:35], v[148:151], v[136:139], v[32:35]
  v_mfma_f32_16x16x32_bf16 v[36:39], v[148:151], v[140:143], v[36:39]
  v_mfma_f32_16x16x32_bf16 v[76:79], v[148:151], v[88:91], v[76:79]
  v_mfma_f32_16x16x32_bf16 v[188:191], v[88:91], v[132:135], v[188:191]
  v_mfma_f32_16x16x32_bf16 v[196:199], v[132:135], v[132:135], v[196:199]
  v_mfma_f32_16x16x32_bf16 v[40:43], v[152:155], v[128:131], v[40:43]
  v_mfma_f32_16x16x32_bf16 v[44:47], v[152:155], v[132:135], v[44:47]
  v_mfma_f32_16x16x32_bf16 v[48:51], v[152:155], v[136:139], v[48:51]
  v_mfma_f32_16x16x32_bf16 v[52:55], v[152:155], v[140:143], v[52:55]
  v_mfma_f32_16x16x32_bf16 v[56:59], v[156:159], v[128:131], v[56:59]
  v_mfma_f32_16x16x32_bf16 v[60:63], v[156:159], v[132:135], v[60:63]
  v_mfma_f32_16x16x32_bf16 v[64:67], v[156:159], v[136:139], v[64:67]
  v_mfma_f32_16x16x32_bf16 v[68:71], v[156:159], v[140:143], v[68:71]
  s_waitcnt lgkmcnt(0)
  v_mfma_f32_16x16x32_bf16 v[8:11], v[112:115], v[96:99], v[8:11]
  ds_read_b128 v[128:131], v161 offset:0
  v_mfma_f32_16x16x32_bf16 v[12:15], v[112:115], v[100:103], v[12:15]
  ds_read_b128 v[132:135], v161 offset:2048
  v_mfma_f32_16x16x32_bf16 v[16:19], v[112:115], v[104:107], v[16:19]
  ds_read_b128 v[136:139], v163 offset:0
  v_mfma_f32_16x16x32_bf16 v[20:23], v[112:115], v[108:111], v[20:23]
  ds_read_b128 v[140:143], v163 offset:2048
  v_mfma_f32_16x16x32_bf16 v[72:75], v[112:115], v[88:91], v[72:75]
  ds_read_b64_tr_b16 v[144:145], v164 offset:8192
  v_mfma_f32_16x16x32_bf16 v[184:187], v[88:91], v[96:99], v[184:187]
  ds_read_b64_tr_b16 v[146:147], v164 offset:12288
  v_mfma_f32_16x16x32_bf16 v[192:195], v[96:99], v[96:99], v[192:195]
  ds_read_b64_tr_b16 v[148:149], v165 offset:8192
  v_mfma_f32_16x16x32_bf16 v[24:27], v[116:119], v[96:99], v[24:27]
  ds_read_b64_tr_b16 v[150:151], v165 offset:12288
  v_mfma_f32_16x16x32_bf16 v[28:31], v[116:119], v[100:103], v[28:31]
  ds_read_b64_tr_b16 v[152:153], v166 offset:8192
  v_mfma_f32_16x16x32_bf16 v[32:35], v[116:119], v[104:107], v[32:35]
  ds_read_b64_tr_b16 v[154:155], v166 offset:12288
  v_mfma_f32_16x16x32_bf16 v[36:39], v[116:119], v[108:111], v[36:39]
  ds_read_b64_tr_b16 v[156:157], v167 offset:8192
  v_mfma_f32_16x16x32_bf16 v[76:79], v[116:119], v[88:91], v[76:79]
  ds_read_b64_tr_b16 v[158:159], v167 offset:12288
  v_mfma_f32_16x16x32_bf16 v[188:191], v[88:91], v[100:103], v[188:191]
  v_mfma_f32_16x16x32_bf16 v[196:199], v[100:103], v[100:103], v[196:199]
  v_mfma_f32_16x16x32_bf16 v[40:43], v[120:123], v[96:99], v[40:43]
  v_mfma_f32_16x16x32_bf16 v[44:47], v[120:123], v[100:103], v[44:47]
  v_mfma_f32_16x16x32_bf16 v[48:51], v[120:123], v[104:107], v[48:51]
  v_mfma_f32_16x16x32_bf16 v[52:55], v[120:123], v[108:111], v[52:55]
  v_mfma_f32_16x16x32_bf16 v[56:59], v[124:127], v[96:99], v[56:59]
  v_mfma_f32_16x16x32_bf16 v[60:63], v[124:127], v[100:103], v[60:63]
  v_mfma_f32_16x16x32_bf16 v[64:67], v[124:127], v[104:107], v[64:67]
  v_mfma_f32_16x16x32_bf16 v[68:71], v[124:127], v[108:111], v[68:71]
  s_waitcnt lgkmcnt(0)
  s_barrier
  ds_read_b128 v[96:99], v160 offset:32768
  ds_read_b128 v[100:103], v160 offset:34816
  ds_read_b128 v[104:107], v162 offset:32768
  ds_read_b128 v[108:111], v162 offset:34816
  v_mfma_f32_16x16x32_bf16 v[8:11], v[144:147], v[128:131], v[8:11]
  ds_read_b64_tr_b16 v[112:113], v164 offset:32768
  v_mfma_f32_16x16x32_bf16 v[12:15], v[144:147], v[132:135], v[12:15]
  ds_read_b64_tr_b16 v[114:115], v164 offset:36864
  v_mfma_f32_16x16x32_bf16 v[16:19], v[144:147], v[136:139], v[16:19]
  ds_read_b64_tr_b16 v[116:117], v165 offset:32768
  v_mfma_f32_16x16x32_bf16 v[20:23], v[144:147], v[140:143], v[20:23]
  ds_read_b64_tr_b16 v[118:119], v165 offset:36864
  v_mfma_f32_16x16x32_bf16 v[72:75], v[144:147], v[88:91], v[72:75]
  ds_read_b64_tr_b16 v[120:121], v166 offset:32768
  v_mfma_f32_16x16x32_bf16 v[184:187], v[88:91], v[128:131], v[184:187]
  ds_read_b64_tr_b16 v[122:123], v166 offset:36864
  v_mfma_f32_16x16x32_bf16 v[192:195], v[128:131], v[128:131], v[192:195]
  ds_read_b64_tr_b16 v[124:125], v167 offset:32768
  v_mfma_f32_16x16x32_bf16 v[24:27], v[148:151], v[128:131], v[24:27]
  ds_read_b64_tr_b16 v[126:127], v167 offset:36864
  v_mfma_f32_16x16x32_bf16 v[28:31], v[148:151], v[132:135], v[28:31]
  v_mfma_f32_16x16x32_bf16 v[32:35], v[148:151], v[136:139], v[32:35]
  v_mfma_f32_16x16x32_bf16 v[36:39], v[148:151], v[140:143], v[36:39]
  v_mfma_f32_16x16x32_bf16 v[76:79], v[148:151], v[88:91], v[76:79]
  v_mfma_f32_16x16x32_bf16 v[188:191], v[88:91], v[132:135], v[188:191]
  v_mfma_f32_16x16x32_bf16 v[196:199], v[132:135], v[132:135], v[196:199]
  v_mfma_f32_16x16x32_bf16 v[40:43], v[152:155], v[128:131], v[40:43]
  v_mfma_f32_16x16x32_bf16 v[44:47], v[152:155], v[132:135], v[44:47]
  v_mfma_f32_16x16x32_bf16 v[48:51], v[152:155], v[136:139], v[48:51]
  v_mfma_f32_16x16x32_bf16 v[52:55], v[152:155], v[140:143], v[52:55]
  v_mfma_f32_16x16x32_bf16 v[56:59], v[156:159], v[128:131], v[56:59]
  v_mfma_f32_16x16x32_bf16 v[60:63], v[156:159], v[132:135], v[60:63]
  v_mfma_f32_16x16x32_bf16 v[64:67], v[156:159], v[136:139], v[64:67]
  v_mfma_f32_16x16x32_bf16 v[68:71], v[156:159], v[140:143], v[68:71]
  s_waitcnt lgkmcnt(0)
  v_mfma_f32_16x16x32_bf16 v[8:11], v[112:115], v[96:99], v[8:11]
  ds_read_b128 v[128:131], v161 offset:32768
  v_mfma_f32_16x16x32_bf16 v[12:15], v[112:115], v[100:103], v[12:15]
  ds_read_b128 v[132:135], v161 offset:34816
  v_mfma_f32_16x16x32_bf16 v[16:19], v[112:115], v[104:107], v[16:19]
  ds_read_b128 v[136:139], v163 offset:32768
  v_mfma_f32_16x16x32_bf16 v[20:23], v[112:115], v[108:111], v[20:23]
  ds_read_b128 v[140:143], v163 offset:34816
  v_mfma_f32_16x16x32_bf16 v[72:75], v[112:115], v[88:91], v[72:75]
  ds_read_b64_tr_b16 v[144:145], v164 offset:40960
  v_mfma_f32_16x16x32_bf16 v[184:187], v[88:91], v[96:99], v[184:187]
  ds_read_b64_tr_b16 v[146:147], v164 offset:45056
  v_mfma_f32_16x16x32_bf16 v[192:195], v[96:99], v[96:99], v[192:195]
  ds_read_b64_tr_b16 v[148:149], v165 offset:40960
  v_mfma_f32_16x16x32_bf16 v[24:27], v[116:119], v[96:99], v[24:27]
  ds_read_b64_tr_b16 v[150:151], v165 offset:45056
  v_mfma_f32_16x16x32_bf16 v[28:31], v[116:119], v[100:103], v[28:31]
  ds_read_b64_tr_b16 v[152:153], v166 offset:40960
  v_mfma_f32_16x16x32_bf16 v[32:35], v[116:119], v[104:107], v[32:35]
  ds_read_b64_tr_b16 v[154:155], v166 offset:45056
  v_mfma_f32_16x16x32_bf16 v[36:39], v[116:119], v[108:111], v[36:39]
  ds_read_b64_tr_b16 v[156:157], v167 offset:40960
  v_mfma_f32_16x16x32_bf16 v[76:79], v[116:119], v[88:91], v[76:79]
  ds_read_b64_tr_b16 v[158:159], v167 offset:45056
  v_mfma_f32_16x16x32_bf16 v[188:191], v[88:91], v[100:103], v[188:191]
  v_mfma_f32_16x16x32_bf16 v[196:199], v[100:103], v[100:103], v[196:199]
  v_mfma_f32_16x16x32_bf16 v[40:43], v[120:123], v[96:99], v[40:43]
  v_mfma_f32_16x16x32_bf16 v[44:47], v[120:123], v[100:103], v[44:47]
  v_mfma_f32_16x16x32_bf16 v[48:51], v[120:123], v[104:107], v[48:51]
  v_mfma_f32_16x16x32_bf16 v[52:55], v[120:123], v[108:111], v[52:55]
  v_mfma_f32_16x16x32_bf16 v[56:59], v[124:127], v[96:99], v[56:59]
  v_mfma_f32_16x16x32_bf16 v[60:63], v[124:127], v[100:103], v[60:63]
  v_mfma_f32_16x16x32_bf16 v[64:67], v[124:127], v[104:107], v[64:67]
  v_mfma_f32_16x16x32_bf16 v[68:71], v[124:127], v[108:111], v[68:71]
  s_waitcnt lgkmcnt(0)
  v_xor_b32 v160, 65536, v160
  v_xor_b32 v161, 65536, v161
  v_xor_b32 v162, 65536, v162
  v_xor_b32 v163, 65536, v163
  v_xor_b32 v164, 65536, v164
  v_xor_b32 v165, 65536, v165
  v_xor_b32 v166, 65536, v166
  v_xor_b32 v167, 65536, v167
  s_add_u32 s26, s26, 1
  s_cmp_lt_u32 s26, 5
  s_cbranch_scc1 L_qkv_loopB
  v_mfma_f32_16x16x32_bf16 v[8:11], v[144:147], v[128:131], v[8:11]
  v_mfma_f32_16x16x32_bf16 v[12:15], v[144:147], v[132:135], v[12:15]
  v_mfma_f32_16x16x32_bf16 v[16:19], v[144:147], v[136:139], v[16:19]
  v_mfma_f32_16x16x32_bf16 v[20:23], v[144:147], v[140:143], v[20:23]
  v_mfma_f32_16x16x32_bf16 v[72:75], v[144:147], v[88:91], v[72:75]
  v_mfma_f32_16x16x32_bf16 v[184:187], v[88:91], v[128:131], v[184:187]
  v_mfma_f32_16x16x32_bf16 v[192:195], v[128:131], v[128:131], v[192:195]
  v_mfma_f32_16x16x32_bf16 v[24:27], v[148:151], v[128:131], v[24:27]
  v_mfma_f32_16x16x32_bf16 v[28:31], v[148:151], v[132:135], v[28:31]
  v_mfma_f32_16x16x32_bf16 v[32:35], v[148:151], v[136:139], v[32:35]
  v_mfma_f32_16x16x32_bf16 v[36:39], v[148:151], v[140:143], v[36:39]
  v_mfma_f32_16x16x32_bf16 v[76:79], v[148:151], v[88:91], v[76:79]
  v_mfma_f32_16x16x32_bf16 v[188:191], v[88:91], v[132:135], v[188:191]
  v_mfma_f32_16x16x32_bf16 v[196:199], v[132:135], v[132:135], v[196:199]
  v_mfma_f32_16x16x32_bf16 v[40:43], v[152:155], v[128:131], v[40:43]
  v_mfma_f32_16x16x32_bf16 v[44:47], v[152:155], v[132:135], v[44:47]
  v_mfma_f32_16x16x32_bf16 v[48:51], v[152:155], v[136:139], v[48:51]
  v_mfma_f32_16x16x32_bf16 v[52:55], v[152:155], v[140:143], v[52:55]
  v_mfma_f32_16x16x32_bf16 v[56:59], v[156:159], v[128:131], v[56:59]
  v_mfma_f32_16x16x32_bf16 v[60:63], v[156:159], v[132:135], v[60:63]
  v_mfma_f32_16x16x32_bf16 v[64:67], v[156:159], v[136:139], v[64:67]
  v_mfma_f32_16x16x32_bf16 v[68:71], v[156:159], v[140:143], v[68:71]
  s_nop 7
  v_and_b32 v178, 3, v4
  v_lshrrev_b32 v179, 2, v4
  v_cmp_eq_u32 s[28:29], v179, v5
  v_cmp_eq_u32 vcc, 1, v178
  s_nop 1
  v_cndmask_b32 v185, v192, v193, vcc
  v_cmp_eq_u32 vcc, 2, v178
  s_nop 1
  v_cndmask_b32 v185, v185, v194, vcc
  v_cmp_eq_u32 vcc, 3, v178
  s_nop 1
  v_cndmask_b32 v185, v185, v195, vcc
  v_cndmask_b32 v185, 0, v185, s[28:29]
  v_cmp_eq_u32 vcc, 1, v178
  s_nop 1
  v_cndmask_b32 v187, v196, v197, vcc
  v_cmp_eq_u32 vcc, 2, v178
  s_nop 1
  v_cndmask_b32 v187, v187, v198, vcc
  v_cmp_eq_u32 vcc, 3, v178
  s_nop 1
  v_cndmask_b32 v187, v187, v199, vcc
  v_cndmask_b32 v187, 0, v187, s[28:29]
  ds_swizzle_b32 v176, v185 offset:0x401F
  ds_swizzle_b32 v177, v187 offset:0x401F
  s_lshl_b32 s24, s3, 11
  s_add_u32 s24, s24, 132096
  v_add_u32 v180, s24, v3
  s_xor_b32 s24, s3, 1
  s_lshl_b32 s24, s24, 11
  s_add_u32 s24, s24, 132096
  v_add_u32 v181, s24, v3
  ds_write_b128 v180, v[72:75]
  ds_write_b128 v180, v[76:79] offset:1024
  s_waitcnt lgkmcnt(2)
  v_add_f32 v185, v185, v176
  v_add_f32 v187, v187, v177
  v_mov_b32 v176, v185
  v_mov_b32 v177, v187
  s_nop 1
  v_permlane32_swap_b32 v176, v185
  v_permlane32_swap_b32 v177, v187
  s_nop 1
  v_add_f32 v185, v185, v176
  v_add_f32 v187, v187, v177
  v_mul_f32 v184, 986500301, v184
  v_mul_f32 v185, 986500301, v185
  v_fma_f32 v185, -v184, v184, v185
  v_max_f32 v185, 0, v185
  v_add_f32 v185, 925353388, v185
  v_rsq_f32 v185, v185
  s_nop 0
  v_mul_f32 v184, v184, v185
  v_mul_f32 v186, 986500301, v188
  v_mul_f32 v187, 986500301, v187
  v_fma_f32 v187, -v186, v186, v187
  v_max_f32 v187, 0, v187
  v_add_f32 v187, 925353388, v187
  v_rsq_f32 v187, v187
  s_nop 0
  v_mul_f32 v186, v186, v187
  v_lshlrev_b32 v176, 2, v4
  v_add_u32 v176, s32, v176
  ds_write_b32 v176, v185
  ds_write_b32 v176, v184 offset:512
  ds_write_b32 v176, v187 offset:64
  ds_write_b32 v176, v186 offset:576
  s_waitcnt lgkmcnt(0)
  s_barrier
  ds_read_b128 v[80:83], v181
  ds_read_b128 v[84:87], v181 offset:1024
  v_lshlrev_b32 v176, 2, v4
  v_add_u32 v177, s33, v176
  v_add_u32 v176, s32, v176
  ds_read_b32 v96, v176 offset:0
  ds_read_b32 v97, v176 offset:512
  ds_read_b32 v98, v176 offset:64
  ds_read_b32 v99, v176 offset:576
  ds_read_b32 v100, v177 offset:0
  ds_read_b32 v101, v177 offset:512
  ds_read_b32 v102, v177 offset:64
  ds_read_b32 v103, v177 offset:576
  s_waitcnt lgkmcnt(0)
  v_mul_f32 v96, s36, v96
  v_mul_f32 v97, s36, v97
  v_mul_f32 v98, s36, v98
  v_mul_f32 v99, s36, v99
  v_mul_f32 v100, s36, v100
  v_mul_f32 v101, s36, v101
  v_mul_f32 v102, s36, v102
  v_mul_f32 v103, s36, v103
  v_pk_mul_f32 v[178:179], v[72:73], v[96:97] op_sel:[0,1] op_sel_hi:[1,1]
  v_pk_fma_f32 v[8:9], v[8:9], v[96:97], v[178:179] op_sel:[0,0,0] op_sel_hi:[1,0,1] neg_lo:[0,0,1] neg_hi:[0,0,1]
  v_pk_mul_f32 v[180:181], v[74:75], v[96:97] op_sel:[0,1] op_sel_hi:[1,1]
  v_pk_fma_f32 v[10:11], v[10:11], v[96:97], v[180:181] op_sel:[0,0,0] op_sel_hi:[1,0,1] neg_lo:[0,0,1] neg_hi:[0,0,1]
  v_cvt_pk_bf16_f32 v8, v8, v9
  v_cvt_pk_bf16_f32 v9, v10, v11
  buffer_store_dwordx2 v[8:9], v168, s[12:15], s41 offen
  v_pk_mul_f32 v[178:179], v[72:73], v[98:99] op_sel:[0,1] op_sel_hi:[1,1]
  v_pk_fma_f32 v[12:13], v[12:13], v[98:99], v[178:179] op_sel:[0,0,0] op_sel_hi:[1,0,1] neg_lo:[0,0,1] neg_hi:[0,0,1]
  v_pk_mul_f32 v[180:181], v[74:75], v[98:99] op_sel:[0,1] op_sel_hi:[1,1]
  v_pk_fma_f32 v[14:15], v[14:15], v[98:99], v[180:181] op_sel:[0,0,0] op_sel_hi:[1,0,1] neg_lo:[0,0,1] neg_hi:[0,0,1]
  v_cvt_pk_bf16_f32 v12, v12, v13
  v_cvt_pk_bf16_f32 v13, v14, v15
  buffer_store_dwordx2 v[12:13], v169, s[12:15], s41 offen
  v_pk_mul_f32 v[178:179], v[72:73], v[100:101] op_sel:[0,1] op_sel_hi:[1,1]
  v_pk_fma_f32 v[16:17], v[16:17], v[100:101], v[178:179] op_sel:[0,0,0] op_sel_hi:[1,0,1] neg_lo:[0,0,1] neg_hi:[0,0,1]
  v_pk_mul_f32 v[180:181], v[74:75], v[100:101] op_sel:[0,1] op_sel_hi:[1,1]
  v_pk_fma_f32 v[18:19], v[18:19], v[100:101], v[180:181] op_sel:[0,0,0] op_sel_hi:[1,0,1] neg_lo:[0,0,1] neg_hi:[0,0,1]
  v_cvt_pk_bf16_f32 v16, v16, v17
  v_cvt_pk_bf16_f32 v17, v18, v19
  buffer_store_dwordx2 v[16:17], v168, s[12:15], s42 offen
  v_pk_mul_f32 v[178:179], v[72:73], v[102:103] op_sel:[0,1] op_sel_hi:[1,1]
  v_pk_fma_f32 v[20:21], v[20:21], v[102:103], v[178:179] op_sel:[0,0,0] op_sel_hi:[1,0,1] neg_lo:[0,0,1] neg_hi:[0,0,1]
  v_pk_mul_f32 v[180:181], v[74:75], v[102:103] op_sel:[0,1] op_sel_hi:[1,1]
  v_pk_fma_f32 v[22:23], v[22:23], v[102:103], v[180:181] op_sel:[0,0,0] op_sel_hi:[1,0,1] neg_lo:[0,0,1] neg_hi:[0,0,1]
  v_cvt_pk_bf16_f32 v20, v20, v21
  v_cvt_pk_bf16_f32 v21, v22, v23
  buffer_store_dwordx2 v[20:21], v169, s[12:15], s42 offen
  v_pk_mul_f32 v[178:179], v[76:77], v[96:97] op_sel:[0,1] op_sel_hi:[1,1]
  v_pk_fma_f32 v[24:25], v[24:25], v[96:97], v[178:179] op_sel:[0,0,0] op_sel_hi:[1,0,1] neg_lo:[0,0,1] neg_hi:[0,0,1]
  v_pk_mul_f32 v[180:181], v[78:79], v[96:97] op_sel:[0,1] op_sel_hi:[1,1]
  v_pk_fma_f32 v[26:27], v[26:27], v[96:97], v[180:181] op_sel:[0,0,0] op_sel_hi:[1,0,1] neg_lo:[0,0,1] neg_hi:[0,0,1]
  v_cvt_pk_bf16_f32 v24, v24, v25
  v_cvt_pk_bf16_f32 v25, v26, v27
  buffer_store_dwordx2 v[24:25], v170, s[12:15], s41 offen
  v_pk_mul_f32 v[178:179], v[76:77], v[98:99] op_sel:[0,1] op_sel_hi:[1,1]
  v_pk_fma_f32 v[28:29], v[28:29], v[98:99], v[178:179] op_sel:[0,0,0] op_sel_hi:[1,0,1] neg_lo:[0,0,1] neg_hi:[0,0,1]
  v_pk_mul_f32 v[180:181], v[78:79], v[98:99] op_sel:[0,1] op_sel_hi:[1,1]
  v_pk_fma_f32 v[30:31], v[30:31], v[98:99], v[180:181] op_sel:[0,0,0] op_sel_hi:[1,0,1] neg_lo:[0,0,1] neg_hi:[0,0,1]
  v_cvt_pk_bf16_f32 v28, v28, v29
  v_cvt_pk_bf16_f32 v29, v30, v31
  buffer_store_dwordx2 v[28:29], v171, s[12:15], s41 offen
  v_pk_mul_f32 v[178:179], v[76:77], v[100:101] op_sel:[0,1] op_sel_hi:[1,1]
  v_pk_fma_f32 v[32:33], v[32:33], v[100:101], v[178:179] op_sel:[0,0,0] op_sel_hi:[1,0,1] neg_lo:[0,0,1] neg_hi:[0,0,1]
  v_pk_mul_f32 v[180:181], v[78:79], v[100:101] op_sel:[0,1] op_sel_hi:[1,1]
  v_pk_fma_f32 v[34:35], v[34:35], v[100:101], v[180:181] op_sel:[0,0,0] op_sel_hi:[1,0,1] neg_lo:[0,0,1] neg_hi:[0,0,1]
  v_cvt_pk_bf16_f32 v32, v32, v33
  v_cvt_pk_bf16_f32 v33, v34, v35
  buffer_store_dwordx2 v[32:33], v170, s[12:15], s42 offen
  v_pk_mul_f32 v[178:179], v[76:77], v[102:103] op_sel:[0,1] op_sel_hi:[1,1]
  v_pk_fma_f32 v[36:37], v[36:37], v[102:103], v[178:179] op_sel:[0,0,0] op_sel_hi:[1,0,1] neg_lo:[0,0,1] neg_hi:[0,0,1]
  v_pk_mul_f32 v[180:181], v[78:79], v[102:103] op_sel:[0,1] op_sel_hi:[1,1]
  v_pk_fma_f32 v[38:39], v[38:39], v[102:103], v[180:181] op_sel:[0,0,0] op_sel_hi:[1,0,1] neg_lo:[0,0,1] neg_hi:[0,0,1]
  v_cvt_pk_bf16_f32 v36, v36, v37
  v_cvt_pk_bf16_f32 v37, v38, v39
  buffer_store_dwordx2 v[36:37], v171, s[12:15], s42 offen
  v_pk_mul_f32 v[178:179], v[80:81], v[96:97] op_sel:[0,1] op_sel_hi:[1,1]
  v_pk_fma_f32 v[40:41], v[40:41], v[96:97], v[178:179] op_sel:[0,0,0] op_sel_hi:[1,0,1] neg_lo:[0,0,1] neg_hi:[0,0,1]
  v_pk_mul_f32 v[180:181], v[82:83], v[96:97] op_sel:[0,1] op_sel_hi:[1,1]
  v_pk_fma_f32 v[42:43], v[42:43], v[96:97], v[180:181] op_sel:[0,0,0] op_sel_hi:[1,0,1] neg_lo:[0,0,1] neg_hi:[0,0,1]
  v_cvt_pk_bf16_f32 v40, v40, v41
  v_cvt_pk_bf16_f32 v41, v42, v43
  buffer_store_dwordx2 v[40:41], v172, s[12:15], s41 offen
  v_pk_mul_f32 v[178:179], v[80:81], v[98:99] op_sel:[0,1] op_sel_hi:[1,1]
  v_pk_fma_f32 v[44:45], v[44:45], v[98:99], v[178:179] op_sel:[0,0,0] op_sel_hi:[1,0,1] neg_lo:[0,0,1] neg_hi:[0,0,1]
  v_pk_mul_f32 v[180:181], v[82:83], v[98:99] op_sel:[0,1] op_sel_hi:[1,1]
  v_pk_fma_f32 v[46:47], v[46:47], v[98:99], v[180:181] op_sel:[0,0,0] op_sel_hi:[1,0,1] neg_lo:[0,0,1] neg_hi:[0,0,1]
  v_cvt_pk_bf16_f32 v44, v44, v45
  v_cvt_pk_bf16_f32 v45, v46, v47
  buffer_store_dwordx2 v[44:45], v173, s[12:15], s41 offen
  v_pk_mul_f32 v[178:179], v[80:81], v[100:101] op_sel:[0,1] op_sel_hi:[1,1]
  v_pk_fma_f32 v[48:49], v[48:49], v[100:101], v[178:179] op_sel:[0,0,0] op_sel_hi:[1,0,1] neg_lo:[0,0,1] neg_hi:[0,0,1]
  v_pk_mul_f32 v[180:181], v[82:83], v[100:101] op_sel:[0,1] op_sel_hi:[1,1]
  v_pk_fma_f32 v[50:51], v[50:51], v[100:101], v[180:181] op_sel:[0,0,0] op_sel_hi:[1,0,1] neg_lo:[0,0,1] neg_hi:[0,0,1]
  v_cvt_pk_bf16_f32 v48, v48, v49
  v_cvt_pk_bf16_f32 v49, v50, v51
  buffer_store_dwordx2 v[48:49], v172, s[12:15], s42 offen
  v_pk_mul_f32 v[178:179], v[80:81], v[102:103] op_sel:[0,1] op_sel_hi:[1,1]
  v_pk_fma_f32 v[52:53], v[52:53], v[102:103], v[178:179] op_sel:[0,0,0] op_sel_hi:[1,0,1] neg_lo:[0,0,1] neg_hi:[0,0,1]
  v_pk_mul_f32 v[180:181], v[82:83], v[102:103] op_sel:[0,1] op_sel_hi:[1,1]
  v_pk_fma_f32 v[54:55], v[54:55], v[102:103], v[180:181] op_sel:[0,0,0] op_sel_hi:[1,0,1] neg_lo:[0,0,1] neg_hi:[0,0,1]
  v_cvt_pk_bf16_f32 v52, v52, v53
  v_cvt_pk_bf16_f32 v53, v54, v55
  buffer_store_dwordx2 v[52:53], v173, s[12:15], s42 offen
  v_pk_mul_f32 v[178:179], v[84:85], v[96:97] op_sel:[0,1] op_sel_hi:[1,1]
  v_pk_fma_f32 v[56:57], v[56:57], v[96:97], v[178:179] op_sel:[0,0,0] op_sel_hi:[1,0,1] neg_lo:[0,0,1] neg_hi:[0,0,1]
  v_pk_mul_f32 v[180:181], v[86:87], v[96:97] op_sel:[0,1] op_sel_hi:[1,1]
  v_pk_fma_f32 v[58:59], v[58:59], v[96:97], v[180:181] op_sel:[0,0,0] op_sel_hi:[1,0,1] neg_lo:[0,0,1] neg_hi:[0,0,1]
  v_cvt_pk_bf16_f32 v56, v56, v57
  v_cvt_pk_bf16_f32 v57, v58, v59
  buffer_store_dwordx2 v[56:57], v174, s[12:15], s41 offen
  v_pk_mul_f32 v[178:179], v[84:85], v[98:99] op_sel:[0,1] op_sel_hi:[1,1]
  v_pk_fma_f32 v[60:61], v[60:61], v[98:99], v[178:179] op_sel:[0,0,0] op_sel_hi:[1,0,1] neg_lo:[0,0,1] neg_hi:[0,0,1]
  v_pk_mul_f32 v[180:181], v[86:87], v[98:99] op_sel:[0,1] op_sel_hi:[1,1]
  v_pk_fma_f32 v[62:63], v[62:63], v[98:99], v[180:181] op_sel:[0,0,0] op_sel_hi:[1,0,1] neg_lo:[0,0,1] neg_hi:[0,0,1]
  v_cvt_pk_bf16_f32 v60, v60, v61
  v_cvt_pk_bf16_f32 v61, v62, v63
  buffer_store_dwordx2 v[60:61], v175, s[12:15], s41 offen
  v_pk_mul_f32 v[178:179], v[84:85], v[100:101] op_sel:[0,1] op_sel_hi:[1,1]
  v_pk_fma_f32 v[64:65], v[64:65], v[100:101], v[178:179] op_sel:[0,0,0] op_sel_hi:[1,0,1] neg_lo:[0,0,1] neg_hi:[0,0,1]
  v_pk_mul_f32 v[180:181], v[86:87], v[100:101] op_sel:[0,1] op_sel_hi:[1,1]
  v_pk_fma_f32 v[66:67], v[66:67], v[100:101], v[180:181] op_sel:[0,0,0] op_sel_hi:[1,0,1] neg_lo:[0,0,1] neg_hi:[0,0,1]
  v_cvt_pk_bf16_f32 v64, v64, v65
  v_cvt_pk_bf16_f32 v65, v66, v67
  buffer_store_dwordx2 v[64:65], v174, s[12:15], s42 offen
  v_pk_mul_f32 v[178:179], v[84:85], v[102:103] op_sel:[0,1] op_sel_hi:[1,1]
  v_pk_fma_f32 v[68:69], v[68:69], v[102:103], v[178:179] op_sel:[0,0,0] op_sel_hi:[1,0,1] neg_lo:[0,0,1] neg_hi:[0,0,1]
  v_pk_mul_f32 v[180:181], v[86:87], v[102:103] op_sel:[0,1] op_sel_hi:[1,1]
  v_pk_fma_f32 v[70:71], v[70:71], v[102:103], v[180:181] op_sel:[0,0,0] op_sel_hi:[1,0,1] neg_lo:[0,0,1] neg_hi:[0,0,1]
  v_cvt_pk_bf16_f32 v68, v68, v69
  v_cvt_pk_bf16_f32 v69, v70, v71
  buffer_store_dwordx2 v[68:69], v175, s[12:15], s42 offen
  s_endpgm
L_qkv_vA:
  s_mul_i32 s41, s30, 2880
  s_add_u32 s41, s41, 13336576
  s_mul_i32 s42, s31, 2880
  s_add_u32 s42, s42, 13336576
  s_sub_u32 s39, s16, 10
  s_lshl_b32 s39, s39, 7
  s_lshl_b32 s24, s19, 6
  s_add_u32 s39, s39, s24
  s_mov_b32 s40, 184320
  s_lshl_b32 s24, s44, 4
  s_add_u32 s24, s24, s39
  v_add_u32 v176, s24, v4
  v_mul_u32_u24 v177, 3277, v176
  v_lshrrev_b32 v177, 16, v177
  v_mul_u32_u24 v178, 20, v177
  v_sub_u32 v178, v176, v178
  v_and_b32 v179, 1, v5
  v_mul_u32_u24 v179, 21, v179
  v_add_u32 v179, v179, v178
  v_lshlrev_b32 v179, 4, v179
  v_lshrrev_b32 v180, 1, v5
  v_lshl_add_u32 v179, v180, 3, v179
  v_mul_lo_u32 v177, v177, s40
  v_add_u32 v181, v179, v177
  v_add_u32 v168, 1536, v181
  v_add_u32 v169, 672, v168
  s_lshl_b32 s24, s45, 4
  s_add_u32 s24, s24, s39
  v_add_u32 v176, s24, v4
  v_mul_u32_u24 v177, 3277, v176
  v_lshrrev_b32 v177, 16, v177
  v_mul_u32_u24 v178, 20, v177
  v_sub_u32 v178, v176, v178
  v_and_b32 v179, 1, v5
  v_mul_u32_u24 v179, 21, v179
  v_add_u32 v179, v179, v178
  v_lshlrev_b32 v179, 4, v179
  v_lshrrev_b32 v180, 1, v5
  v_lshl_add_u32 v179, v180, 3, v179
  v_mul_lo_u32 v177, v177, s40
  v_add_u32 v181, v179, v177
  v_add_u32 v170, 1536, v181
  v_add_u32 v171, 672, v170
  s_lshl_b32 s24, s46, 4
  s_add_u32 s24, s24, s39
  v_add_u32 v176, s24, v4
  v_mul_u32_u24 v177, 3277, v176
  v_lshrrev_b32 v177, 16, v177
  v_mul_u32_u24 v178, 20, v177
  v_sub_u32 v178, v176, v178
  v_and_b32 v179, 1, v5
  v_mul_u32_u24 v179, 21, v179
  v_add_u32 v179, v179, v178
  v_lshlrev_b32 v179, 4, v179
  v_lshrrev_b32 v180, 1, v5
  v_lshl_add_u32 v179, v180, 3, v179
  v_mul_lo_u32 v177, v177, s40
  v_add_u32 v181, v179, v177
  v_add_u32 v172, 1536, v181
  v_add_u32 v173, 672, v172
  s_lshl_b32 s24, s47, 4
  s_add_u32 s24, s24, s39
  v_add_u32 v176, s24, v4
  v_mul_u32_u24 v177, 3277, v176
  v_lshrrev_b32 v177, 16, v177
  v_mul_u32_u24 v178, 20, v177
  v_sub_u32 v178, v176, v178
  v_and_b32 v179, 1, v5
  v_mul_u32_u24 v179, 21, v179
  v_add_u32 v179, v179, v178
  v_lshlrev_b32 v179, 4, v179
  v_lshrrev_b32 v180, 1, v5
  v_lshl_add_u32 v179, v180, 3, v179
  v_mul_lo_u32 v177, v177, s40
  v_add_u32 v181, v179, v177
  v_add_u32 v174, 1536, v181
  v_add_u32 v175, 672, v174
  s_waitcnt lgkmcnt(0)
  s_and_b32 s13, s13, 0xffff
  s_mov_b32 s26, 0
L_qkv_loopA:
  s_barrier
  ds_read_b128 v[96:99], v160 offset:0
  ds_read_b128 v[100:103], v160 offset:2048
  ds_read_b128 v[104:107], v162 offset:0
  ds_read_b128 v[108:111], v162 offset:2048
  v_mfma_f32_16x16x32_bf16 v[8:11], v[128:131], v[144:147], v[8:11]
  ds_read_b64_tr_b16 v[112:113], v164 offset:0
  v_mfma_f32_16x16x32_bf16 v[12:15], v[132:135], v[144:147], v[12:15]
  ds_read_b64_tr_b16 v[114:115], v164 offset:4096
  v_mfma_f32_16x16x32_bf16 v[16:19], v[136:139], v[144:147], v[16:19]
  ds_read_b64_tr_b16 v[116:117], v165 offset:0
  v_mfma_f32_16x16x32_bf16 v[20:23], v[140:143], v[144:147], v[20:23]
  ds_read_b64_tr_b16 v[118:119], v165 offset:4096
  v_mfma_f32_16x16x32_bf16 v[72:75], v[88:91], v[144:147], v[72:75]
  ds_read_b64_tr_b16 v[120:121], v166 offset:0
  v_mfma_f32_16x16x32_bf16 v[184:187], v[88:91], v[128:131], v[184:187]
  ds_read_b64_tr_b16 v[122:123], v166 offset:4096
  v_mfma_f32_16x16x32_bf16 v[192:195], v[128:131], v[128:131], v[192:195]
  ds_read_b64_tr_b16 v[124:125], v167 offset:0
  v_mfma_f32_16x16x32_bf16 v[24:27], v[128:131], v[148:151], v[24:27]
  ds_read_b64_tr_b16 v[126:127], v167 offset:4096
  v_mfma_f32_16x16x32_bf16 v[28:31], v[132:135], v[148:151], v[28:31]
  v_mfma_f32_16x16x32_bf16 v[32:35], v[136:139], v[148:151], v[32:35]
  v_mfma_f32_16x16x32_bf16 v[36:39], v[140:143], v[148:151], v[36:39]
  v_mfma_f32_16x16x32_bf16 v[76:79], v[88:91], v[148:151], v[76:79]
  v_mfma_f32_16x16x32_bf16 v[188:191], v[88:91], v[132:135], v[188:191]
  v_mfma_f32_16x16x32_bf16 v[196:199], v[132:135], v[132:135], v[196:199]
  v_mfma_f32_16x16x32_bf16 v[40:43], v[128:131], v[152:155], v[40:43]
  v_mfma_f32_16x16x32_bf16 v[44:47], v[132:135], v[152:155], v[44:47]
  v_mfma_f32_16x16x32_bf16 v[48:51], v[136:139], v[152:155], v[48:51]
  v_mfma_f32_16x16x32_bf16 v[52:55], v[140:143], v[152:155], v[52:55]
  v_mfma_f32_16x16x32_bf16 v[56:59], v[128:131], v[156:159], v[56:59]
  v_mfma_f32_16x16x32_bf16 v[60:63], v[132:135], v[156:159], v[60:63]
  v_mfma_f32_16x16x32_bf16 v[64:67], v[136:139], v[156:159], v[64:67]
  v_mfma_f32_16x16x32_bf16 v[68:71], v[140:143], v[156:159], v[68:71]
  s_waitcnt lgkmcnt(0)
  v_mfma_f32_16x16x32_bf16 v[8:11], v[96:99], v[112:115], v[8:11]
  ds_read_b128 v[128:131], v161 offset:0
  v_mfma_f32_16x16x32_bf16 v[12:15], v[100:103], v[112:115], v[12:15]
  ds_read_b128 v[132:135], v161 offset:2048
  v_mfma_f32_16x16x32_bf16 v[16:19], v[104:107], v[112:115], v[16:19]
  ds_read_b128 v[136:139], v163 offset:0
  v_mfma_f32_16x16x32_bf16 v[20:23], v[108:111], v[112:115], v[20:23]
  ds_read_b128 v[140:143], v163 offset:2048
  v_mfma_f32_16x16x32_bf16 v[72:75], v[88:91], v[112:115], v[72:75]
  ds_read_b64_tr_b16 v[144:145], v164 offset:8192
  v_mfma_f32_16x16x32_bf16 v[184:187], v[88:91], v[96:99], v[184:187]
  ds_read_b64_tr_b16 v[146:147], v164 offset:12288
  v_mfma_f32_16x16x32_bf16 v[192:195], v[96:99], v[96:99], v[192:195]
  ds_read_b64_tr_b16 v[148:149], v165 offset:8192
  v_mfma_f32_16x16x32_bf16 v[24:27], v[96:99], v[116:119], v[24:27]
  ds_read_b64_tr_b16 v[150:151], v165 offset:12288
  v_mfma_f32_16x16x32_bf16 v[28:31], v[100:103], v[116:119], v[28:31]
  ds_read_b64_tr_b16 v[152:153], v166 offset:8192
  v_mfma_f32_16x16x32_bf16 v[32:35], v[104:107], v[116:119], v[32:35]
  ds_read_b64_tr_b16 v[154:155], v166 offset:12288
  v_mfma_f32_16x16x32_bf16 v[36:39], v[108:111], v[116:119], v[36:39]
  ds_read_b64_tr_b16 v[156:157], v167 offset:8192
  v_mfma_f32_16x16x32_bf16 v[76:79], v[88:91], v[116:119], v[76:79]
  ds_read_b64_tr_b16 v[158:159], v167 offset:12288
  v_mfma_f32_16x16x32_bf16 v[188:191], v[88:91], v[100:103], v[188:191]
  v_mfma_f32_16x16x32_bf16 v[196:199], v[100:103], v[100:103], v[196:199]
  v_mfma_f32_16x16x32_bf16 v[40:43], v[96:99], v[120:123], v[40:43]
  v_mfma_f32_16x16x32_bf16 v[44:47], v[100:103], v[120:123], v[44:47]
  v_mfma_f32_16x16x32_bf16 v[48:51], v[104:107], v[120:123], v[48:51]
  v_mfma_f32_16x16x32_bf16 v[52:55], v[108:111], v[120:123], v[52:55]
  v_mfma_f32_16x16x32_bf16 v[56:59], v[96:99], v[124:127], v[56:59]
  v_mfma_f32_16x16x32_bf16 v[60:63], v[100:103], v[124:127], v[60:63]
  v_mfma_f32_16x16x32_bf16 v[64:67], v[104:107], v[124:127], v[64:67]
  v_mfma_f32_16x16x32_bf16 v[68:71], v[108:111], v[124:127], v[68:71]
  s_waitcnt lgkmcnt(0)
  s_barrier
  ds_read_b128 v[96:99], v160 offset:32768
  ds_read_b128 v[100:103], v160 offset:34816
  ds_read_b128 v[104:107], v162 offset:32768
  ds_read_b128 v[108:111], v162 offset:34816
  v_mfma_f32_16x16x32_bf16 v[8:11], v[128:131], v[144:147], v[8:11]
  ds_read_b64_tr_b16 v[112:113], v164 offset:32768
  v_mfma_f32_16x16x32_bf16 v[12:15], v[132:135], v[144:147], v[12:15]
  ds_read_b64_tr_b16 v[114:115], v164 offset:36864
  v_mfma_f32_16x16x32_bf16 v[16:19], v[136:139], v[144:147], v[16:19]
  ds_read_b64_tr_b16 v[116:117], v165 offset:32768
  v_mfma_f32_16x16x32_bf16 v[20:23], v[140:143], v[144:147], v[20:23]
  ds_read_b64_tr_b16 v[118:119], v165 offset:36864
  v_mfma_f32_16x16x32_bf16 v[72:75], v[88:91], v[144:147], v[72:75]
  ds_read_b64_tr_b16 v[120:121], v166 offset:32768
  v_mfma_f32_16x16x32_bf16 v[184:187], v[88:91], v[128:131], v[184:187]
  ds_read_b64_tr_b16 v[122:123], v166 offset:36864
  v_mfma_f32_16x16x32_bf16 v[192:195], v[128:131], v[128:131], v[192:195]
  ds_read_b64_tr_b16 v[124:125], v167 offset:32768
  v_mfma_f32_16x16x32_bf16 v[24:27], v[128:131], v[148:151], v[24:27]
  ds_read_b64_tr_b16 v[126:127], v167 offset:36864
  v_mfma_f32_16x16x32_bf16 v[28:31], v[132:135], v[148:151], v[28:31]
  v_mfma_f32_16x16x32_bf16 v[32:35], v[136:139], v[148:151], v[32:35]
  v_mfma_f32_16x16x32_bf16 v[36:39], v[140:143], v[148:151], v[36:39]
  v_mfma_f32_16x16x32_bf16 v[76:79], v[88:91], v[148:151], v[76:79]
  v_mfma_f32_16x16x32_bf16 v[188:191], v[88:91], v[132:135], v[188:191]
  v_mfma_f32_16x16x32_bf16 v[196:199], v[132:135], v[132:135], v[196:199]
  v_mfma_f32_16x16x32_bf16 v[40:43], v[128:131], v[152:155], v[40:43]
  v_mfma_f32_16x16x32_bf16 v[44:47], v[132:135], v[152:155], v[44:47]
  v_mfma_f32_16x16x32_bf16 v[48:51], v[136:139], v[152:155], v[48:51]
  v_mfma_f32_16x16x32_bf16 v[52:55], v[140:143], v[152:155], v[52:55]
  v_mfma_f32_16x16x32_bf16 v[56:59], v[128:131], v[156:159], v[56:59]
  v_mfma_f32_16x16x32_bf16 v[60:63], v[132:135], v[156:159], v[60:63]
  v_mfma_f32_16x16x32_bf16 v[64:67], v[136:139], v[156:159], v[64:67]
  v_mfma_f32_16x16x32_bf16 v[68:71], v[140:143], v[156:159], v[68:71]
  s_waitcnt lgkmcnt(0)
  v_mfma_f32_16x16x32_bf16 v[8:11], v[96:99], v[112:115], v[8:11]
  ds_read_b128 v[128:131], v161 offset:32768
  v_mfma_f32_16x16x32_bf16 v[12:15], v[100:103], v[112:115], v[12:15]
  ds_read_b128 v[132:135], v161 offset:34816
  v_mfma_f32_16x16x32_bf16 v[16:19], v[104:107], v[112:115], v[16:19]
  ds_read_b128 v[136:139], v163 offset:32768
  v_mfma_f32_16x16x32_bf16 v[20:23], v[108:111], v[112:115], v[20:23]
  ds_read_b128 v[140:143], v163 offset:34816
  v_mfma_f32_16x16x32_bf16 v[72:75], v[88:91], v[112:115], v[72:75]
  ds_read_b64_tr_b16 v[144:145], v164 offset:40960
  v_mfma_f32_16x16x32_bf16 v[184:187], v[88:91], v[96:99], v[184:187]
  ds_read_b64_tr_b16 v[146:147], v164 offset:45056
  v_mfma_f32_16x16x32_bf16 v[192:195], v[96:99], v[96:99], v[192:195]
  ds_read_b64_tr_b16 v[148:149], v165 offset:40960
  v_mfma_f32_16x16x32_bf16 v[24:27], v[96:99], v[116:119], v[24:27]
  ds_read_b64_tr_b16 v[150:151], v165 offset:45056
  v_mfma_f32_16x16x32_bf16 v[28:31], v[100:103], v[116:119], v[28:31]
  ds_read_b64_tr_b16 v[152:153], v166 offset:40960
  v_mfma_f32_16x16x32_bf16 v[32:35], v[104:107], v[116:119], v[32:35]
  ds_read_b64_tr_b16 v[154:155], v166 offset:45056
  v_mfma_f32_16x16x32_bf16 v[36:39], v[108:111], v[116:119], v[36:39]
  ds_read_b64_tr_b16 v[156:157], v167 offset:40960
  v_mfma_f32_16x16x32_bf16 v[76:79], v[88:91], v[116:119], v[76:79]
  ds_read_b64_tr_b16 v[158:159], v167 offset:45056
  v_mfma_f32_16x16x32_bf16 v[188:191], v[88:91], v[100:103], v[188:191]
  v_mfma_f32_16x16x32_bf16 v[196:199], v[100:103], v[100:103], v[196:199]
  v_mfma_f32_16x16x32_bf16 v[40:43], v[96:99], v[120:123], v[40:43]
  v_mfma_f32_16x16x32_bf16 v[44:47], v[100:103], v[120:123], v[44:47]
  v_mfma_f32_16x16x32_bf16 v[48:51], v[104:107], v[120:123], v[48:51]
  v_mfma_f32_16x16x32_bf16 v[52:55], v[108:111], v[120:123], v[52:55]
  v_mfma_f32_16x16x32_bf16 v[56:59], v[96:99], v[124:127], v[56:59]
  v_mfma_f32_16x16x32_bf16 v[60:63], v[100:103], v[124:127], v[60:63]
  v_mfma_f32_16x16x32_bf16 v[64:67], v[104:107], v[124:127], v[64:67]
  v_mfma_f32_16x16x32_bf16 v[68:71], v[108:111], v[124:127], v[68:71]
  s_waitcnt lgkmcnt(0)
  v_xor_b32 v160, 65536, v160
  v_xor_b32 v161, 65536, v161
  v_xor_b32 v162, 65536, v162
  v_xor_b32 v163, 65536, v163
  v_xor_b32 v164, 65536, v164
  v_xor_b32 v165, 65536, v165
  v_xor_b32 v166, 65536, v166
  v_xor_b32 v167, 65536, v167
  s_add_u32 s26, s26, 1
  s_cmp_lt_u32 s26, 5
  s_cbranch_scc1 L_qkv_loopA
  v_mfma_f32_16x16x32_bf16 v[8:11], v[128:131], v[144:147], v[8:11]
  v_mfma_f32_16x16x32_bf16 v[12:15], v[132:135], v[144:147], v[12:15]
  v_mfma_f32_16x16x32_bf16 v[16:19], v[136:139], v[144:147], v[16:19]
  v_mfma_f32_16x16x32_bf16 v[20:23], v[140:143], v[144:147], v[20:23]
  v_mfma_f32_16x16x32_bf16 v[72:75], v[88:91], v[144:147], v[72:75]
  v_mfma_f32_16x16x32_bf16 v[184:187], v[88:91], v[128:131], v[184:187]
  v_mfma_f32_16x16x32_bf16 v[192:195], v[128:131], v[128:131], v[192:195]
  v_mfma_f32_16x16x32_bf16 v[24:27], v[128:131], v[148:151], v[24:27]
  v_mfma_f32_16x16x32_bf16 v[28:31], v[132:135], v[148:151], v[28:31]
  v_mfma_f32_16x16x32_bf16 v[32:35], v[136:139], v[148:151], v[32:35]
  v_mfma_f32_16x16x32_bf16 v[36:39], v[140:143], v[148:151], v[36:39]
  v_mfma_f32_16x16x32_bf16 v[76:79], v[88:91], v[148:151], v[76:79]
  v_mfma_f32_16x16x32_bf16 v[188:191], v[88:91], v[132:135], v[188:191]
  v_mfma_f32_16x16x32_bf16 v[196:199], v[132:135], v[132:135], v[196:199]
  v_mfma_f32_16x16x32_bf16 v[40:43], v[128:131], v[152:155], v[40:43]
  v_mfma_f32_16x16x32_bf16 v[44:47], v[132:135], v[152:155], v[44:47]
  v_mfma_f32_16x16x32_bf16 v[48:51], v[136:139], v[152:155], v[48:51]
  v_mfma_f32_16x16x32_bf16 v[52:55], v[140:143], v[152:155], v[52:55]
  v_mfma_f32_16x16x32_bf16 v[56:59], v[128:131], v[156:159], v[56:59]
  v_mfma_f32_16x16x32_bf16 v[60:63], v[132:135], v[156:159], v[60:63]
  v_mfma_f32_16x16x32_bf16 v[64:67], v[136:139], v[156:159], v[64:67]
  v_mfma_f32_16x16x32_bf16 v[68:71], v[140:143], v[156:159], v[68:71]
  s_nop 7
  v_and_b32 v178, 3, v4
  v_lshrrev_b32 v179, 2, v4
  v_cmp_eq_u32 s[28:29], v179, v5
  v_cmp_eq_u32 vcc, 1, v178
  s_nop 1
  v_cndmask_b32 v185, v192, v193, vcc
  v_cmp_eq_u32 vcc, 2, v178
  s_nop 1
  v_cndmask_b32 v185, v185, v194, vcc
  v_cmp_eq_u32 vcc, 3, v178
  s_nop 1
  v_cndmask_b32 v185, v185, v195, vcc
  v_cndmask_b32 v185, 0, v185, s[28:29]
  v_cmp_eq_u32 vcc, 1, v178
  s_nop 1
  v_cndmask_b32 v187, v196, v197, vcc
  v_cmp_eq_u32 vcc, 2, v178
  s_nop 1
  v_cndmask_b32 v187, v187, v198, vcc
  v_cmp_eq_u32 vcc, 3, v178
  s_nop 1
  v_cndmask_b32 v187, v187, v199, vcc
  v_cndmask_b32 v187, 0, v187, s[28:29]
  ds_swizzle_b32 v176, v185 offset:0x401F
  ds_swizzle_b32 v177, v187 offset:0x401F
  s_lshl_b32 s24, s3, 11
  s_add_u32 s24, s24, 132096
  v_add_u32 v180, s24, v3
  s_xor_b32 s24, s3, 1
  s_lshl_b32 s24, s24, 11
  s_add_u32 s24, s24, 132096
  v_add_u32 v181, s24, v3
  ds_write_b128 v180, v[72:75]
  ds_write_b128 v180, v[76:79] offset:1024
  s_waitcnt lgkmcnt(2)
  v_add_f32 v185, v185, v176
  v_add_f32 v187, v187, v177
  v_mov_b32 v176, v185
  v_mov_b32 v177, v187
  s_nop 1
  v_permlane32_swap_b32 v176, v185
  v_permlane32_swap_b32 v177, v187
  s_nop 1
  v_add_f32 v185, v185, v176
  v_add_f32 v187, v187, v177
  v_mul_f32 v184, 986500301, v184
  v_mul_f32 v185, 986500301, v185
  v_fma_f32 v185, -v184, v184, v185
  v_max_f32 v185, 0, v185
  v_add_f32 v185, 925353388, v185
  v_rsq_f32 v185, v185
  s_nop 0
  v_mul_f32 v184, v184, v185
  v_mul_f32 v186, 986500301, v188
  v_mul_f32 v187, 986500301, v187
  v_fma_f32 v187, -v186, v186, v187
  v_max_f32 v187, 0, v187
  v_add_f32 v187, 925353388, v187
  v_rsq_f32 v187, v187
  s_nop 0
  v_mul_f32 v186, v186, v187
  v_lshlrev_b32 v176, 2, v4
  v_add_u32 v176, s32, v176
  ds_write_b32 v176, v185
  ds_write_b32 v176, v184 offset:512
  ds_write_b32 v176, v187 offset:64
  ds_write_b32 v176, v186 offset:576
  s_waitcnt lgkmcnt(0)
  s_barrier
  ds_read_b128 v[80:83], v181
  ds_read_b128 v[84:87], v181 offset:1024
  v_lshlrev_b32 v176, 4, v5
  v_add_u32 v177, s33, v176
  v_add_u32 v176, s32, v176
  ds_read_b128 v[96:99], v176 offset:0
  ds_read_b128 v[100:103], v176 offset:512
  ds_read_b128 v[104:107], v176 offset:64
  ds_read_b128 v[108:111], v176 offset:576
  ds_read_b128 v[112:115], v177 offset:0
  ds_read_b128 v[116:119], v177 offset:512
  ds_read_b128 v[120:123], v177 offset:64
  ds_read_b128 v[124:127], v177 offset:576
  s_waitcnt lgkmcnt(0)
  v_pk_mul_f32 v[178:179], v[100:101], v[72:73]
  v_pk_fma_f32 v[8:9], v[8:9], v[96:97], v[178:179] neg_lo:[0,0,1] neg_hi:[0,0,1]
  v_pk_mul_f32 v[180:181], v[102:103], v[72:73]
  v_pk_fma_f32 v[10:11], v[10:11], v[98:99], v[180:181] neg_lo:[0,0,1] neg_hi:[0,0,1]
  v_cvt_pk_bf16_f32 v8, v8, v9
  v_cvt_pk_bf16_f32 v9, v10, v11
  buffer_store_dwordx2 v[8:9], v168, s[12:15], s41 offen
  v_pk_mul_f32 v[178:179], v[108:109], v[72:73]
  v_pk_fma_f32 v[12:13], v[12:13], v[104:105], v[178:179] neg_lo:[0,0,1] neg_hi:[0,0,1]
  v_pk_mul_f32 v[180:181], v[110:111], v[72:73]
  v_pk_fma_f32 v[14:15], v[14:15], v[106:107], v[180:181] neg_lo:[0,0,1] neg_hi:[0,0,1]
  v_cvt_pk_bf16_f32 v12, v12, v13
  v_cvt_pk_bf16_f32 v13, v14, v15
  buffer_store_dwordx2 v[12:13], v169, s[12:15], s41 offen
  v_pk_mul_f32 v[178:179], v[116:117], v[72:73]
  v_pk_fma_f32 v[16:17], v[16:17], v[112:113], v[178:179] neg_lo:[0,0,1] neg_hi:[0,0,1]
  v_pk_mul_f32 v[180:181], v[118:119], v[72:73]
  v_pk_fma_f32 v[18:19], v[18:19], v[114:115], v[180:181] neg_lo:[0,0,1] neg_hi:[0,0,1]
  v_cvt_pk_bf16_f32 v16, v16, v17
  v_cvt_pk_bf16_f32 v17, v18, v19
  buffer_store_dwordx2 v[16:17], v168, s[12:15], s42 offen
  v_pk_mul_f32 v[178:179], v[124:125], v[72:73]
  v_pk_fma_f32 v[20:21], v[20:21], v[120:121], v[178:179] neg_lo:[0,0,1] neg_hi:[0,0,1]
  v_pk_mul_f32 v[180:181], v[126:127], v[72:73]
  v_pk_fma_f32 v[22:23], v[22:23], v[122:123], v[180:181] neg_lo:[0,0,1] neg_hi:[0,0,1]
  v_cvt_pk_bf16_f32 v20, v20, v21
  v_cvt_pk_bf16_f32 v21, v22, v23
  buffer_store_dwordx2 v[20:21], v169, s[12:15], s42 offen
  v_pk_mul_f32 v[178:179], v[100:101], v[76:77]
  v_pk_fma_f32 v[24:25], v[24:25], v[96:97], v[178:179] neg_lo:[0,0,1] neg_hi:[0,0,1]
  v_pk_mul_f32 v[180:181], v[102:103], v[76:77]
  v_pk_fma_f32 v[26:27], v[26:27], v[98:99], v[180:181] neg_lo:[0,0,1] neg_hi:[0,0,1]
  v_cvt_pk_bf16_f32 v24, v24, v25
  v_cvt_pk_bf16_f32 v25, v26, v27
  buffer_store_dwordx2 v[24:25], v170, s[12:15], s41 offen
  v_pk_mul_f32 v[178:179], v[108:109], v[76:77]
  v_pk_fma_f32 v[28:29], v[28:29], v[104:105], v[178:179] neg_lo:[0,0,1] neg_hi:[0,0,1]
  v_pk_mul_f32 v[180:181], v[110:111], v[76:77]
  v_pk_fma_f32 v[30:31], v[30:31], v[106:107], v[180:181] neg_lo:[0,0,1] neg_hi:[0,0,1]
  v_cvt_pk_bf16_f32 v28, v28, v29
  v_cvt_pk_bf16_f32 v29, v30, v31
  buffer_store_dwordx2 v[28:29], v171, s[12:15], s41 offen
  v_pk_mul_f32 v[178:179], v[116:117], v[76:77]
  v_pk_fma_f32 v[32:33], v[32:33], v[112:113], v[178:179] neg_lo:[0,0,1] neg_hi:[0,0,1]
  v_pk_mul_f32 v[180:181], v[118:119], v[76:77]
  v_pk_fma_f32 v[34:35], v[34:35], v[114:115], v[180:181] neg_lo:[0,0,1] neg_hi:[0,0,1]
  v_cvt_pk_bf16_f32 v32, v32, v33
  v_cvt_pk_bf16_f32 v33, v34, v35
  buffer_store_dwordx2 v[32:33], v170, s[12:15], s42 offen
  v_pk_mul_f32 v[178:179], v[124:125], v[76:77]
  v_pk_fma_f32 v[36:37], v[36:37], v[120:121], v[178:179] neg_lo:[0,0,1] neg_hi:[0,0,1]
  v_pk_mul_f32 v[180:181], v[126:127], v[76:77]
  v_pk_fma_f32 v[38:39], v[38:39], v[122:123], v[180:181] neg_lo:[0,0,1] neg_hi:[0,0,1]
  v_cvt_pk_bf16_f32 v36, v36, v37
  v_cvt_pk_bf16_f32 v37, v38, v39
  buffer_store_dwordx2 v[36:37], v171, s[12:15], s42 offen
  v_pk_mul_f32 v[178:179], v[100:101], v[80:81]
  v_pk_fma_f32 v[40:41], v[40:41], v[96:97], v[178:179] neg_lo:[0,0,1] neg_hi:[0,0,1]
  v_pk_mul_f32 v[180:181], v[102:103], v[80:81]
  v_pk_fma_f32 v[42:43], v[42:43], v[98:99], v[180:181] neg_lo:[0,0,1] neg_hi:[0,0,1]
  v_cvt_pk_bf16_f32 v40, v40, v41
  v_cvt_pk_bf16_f32 v41, v42, v43
  buffer_store_dwordx2 v[40:41], v172, s[12:15], s41 offen
  v_pk_mul_f32 v[178:179], v[108:109], v[80:81]
  v_pk_fma_f32 v[44:45], v[44:45], v[104:105], v[178:179] neg_lo:[0,0,1] neg_hi:[0,0,1]
  v_pk_mul_f32 v[180:181], v[110:111], v[80:81]
  v_pk_fma_f32 v[46:47], v[46:47], v[106:107], v[180:181] neg_lo:[0,0,1] neg_hi:[0,0,1]
  v_cvt_pk_bf16_f32 v44, v44, v45
  v_cvt_pk_bf16_f32 v45, v46, v47
  buffer_store_dwordx2 v[44:45], v173, s[12:15], s41 offen
  v_pk_mul_f32 v[178:179], v[116:117], v[80:81]
  v_pk_fma_f32 v[48:49], v[48:49], v[112:113], v[178:179] neg_lo:[0,0,1] neg_hi:[0,0,1]
  v_pk_mul_f32 v[180:181], v[118:119], v[80:81]
  v_pk_fma_f32 v[50:51], v[50:51], v[114:115], v[180:181] neg_lo:[0,0,1] neg_hi:[0,0,1]
  v_cvt_pk_bf16_f32 v48, v48, v49
  v_cvt_pk_bf16_f32 v49, v50, v51
  buffer_store_dwordx2 v[48:49], v172, s[12:15], s42 offen
  v_pk_mul_f32 v[178:179], v[124:125], v[80:81]
  v_pk_fma_f32 v[52:53], v[52:53], v[120:121], v[178:179] neg_lo:[0,0,1] neg_hi:[0,0,1]
  v_pk_mul_f32 v[180:181], v[126:127], v[80:81]
  v_pk_fma_f32 v[54:55], v[54:55], v[122:123], v[180:181] neg_lo:[0,0,1] neg_hi:[0,0,1]
  v_cvt_pk_bf16_f32 v52, v52, v53
  v_cvt_pk_bf16_f32 v53, v54, v55
  buffer_store_dwordx2 v[52:53], v173, s[12:15], s42 offen
  v_pk_mul_f32 v[178:179], v[100:101], v[84:85]
  v_pk_fma_f32 v[56:57], v[56:57], v[96:97], v[178:179] neg_lo:[0,0,1] neg_hi:[0,0,1]
  v_pk_mul_f32 v[180:181], v[102:103], v[84:85]
  v_pk_fma_f32 v[58:59], v[58:59], v[98:99], v[180:181] neg_lo:[0,0,1] neg_hi:[0,0,1]
  v_cvt_pk_bf16_f32 v56, v56, v57
  v_cvt_pk_bf16_f32 v57, v58, v59
  buffer_store_dwordx2 v[56:57], v174, s[12:15], s41 offen
  v_pk_mul_f32 v[178:179], v[108:109], v[84:85]
  v_pk_fma_f32 v[60:61], v[60:61], v[104:105], v[178:179] neg_lo:[0,0,1] neg_hi:[0,0,1]
  v_pk_mul_f32 v[180:181], v[110:111], v[84:85]
  v_pk_fma_f32 v[62:63], v[62:63], v[106:107], v[180:181] neg_lo:[0,0,1] neg_hi:[0,0,1]
  v_cvt_pk_bf16_f32 v60, v60, v61
  v_cvt_pk_bf16_f32 v61, v62, v63
  buffer_store_dwordx2 v[60:61], v175, s[12:15], s41 offen
  v_pk_mul_f32 v[178:179], v[116:117], v[84:85]
  v_pk_fma_f32 v[64:65], v[64:65], v[112:113], v[178:179] neg_lo:[0,0,1] neg_hi:[0,0,1]
  v_pk_mul_f32 v[180:181], v[118:119], v[84:85]
  v_pk_fma_f32 v[66:67], v[66:67], v[114:115], v[180:181] neg_lo:[0,0,1] neg_hi:[0,0,1]
  v_cvt_pk_bf16_f32 v64, v64, v65
  v_cvt_pk_bf16_f32 v65, v66, v67
  buffer_store_dwordx2 v[64:65], v174, s[12:15], s42 offen
  v_pk_mul_f32 v[178:179], v[124:125], v[84:85]
  v_pk_fma_f32 v[68:69], v[68:69], v[120:121], v[178:179] neg_lo:[0,0,1] neg_hi:[0,0,1]
  v_pk_mul_f32 v[180:181], v[126:127], v[84:85]
  v_pk_fma_f32 v[70:71], v[70:71], v[122:123], v[180:181] neg_lo:[0,0,1] neg_hi:[0,0,1]
  v_cvt_pk_bf16_f32 v68, v68, v69
  v_cvt_pk_bf16_f32 v69, v70, v71
  buffer_store_dwordx2 v[68:69], v175, s[12:15], s42 offen
  s_endpgm
L_qkv_end:
  s_endpgm
.globl attn_kernel
.p2align 8
.type attn_kernel,@function
attn_kernel:
  s_cmp_ge_u32 s2, 256
  s_cbranch_scc1 L_attn_end
  s_load_dwordx2 s[12:13], s[0:1], 72
  v_lshrrev_b32 v1, 6, v0
  v_and_b32 v2, 63, v0
  s_and_b32 s16, s2, 7
  v_readfirstlane_b32 s3, v1
  s_lshr_b32 s17, s2, 3
  s_lshr_b32 s18, s17, 3
  s_lshl_b32 s19, s16, 2
  s_add_u32 s18, s18, s19
  s_and_b32 s19, s17, 7
  v_lshlrev_b32 v3, 4, v2
  s_mul_i32 s22, s18, 184320
  s_add_u32 s22, s22, 13336576
  s_mul_i32 s23, s3, 6144
  s_add_u32 s24, s22, s23
  s_cmp_ge_u32 s3, 8
  s_cbranch_scc0 L_attn_prep_else
  s_load_dwordx2 s[44:45], s[0:1], 16
  s_load_dwordx4 s[48:51], s[0:1], 32
  s_load_dwordx2 s[46:47], s[0:1], 48
  s_mov_b32 s14, 32751616
  s_mov_b32 s15, 0x00020000
  s_sub_u32 s20, s3, 8
  s_lshl_b32 s42, s2, 3
  s_lshl_b32 s21, s20, 2
  s_add_u32 s42, s42, s21
  s_mul_i32 s43, s20, 5120
  s_add_u32 s43, s43, 147456
  s_mul_i32 s23, s20, 24576
  s_add_u32 s24, s22, s23
  s_waitcnt lgkmcnt(0)
  s_and_b32 s13, s13, 0xffff
  s_add_u32 m0, s23, 0
  s_add_u32 s25, s24, 0
  buffer_load_dwordx4 v3, s[12:15], s25 offen lds
  buffer_load_dwordx4 v3, s[12:15], s25 offen offset:1024 lds
  buffer_load_dwordx4 v3, s[12:15], s25 offen offset:2048 lds
  buffer_load_dwordx4 v3, s[12:15], s25 offen offset:3072 lds
  s_add_u32 m0, s23, 4096
  s_add_u32 s25, s24, 4096
  buffer_load_dwordx4 v3, s[12:15], s25 offen lds
  buffer_load_dwordx4 v3, s[12:15], s25 offen offset:1024 lds
  buffer_load_dwordx4 v3, s[12:15], s25 offen offset:2048 lds
  buffer_load_dwordx4 v3, s[12:15], s25 offen offset:3072 lds
  s_add_u32 m0, s23, 8192
  s_add_u32 s25, s24, 8192
  buffer_load_dwordx4 v3, s[12:15], s25 offen lds
  buffer_load_dwordx4 v3, s[12:15], s25 offen offset:1024 lds
  buffer_load_dwordx4 v3, s[12:15], s25 offen offset:2048 lds
  buffer_load_dwordx4 v3, s[12:15], s25 offen offset:3072 lds
  s_add_u32 m0, s23, 12288
  s_add_u32 s25, s24, 12288
  buffer_load_dwordx4 v3, s[12:15], s25 offen lds
  buffer_load_dwordx4 v3, s[12:15], s25 offen offset:1024 lds
  buffer_load_dwordx4 v3, s[12:15], s25 offen offset:2048 lds
  buffer_load_dwordx4 v3, s[12:15], s25 offen offset:3072 lds
  s_add_u32 m0, s23, 16384
  s_add_u32 s25, s24, 16384
  buffer_load_dwordx4 v3, s[12:15], s25 offen lds
  buffer_load_dwordx4 v3, s[12:15], s25 offen offset:1024 lds
  buffer_load_dwordx4 v3, s[12:15], s25 offen offset:2048 lds
  buffer_load_dwordx4 v3, s[12:15], s25 offen offset:3072 lds
  s_add_u32 m0, s23, 20480
  s_add_u32 s25, s24, 20480
  buffer_load_dwordx4 v3, s[12:15], s25 offen lds
  buffer_load_dwordx4 v3, s[12:15], s25 offen offset:1024 lds
  buffer_load_dwordx4 v3, s[12:15], s25 offen offset:2048 lds
  buffer_load_dwordx4 v3, s[12:15], s25 offen offset:3072 lds
  s_waitcnt vmcnt(0)
  s_barrier
  s_add_u32 m0, s23, 49152
  s_add_u32 s25, s24, 46080
  buffer_load_dwordx4 v3, s[12:15], s25 offen lds
  buffer_load_dwordx4 v3, s[12:15], s25 offen offset:1024 lds
  buffer_load_dwordx4 v3, s[12:15], s25 offen offset:2048 lds
  buffer_load_dwordx4 v3, s[12:15], s25 offen offset:3072 lds
  s_add_u32 m0, s23, 53248
  s_add_u32 s25, s24, 50176
  buffer_load_dwordx4 v3, s[12:15], s25 offen lds
  buffer_load_dwordx4 v3, s[12:15], s25 offen offset:1024 lds
  buffer_load_dwordx4 v3, s[12:15], s25 offen offset:2048 lds
  buffer_load_dwordx4 v3, s[12:15], s25 offen offset:3072 lds
  s_add_u32 m0, s23, 57344
  s_add_u32 s25, s24, 54272
  buffer_load_dwordx4 v3, s[12:15], s25 offen lds
  buffer_load_dwordx4 v3, s[12:15], s25 offen offset:1024 lds
  buffer_load_dwordx4 v3, s[12:15], s25 offen offset:2048 lds
  buffer_load_dwordx4 v3, s[12:15], s25 offen offset:3072 lds
  s_add_u32 m0, s23, 61440
  s_add_u32 s25, s24, 58368
  buffer_load_dwordx4 v3, s[12:15], s25 offen lds
  buffer_load_dwordx4 v3, s[12:15], s25 offen offset:1024 lds
  buffer_load_dwordx4 v3, s[12:15], s25 offen offset:2048 lds
  buffer_load_dwordx4 v3, s[12:15], s25 offen offset:3072 lds
  s_add_u32 m0, s23, 65536
  s_add_u32 s25, s24, 62464
  buffer_load_dwordx4 v3, s[12:15], s25 offen lds
  buffer_load_dwordx4 v3, s[12:15], s25 offen offset:1024 lds
  buffer_load_dwordx4 v3, s[12:15], s25 offen offset:2048 lds
  buffer_load_dwordx4 v3, s[12:15], s25 offen offset:3072 lds
  s_add_u32 m0, s23, 69632
  s_add_u32 s25, s24, 66560
  buffer_load_dwordx4 v3, s[12:15], s25 offen lds
  buffer_load_dwordx4 v3, s[12:15], s25 offen offset:1024 lds
  buffer_load_dwordx4 v3, s[12:15], s25 offen offset:2048 lds
  buffer_load_dwordx4 v3, s[12:15], s25 offen offset:3072 lds
  s_add_u32 m0, s23, 98304
  s_add_u32 s25, s24, 92160
  buffer_load_dwordx4 v3, s[12:15], s25 offen lds
  buffer_load_dwordx4 v3, s[12:15], s25 offen offset:1024 lds
  buffer_load_dwordx4 v3, s[12:15], s25 offen offset:2048 lds
  buffer_load_dwordx4 v3, s[12:15], s25 offen offset:3072 lds
  s_add_u32 m0, s23, 102400
  s_add_u32 s25, s24, 96256
  buffer_load_dwordx4 v3, s[12:15], s25 offen lds
  buffer_load_dwordx4 v3, s[12:15], s25 offen offset:1024 lds
  buffer_load_dwordx4 v3, s[12:15], s25 offen offset:2048 lds
  buffer_load_dwordx4 v3, s[12:15], s25 offen offset:3072 lds
  s_add_u32 m0, s23, 106496
  s_add_u32 s25, s24, 100352
  buffer_load_dwordx4 v3, s[12:15], s25 offen lds
  buffer_load_dwordx4 v3, s[12:15], s25 offen offset:1024 lds
  buffer_load_dwordx4 v3, s[12:15], s25 offen offset:2048 lds
  buffer_load_dwordx4 v3, s[12:15], s25 offen offset:3072 lds
  s_add_u32 m0, s23, 110592
  s_add_u32 s25, s24, 104448
  buffer_load_dwordx4 v3, s[12:15], s25 offen lds
  buffer_load_dwordx4 v3, s[12:15], s25 offen offset:1024 lds
  buffer_load_dwordx4 v3, s[12:15], s25 offen offset:2048 lds
  buffer_load_dwordx4 v3, s[12:15], s25 offen offset:3072 lds
  s_add_u32 m0, s23, 114688
  s_add_u32 s25, s24, 108544
  buffer_load_dwordx4 v3, s[12:15], s25 offen lds
  buffer_load_dwordx4 v3, s[12:15], s25 offen offset:1024 lds
  buffer_load_dwordx4 v3, s[12:15], s25 offen offset:2048 lds
  buffer_load_dwordx4 v3, s[12:15], s25 offen offset:3072 lds
  s_add_u32 m0, s23, 118784
  s_add_u32 s25, s24, 112640
  buffer_load_dwordx4 v3, s[12:15], s25 offen lds
  buffer_load_dwordx4 v3, s[12:15], s25 offen offset:1024 lds
  buffer_load_dwordx4 v3, s[12:15], s25 offen offset:2048 lds
  buffer_load_dwordx4 v3, s[12:15], s25 offen offset:3072 lds
  s_mov_b32 s63, 0
  s_cmp_ge_u32 s42, 2032
  s_cbranch_scc1 L_apA_p1done
  s_cmp_lt_u32 s42, 160
  s_cbranch_scc0 L_apA_seg1
  s_mov_b32 s8, s44
  s_and_b32 s9, s45, 0xffff
  s_sub_u32 s52, s42, 0
  s_mov_b32 s10, 819200
  s_mov_b32 s53, 1280
  s_mov_b32 s54, 20
  s_mov_b32 s55, 8
  s_mov_b32 s56, 2457600
  s_mov_b32 s57, 536870913
  s_mov_b32 s58, 0
  s_branch L_apA_nb5
L_apA_seg1:
  s_cmp_lt_u32 s42, 592
  s_cbranch_scc0 L_apA_seg2
  s_mov_b32 s8, s46
  s_and_b32 s9, s47, 0xffff
  s_sub_u32 s52, s42, 160
  s_mov_b32 s10, 2211840
  s_mov_b32 s53, 1280
  s_mov_b32 s54, 54
  s_mov_b32 s55, 8
  s_mov_b32 s56, 7700480
  s_mov_b32 s57, 536870913
  s_mov_b32 s58, 0
  s_branch L_apA_nb5
L_apA_seg2:
  s_cmp_lt_u32 s42, 1312
  s_cbranch_scc0 L_apA_seg3
  s_mov_b32 s8, s48
  s_and_b32 s9, s49, 0xffff
  s_sub_u32 s52, s42, 592
  s_mov_b32 s10, 2211840
  s_mov_b32 s53, 3456
  s_mov_b32 s54, 20
  s_mov_b32 s55, 36
  s_mov_b32 s56, 3276800
  s_mov_b32 s57, 119304648
  s_mov_b32 s58, 0
  s_branch L_apA_nb3
L_apA_seg3:
  s_mov_b32 s8, s50
  s_and_b32 s9, s51, 0xffff
  s_sub_u32 s52, s42, 1312
  s_mov_b32 s10, 2211840
  s_mov_b32 s53, 3456
  s_mov_b32 s54, 20
  s_mov_b32 s55, 36
  s_mov_b32 s56, 5488640
  s_mov_b32 s57, 119304648
  s_mov_b32 s58, 1
  s_branch L_apA_nb3
L_apA_seg4:
L_apA_nb5:
  s_mov_b32 s11, 0x00020000
  s_mov_b32 s63, 5
  s_mul_hi_u32 s59, s52, s57
  s_mul_i32 s60, s59, s55
  s_sub_u32 s60, s52, s60
  s_lshl_b32 s61, s59, 5
  s_mul_i32 s61, s61, s53
  s_mul_i32 s62, s60, 160
  s_add_u32 s61, s61, s62
  v_add_u32 v52, 0, v2
  v_mul_u32_u24 v53, 205, v52
  v_lshrrev_b32 v53, 11, v53
  v_mul_u32_u24 v54, 10, v53
  v_sub_u32 v54, v52, v54
  v_mul_lo_u32 v53, v53, s53
  v_lshl_add_u32 v53, v54, 4, v53
  s_add_u32 m0, s43, 0
  s_nop 0
  buffer_load_dwordx4 v53, s[8:11], s61 offen lds
  v_add_u32 v52, 64, v2
  v_mul_u32_u24 v53, 205, v52
  v_lshrrev_b32 v53, 11, v53
  v_mul_u32_u24 v54, 10, v53
  v_sub_u32 v54, v52, v54
  v_mul_lo_u32 v53, v53, s53
  v_lshl_add_u32 v53, v54, 4, v53
  s_add_u32 m0, s43, 1024
  s_nop 0
  buffer_load_dwordx4 v53, s[8:11], s61 offen lds
  v_add_u32 v52, 128, v2
  v_mul_u32_u24 v53, 205, v52
  v_lshrrev_b32 v53, 11, v53
  v_mul_u32_u24 v54, 10, v53
  v_sub_u32 v54, v52, v54
  v_mul_lo_u32 v53, v53, s53
  v_lshl_add_u32 v53, v54, 4, v53
  s_add_u32 m0, s43, 2048
  s_nop 0
  buffer_load_dwordx4 v53, s[8:11], s61 offen lds
  v_add_u32 v52, 192, v2
  v_mul_u32_u24 v53, 205, v52
  v_lshrrev_b32 v53, 11, v53
  v_mul_u32_u24 v54, 10, v53
  v_sub_u32 v54, v52, v54
  v_mul_lo_u32 v53, v53, s53
  v_lshl_add_u32 v53, v54, 4, v53
  s_add_u32 m0, s43, 3072
  s_nop 0
  buffer_load_dwordx4 v53, s[8:11], s61 offen lds
  v_add_u32 v52, 256, v2
  v_mul_u32_u24 v53, 205, v52
  v_lshrrev_b32 v53, 11, v53
  v_mul_u32_u24 v54, 10, v53
  v_sub_u32 v54, v52, v54
  v_mul_lo_u32 v53, v53, s53
  v_lshl_add_u32 v53, v54, 4, v53
  s_add_u32 m0, s43, 4096
  s_nop 0
  buffer_load_dwordx4 v53, s[8:11], s61 offen lds
  s_branch L_apA_p1done
L_apA_nb3:
  s_mov_b32 s11, 0x00020000
  s_mov_b32 s63, 3
  s_mul_hi_u32 s59, s52, s57
  s_mul_i32 s60, s59, s55
  s_sub_u32 s60, s52, s60
  s_lshl_b32 s61, s59, 5
  s_mul_i32 s61, s61, s53
  s_mul_i32 s62, s60, 96
  s_add_u32 s61, s61, s62
  v_add_u32 v52, 0, v2
  v_mul_u32_u24 v53, 171, v52
  v_lshrrev_b32 v53, 10, v53
  v_mul_u32_u24 v54, 6, v53
  v_sub_u32 v54, v52, v54
  v_mul_lo_u32 v53, v53, s53
  v_lshl_add_u32 v53, v54, 4, v53
  s_add_u32 m0, s43, 0
  s_nop 0
  buffer_load_dwordx4 v53, s[8:11], s61 offen lds
  v_add_u32 v52, 64, v2
  v_mul_u32_u24 v53, 171, v52
  v_lshrrev_b32 v53, 10, v53
  v_mul_u32_u24 v54, 6, v53
  v_sub_u32 v54, v52, v54
  v_mul_lo_u32 v53, v53, s53
  v_lshl_add_u32 v53, v54, 4, v53
  s_add_u32 m0, s43, 1024
  s_nop 0
  buffer_load_dwordx4 v53, s[8:11], s61 offen lds
  v_add_u32 v52, 128, v2
  v_mul_u32_u24 v53, 171, v52
  v_lshrrev_b32 v53, 10, v53
  v_mul_u32_u24 v54, 6, v53
  v_sub_u32 v54, v52, v54
  v_mul_lo_u32 v53, v53, s53
  v_lshl_add_u32 v53, v54, 4, v53
  s_add_u32 m0, s43, 2048
  s_nop 0
  buffer_load_dwordx4 v53, s[8:11], s61 offen lds
L_apA_p1done:
  s_waitcnt vmcnt(24)
  s_barrier
  s_cmp_eq_u32 s63, 0
  s_cbranch_scc1 L_apA_p2done
  s_waitcnt vmcnt(0)
  s_cmp_eq_u32 s63, 3
  s_cbranch_scc1 L_apA_q3
  v_lshrrev_b32 v52, 4, v2
  v_bfe_u32 v53, v2, 2, 2
  v_lshl_add_u32 v52, v52, 2, v53
  v_mul_u32_u24 v52, 160, v52
  v_and_b32 v53, 3, v2
  v_lshl_add_u32 v52, v53, 3, v52
  v_add_u32 v52, s43, v52
  s_mul_i32 s61, s60, 5
  s_mul_i32 s61, s61, s54
  s_add_u32 s61, s61, s59
  s_lshl_b32 s61, s61, 10
  s_add_u32 s61, s61, s56
  s_lshl_b32 s62, s54, 10
  ds_read_b64_tr_b16 v[56:57], v52 offset:0
  ds_read_b64_tr_b16 v[58:59], v52 offset:2560
  ds_read_b64_tr_b16 v[60:61], v52 offset:32
  ds_read_b64_tr_b16 v[62:63], v52 offset:2592
  ds_read_b64_tr_b16 v[64:65], v52 offset:64
  ds_read_b64_tr_b16 v[66:67], v52 offset:2624
  ds_read_b64_tr_b16 v[68:69], v52 offset:96
  ds_read_b64_tr_b16 v[70:71], v52 offset:2656
  ds_read_b64_tr_b16 v[72:73], v52 offset:128
  ds_read_b64_tr_b16 v[74:75], v52 offset:2688
  s_waitcnt lgkmcnt(0)
  buffer_store_dwordx4 v[56:59], v3, s[12:15], s61 offen sc0 sc1
  s_add_u32 s61, s61, s62
  buffer_store_dwordx4 v[60:63], v3, s[12:15], s61 offen sc0 sc1
  s_add_u32 s61, s61, s62
  buffer_store_dwordx4 v[64:67], v3, s[12:15], s61 offen sc0 sc1
  s_add_u32 s61, s61, s62
  buffer_store_dwordx4 v[68:71], v3, s[12:15], s61 offen sc0 sc1
  s_add_u32 s61, s61, s62
  buffer_store_dwordx4 v[72:75], v3, s[12:15], s61 offen sc0 sc1
  s_add_u32 s61, s61, s62
  s_branch L_apA_p2done
L_apA_q3:
  v_lshrrev_b32 v52, 4, v2
  v_bfe_u32 v53, v2, 2, 2
  v_lshl_add_u32 v52, v52, 2, v53
  v_mul_u32_u24 v52, 96, v52
  v_and_b32 v53, 3, v2
  v_lshl_add_u32 v52, v53, 3, v52
  v_add_u32 v52, s43, v52
  s_mul_i32 s61, s60, 3
  s_mul_i32 s61, s61, s54
  s_add_u32 s61, s61, s59
  s_lshl_b32 s61, s61, 10
  s_add_u32 s61, s61, s56
  s_lshl_b32 s62, s54, 10
  ds_read_b64_tr_b16 v[56:57], v52 offset:0
  ds_read_b64_tr_b16 v[58:59], v52 offset:1536
  ds_read_b64_tr_b16 v[60:61], v52 offset:32
  ds_read_b64_tr_b16 v[62:63], v52 offset:1568
  ds_read_b64_tr_b16 v[64:65], v52 offset:64
  ds_read_b64_tr_b16 v[66:67], v52 offset:1600
  s_waitcnt lgkmcnt(0)
  buffer_store_dwordx4 v[56:59], v3, s[12:15], s61 offen sc0 sc1
  s_add_u32 s61, s61, s62
  buffer_store_dwordx4 v[60:63], v3, s[12:15], s61 offen sc0 sc1
  s_add_u32 s61, s61, s62
  buffer_store_dwordx4 v[64:67], v3, s[12:15], s61 offen sc0 sc1
  s_add_u32 s61, s61, s62
  v_mov_b32 v76, 1065369472
  v_mov_b32 v77, 1065369472
  v_mov_b32 v78, 1065369472
  v_mov_b32 v79, 1065369472
  s_lshl_b32 s61, s59, 1
  s_add_u32 s61, s61, s58
  s_mul_i32 s61, s61, 1728
  s_mul_i32 s62, s60, 48
  s_add_u32 s61, s61, s62
  s_lshl_b32 s61, s61, 2
  s_add_u32 s61, s61, 9912320
  v_lshrrev_b32 v53, 4, v2
  v_lshlrev_b32 v53, 4, v53
  v_and_b32 v54, 15, v2
  v_cmp_eq_u32 vcc, 0, v54
  v_mfma_f32_16x16x32_bf16 v[80:83], v[56:59], v[76:79], 0
  v_mfma_f32_16x16x32_bf16 v[84:87], v[60:63], v[76:79], 0
  v_mfma_f32_16x16x32_bf16 v[88:91], v[64:67], v[76:79], 0
  s_nop 7
  s_and_saveexec_b64 s[52:53], vcc
  buffer_store_dwordx4 v[80:83], v53, s[12:15], s61 offen offset:0
  buffer_store_dwordx4 v[84:87], v53, s[12:15], s61 offen offset:64
  buffer_store_dwordx4 v[88:91], v53, s[12:15], s61 offen offset:128
  s_mov_b64 exec, s[52:53]
L_apA_p2done:
  s_add_u32 s42, s42, 1
  s_waitcnt vmcnt(0)
  s_mov_b32 s63, 0
  s_cmp_ge_u32 s42, 2032
  s_cbranch_scc1 L_apB_p1done
  s_cmp_lt_u32 s42, 160
  s_cbranch_scc0 L_apB_seg1
  s_mov_b32 s8, s44
  s_and_b32 s9, s45, 0xffff
  s_sub_u32 s52, s42, 0
  s_mov_b32 s10, 819200
  s_mov_b32 s53, 1280
  s_mov_b32 s54, 20
  s_mov_b32 s55, 8
  s_mov_b32 s56, 2457600
  s_mov_b32 s57, 536870913
  s_mov_b32 s58, 0
  s_branch L_apB_nb5
L_apB_seg1:
  s_cmp_lt_u32 s42, 592
  s_cbranch_scc0 L_apB_seg2
  s_mov_b32 s8, s46
  s_and_b32 s9, s47, 0xffff
  s_sub_u32 s52, s42, 160
  s_mov_b32 s10, 2211840
  s_mov_b32 s53, 1280
  s_mov_b32 s54, 54
  s_mov_b32 s55, 8
  s_mov_b32 s56, 7700480
  s_mov_b32 s57, 536870913
  s_mov_b32 s58, 0
  s_branch L_apB_nb5
L_apB_seg2:
  s_cmp_lt_u32 s42, 1312
  s_cbranch_scc0 L_apB_seg3
  s_mov_b32 s8, s48
  s_and_b32 s9, s49, 0xffff
  s_sub_u32 s52, s42, 592
  s_mov_b32 s10, 2211840
  s_mov_b32 s53, 3456
  s_mov_b32 s54, 20
  s_mov_b32 s55, 36
  s_mov_b32 s56, 3276800
  s_mov_b32 s57, 119304648
  s_mov_b32 s58, 0
  s_branch L_apB_nb3
L_apB_seg3:
  s_mov_b32 s8, s50
  s_and_b32 s9, s51, 0xffff
  s_sub_u32 s52, s42, 1312
  s_mov_b32 s10, 2211840
  s_mov_b32 s53, 3456
  s_mov_b32 s54, 20
  s_mov_b32 s55, 36
  s_mov_b32 s56, 5488640
  s_mov_b32 s57, 119304648
  s_mov_b32 s58, 1
  s_branch L_apB_nb3
L_apB_seg4:
L_apB_nb5:
  s_mov_b32 s11, 0x00020000
  s_mov_b32 s63, 5
  s_mul_hi_u32 s59, s52, s57
  s_mul_i32 s60, s59, s55
  s_sub_u32 s60, s52, s60
  s_lshl_b32 s61, s59, 5
  s_mul_i32 s61, s61, s53
  s_mul_i32 s62, s60, 160
  s_add_u32 s61, s61, s62
  v_add_u32 v52, 0, v2
  v_mul_u32_u24 v53, 205, v52
  v_lshrrev_b32 v53, 11, v53
  v_mul_u32_u24 v54, 10, v53
  v_sub_u32 v54, v52, v54
  v_mul_lo_u32 v53, v53, s53
  v_lshl_add_u32 v53, v54, 4, v53
  s_add_u32 m0, s43, 0
  s_nop 0
  buffer_load_dwordx4 v53, s[8:11], s61 offen lds
  v_add_u32 v52, 64, v2
  v_mul_u32_u24 v53, 205, v52
  v_lshrrev_b32 v53, 11, v53
  v_mul_u32_u24 v54, 10, v53
  v_sub_u32 v54, v52, v54
  v_mul_lo_u32 v53, v53, s53
  v_lshl_add_u32 v53, v54, 4, v53
  s_add_u32 m0, s43, 1024
  s_nop 0
  buffer_load_dwordx4 v53, s[8:11], s61 offen lds
  v_add_u32 v52, 128, v2
  v_mul_u32_u24 v53, 205, v52
  v_lshrrev_b32 v53, 11, v53
  v_mul_u32_u24 v54, 10, v53
  v_sub_u32 v54, v52, v54
  v_mul_lo_u32 v53, v53, s53
  v_lshl_add_u32 v53, v54, 4, v53
  s_add_u32 m0, s43, 2048
  s_nop 0
  buffer_load_dwordx4 v53, s[8:11], s61 offen lds
  v_add_u32 v52, 192, v2
  v_mul_u32_u24 v53, 205, v52
  v_lshrrev_b32 v53, 11, v53
  v_mul_u32_u24 v54, 10, v53
  v_sub_u32 v54, v52, v54
  v_mul_lo_u32 v53, v53, s53
  v_lshl_add_u32 v53, v54, 4, v53
  s_add_u32 m0, s43, 3072
  s_nop 0
  buffer_load_dwordx4 v53, s[8:11], s61 offen lds
  v_add_u32 v52, 256, v2
  v_mul_u32_u24 v53, 205, v52
  v_lshrrev_b32 v53, 11, v53
  v_mul_u32_u24 v54, 10, v53
  v_sub_u32 v54, v52, v54
  v_mul_lo_u32 v53, v53, s53
  v_lshl_add_u32 v53, v54, 4, v53
  s_add_u32 m0, s43, 4096
  s_nop 0
  buffer_load_dwordx4 v53, s[8:11], s61 offen lds
  s_branch L_apB_p1done
L_apB_nb3:
  s_mov_b32 s11, 0x00020000
  s_mov_b32 s63, 3
  s_mul_hi_u32 s59, s52, s57
  s_mul_i32 s60, s59, s55
  s_sub_u32 s60, s52, s60
  s_lshl_b32 s61, s59, 5
  s_mul_i32 s61, s61, s53
  s_mul_i32 s62, s60, 96
  s_add_u32 s61, s61, s62
  v_add_u32 v52, 0, v2
  v_mul_u32_u24 v53, 171, v52
  v_lshrrev_b32 v53, 10, v53
  v_mul_u32_u24 v54, 6, v53
  v_sub_u32 v54, v52, v54
  v_mul_lo_u32 v53, v53, s53
  v_lshl_add_u32 v53, v54, 4, v53
  s_add_u32 m0, s43, 0
  s_nop 0
  buffer_load_dwordx4 v53, s[8:11], s61 offen lds
  v_add_u32 v52, 64, v2
  v_mul_u32_u24 v53, 171, v52
  v_lshrrev_b32 v53, 10, v53
  v_mul_u32_u24 v54, 6, v53
  v_sub_u32 v54, v52, v54
  v_mul_lo_u32 v53, v53, s53
  v_lshl_add_u32 v53, v54, 4, v53
  s_add_u32 m0, s43, 1024
  s_nop 0
  buffer_load_dwordx4 v53, s[8:11], s61 offen lds
  v_add_u32 v52, 128, v2
  v_mul_u32_u24 v53, 171, v52
  v_lshrrev_b32 v53, 10, v53
  v_mul_u32_u24 v54, 6, v53
  v_sub_u32 v54, v52, v54
  v_mul_lo_u32 v53, v53, s53
  v_lshl_add_u32 v53, v54, 4, v53
  s_add_u32 m0, s43, 2048
  s_nop 0
  buffer_load_dwordx4 v53, s[8:11], s61 offen lds
L_apB_p1done:
  s_barrier
  s_add_u32 m0, s23, 0
  s_add_u32 s25, s24, 138240
  buffer_load_dwordx4 v3, s[12:15], s25 offen lds
  buffer_load_dwordx4 v3, s[12:15], s25 offen offset:1024 lds
  buffer_load_dwordx4 v3, s[12:15], s25 offen offset:2048 lds
  buffer_load_dwordx4 v3, s[12:15], s25 offen offset:3072 lds
  s_add_u32 m0, s23, 4096
  s_add_u32 s25, s24, 142336
  buffer_load_dwordx4 v3, s[12:15], s25 offen lds
  buffer_load_dwordx4 v3, s[12:15], s25 offen offset:1024 lds
  buffer_load_dwordx4 v3, s[12:15], s25 offen offset:2048 lds
  buffer_load_dwordx4 v3, s[12:15], s25 offen offset:3072 lds
  s_add_u32 m0, s23, 8192
  s_add_u32 s25, s24, 146432
  buffer_load_dwordx4 v3, s[12:15], s25 offen lds
  buffer_load_dwordx4 v3, s[12:15], s25 offen offset:1024 lds
  buffer_load_dwordx4 v3, s[12:15], s25 offen offset:2048 lds
  buffer_load_dwordx4 v3, s[12:15], s25 offen offset:3072 lds
  s_add_u32 m0, s23, 12288
  s_add_u32 s25, s24, 150528
  buffer_load_dwordx4 v3, s[12:15], s25 offen lds
  buffer_load_dwordx4 v3, s[12:15], s25 offen offset:1024 lds
  buffer_load_dwordx4 v3, s[12:15], s25 offen offset:2048 lds
  buffer_load_dwordx4 v3, s[12:15], s25 offen offset:3072 lds
  s_add_u32 m0, s23, 16384
  s_add_u32 s25, s24, 154624
  buffer_load_dwordx4 v3, s[12:15], s25 offen lds
  buffer_load_dwordx4 v3, s[12:15], s25 offen offset:1024 lds
  buffer_load_dwordx4 v3, s[12:15], s25 offen offset:2048 lds
  buffer_load_dwordx4 v3, s[12:15], s25 offen offset:3072 lds
  s_add_u32 m0, s23, 20480
  s_add_u32 s25, s24, 158720
  buffer_load_dwordx4 v3, s[12:15], s25 offen lds
  buffer_load_dwordx4 v3, s[12:15], s25 offen offset:1024 lds
  buffer_load_dwordx4 v3, s[12:15], s25 offen offset:2048 lds
  buffer_load_dwordx4 v3, s[12:15], s25 offen offset:3072 lds
  s_cmp_eq_u32 s63, 0
  s_cbranch_scc1 L_apB_p2done
  s_waitcnt vmcnt(24)
  s_cmp_eq_u32 s63, 3
  s_cbranch_scc1 L_apB_q3
  v_lshrrev_b32 v52, 4, v2
  v_bfe_u32 v53, v2, 2, 2
  v_lshl_add_u32 v52, v52, 2, v53
  v_mul_u32_u24 v52, 160, v52
  v_and_b32 v53, 3, v2
  v_lshl_add_u32 v52, v53, 3, v52
  v_add_u32 v52, s43, v52
  s_mul_i32 s61, s60, 5
  s_mul_i32 s61, s61, s54
  s_add_u32 s61, s61, s59
  s_lshl_b32 s61, s61, 10
  s_add_u32 s61, s61, s56
  s_lshl_b32 s62, s54, 10
  ds_read_b64_tr_b16 v[56:57], v52 offset:0
  ds_read_b64_tr_b16 v[58:59], v52 offset:2560
  ds_read_b64_tr_b16 v[60:61], v52 offset:32
  ds_read_b64_tr_b16 v[62:63], v52 offset:2592
  ds_read_b64_tr_b16 v[64:65], v52 offset:64
  ds_read_b64_tr_b16 v[66:67], v52 offset:2624
  ds_read_b64_tr_b16 v[68:69], v52 offset:96
  ds_read_b64_tr_b16 v[70:71], v52 offset:2656
  ds_read_b64_tr_b16 v[72:73], v52 offset:128
  ds_read_b64_tr_b16 v[74:75], v52 offset:2688
  s_waitcnt lgkmcnt(0)
  buffer_store_dwordx4 v[56:59], v3, s[12:15], s61 offen sc0 sc1
  s_add_u32 s61, s61, s62
  buffer_store_dwordx4 v[60:63], v3, s[12:15], s61 offen sc0 sc1
  s_add_u32 s61, s61, s62
  buffer_store_dwordx4 v[64:67], v3, s[12:15], s61 offen sc0 sc1
  s_add_u32 s61, s61, s62
  buffer_store_dwordx4 v[68:71], v3, s[12:15], s61 offen sc0 sc1
  s_add_u32 s61, s61, s62
  buffer_store_dwordx4 v[72:75], v3, s[12:15], s61 offen sc0 sc1
  s_add_u32 s61, s61, s62
  s_branch L_apB_p2done
L_apB_q3:
  v_lshrrev_b32 v52, 4, v2
  v_bfe_u32 v53, v2, 2, 2
  v_lshl_add_u32 v52, v52, 2, v53
  v_mul_u32_u24 v52, 96, v52
  v_and_b32 v53, 3, v2
  v_lshl_add_u32 v52, v53, 3, v52
  v_add_u32 v52, s43, v52
  s_mul_i32 s61, s60, 3
  s_mul_i32 s61, s61, s54
  s_add_u32 s61, s61, s59
  s_lshl_b32 s61, s61, 10
  s_add_u32 s61, s61, s56
  s_lshl_b32 s62, s54, 10
  ds_read_b64_tr_b16 v[56:57], v52 offset:0
  ds_read_b64_tr_b16 v[58:59], v52 offset:1536
  ds_read_b64_tr_b16 v[60:61], v52 offset:32
  ds_read_b64_tr_b16 v[62:63], v52 offset:1568
  ds_read_b64_tr_b16 v[64:65], v52 offset:64
  ds_read_b64_tr_b16 v[66:67], v52 offset:1600
  s_waitcnt lgkmcnt(0)
  buffer_store_dwordx4 v[56:59], v3, s[12:15], s61 offen sc0 sc1
  s_add_u32 s61, s61, s62
  buffer_store_dwordx4 v[60:63], v3, s[12:15], s61 offen sc0 sc1
  s_add_u32 s61, s61, s62
  buffer_store_dwordx4 v[64:67], v3, s[12:15], s61 offen sc0 sc1
  s_add_u32 s61, s61, s62
  v_mov_b32 v76, 1065369472
  v_mov_b32 v77, 1065369472
  v_mov_b32 v78, 1065369472
  v_mov_b32 v79, 1065369472
  s_lshl_b32 s61, s59, 1
  s_add_u32 s61, s61, s58
  s_mul_i32 s61, s61, 1728
  s_mul_i32 s62, s60, 48
  s_add_u32 s61, s61, s62
  s_lshl_b32 s61, s61, 2
  s_add_u32 s61, s61, 9912320
  v_lshrrev_b32 v53, 4, v2
  v_lshlrev_b32 v53, 4, v53
  v_and_b32 v54, 15, v2
  v_cmp_eq_u32 vcc, 0, v54
  v_mfma_f32_16x16x32_bf16 v[80:83], v[56:59], v[76:79], 0
  v_mfma_f32_16x16x32_bf16 v[84:87], v[60:63], v[76:79], 0
  v_mfma_f32_16x16x32_bf16 v[88:91], v[64:67], v[76:79], 0
  s_nop 7
  s_and_saveexec_b64 s[52:53], vcc
  buffer_store_dwordx4 v[80:83], v53, s[12:15], s61 offen offset:0
  buffer_store_dwordx4 v[84:87], v53, s[12:15], s61 offen offset:64
  buffer_store_dwordx4 v[88:91], v53, s[12:15], s61 offen offset:128
  s_mov_b64 exec, s[52:53]
L_apB_p2done:
  s_add_u32 s42, s42, 1
  s_mov_b32 s63, 0
  s_cmp_ge_u32 s42, 2032
  s_cbranch_scc1 L_apC_p1done
  s_cmp_lt_u32 s42, 160
  s_cbranch_scc0 L_apC_seg1
  s_mov_b32 s8, s44
  s_and_b32 s9, s45, 0xffff
  s_sub_u32 s52, s42, 0
  s_mov_b32 s10, 819200
  s_mov_b32 s53, 1280
  s_mov_b32 s54, 20
  s_mov_b32 s55, 8
  s_mov_b32 s56, 2457600
  s_mov_b32 s57, 536870913
  s_mov_b32 s58, 0
  s_branch L_apC_nb5
L_apC_seg1:
  s_cmp_lt_u32 s42, 592
  s_cbranch_scc0 L_apC_seg2
  s_mov_b32 s8, s46
  s_and_b32 s9, s47, 0xffff
  s_sub_u32 s52, s42, 160
  s_mov_b32 s10, 2211840
  s_mov_b32 s53, 1280
  s_mov_b32 s54, 54
  s_mov_b32 s55, 8
  s_mov_b32 s56, 7700480
  s_mov_b32 s57, 536870913
  s_mov_b32 s58, 0
  s_branch L_apC_nb5
L_apC_seg2:
  s_cmp_lt_u32 s42, 1312
  s_cbranch_scc0 L_apC_seg3
  s_mov_b32 s8, s48
  s_and_b32 s9, s49, 0xffff
  s_sub_u32 s52, s42, 592
  s_mov_b32 s10, 2211840
  s_mov_b32 s53, 3456
  s_mov_b32 s54, 20
  s_mov_b32 s55, 36
  s_mov_b32 s56, 3276800
  s_mov_b32 s57, 119304648
  s_mov_b32 s58, 0
  s_branch L_apC_nb3
L_apC_seg3:
  s_mov_b32 s8, s50
  s_and_b32 s9, s51, 0xffff
  s_sub_u32 s52, s42, 1312
  s_mov_b32 s10, 2211840
  s_mov_b32 s53, 3456
  s_mov_b32 s54, 20
  s_mov_b32 s55, 36
  s_mov_b32 s56, 5488640
  s_mov_b32 s57, 119304648
  s_mov_b32 s58, 1
  s_branch L_apC_nb3
L_apC_seg4:
L_apC_nb5:
  s_mov_b32 s11, 0x00020000
  s_mov_b32 s63, 5
  s_mul_hi_u32 s59, s52, s57
  s_mul_i32 s60, s59, s55
  s_sub_u32 s60, s52, s60
  s_lshl_b32 s61, s59, 5
  s_mul_i32 s61, s61, s53
  s_mul_i32 s62, s60, 160
  s_add_u32 s61, s61, s62
  v_add_u32 v52, 0, v2
  v_mul_u32_u24 v53, 205, v52
  v_lshrrev_b32 v53, 11, v53
  v_mul_u32_u24 v54, 10, v53
  v_sub_u32 v54, v52, v54
  v_mul_lo_u32 v53, v53, s53
  v_lshl_add_u32 v53, v54, 4, v53
  s_add_u32 m0, s43, 0
  s_nop 0
  buffer_load_dwordx4 v53, s[8:11], s61 offen lds
  v_add_u32 v52, 64, v2
  v_mul_u32_u24 v53, 205, v52
  v_lshrrev_b32 v53, 11, v53
  v_mul_u32_u24 v54, 10, v53
  v_sub_u32 v54, v52, v54
  v_mul_lo_u32 v53, v53, s53
  v_lshl_add_u32 v53, v54, 4, v53
  s_add_u32 m0, s43, 1024
  s_nop 0
  buffer_load_dwordx4 v53, s[8:11], s61 offen lds
  v_add_u32 v52, 128, v2
  v_mul_u32_u24 v53, 205, v52
  v_lshrrev_b32 v53, 11, v53
  v_mul_u32_u24 v54, 10, v53
  v_sub_u32 v54, v52, v54
  v_mul_lo_u32 v53, v53, s53
  v_lshl_add_u32 v53, v54, 4, v53
  s_add_u32 m0, s43, 2048
  s_nop 0
  buffer_load_dwordx4 v53, s[8:11], s61 offen lds
  v_add_u32 v52, 192, v2
  v_mul_u32_u24 v53, 205, v52
  v_lshrrev_b32 v53, 11, v53
  v_mul_u32_u24 v54, 10, v53
  v_sub_u32 v54, v52, v54
  v_mul_lo_u32 v53, v53, s53
  v_lshl_add_u32 v53, v54, 4, v53
  s_add_u32 m0, s43, 3072
  s_nop 0
  buffer_load_dwordx4 v53, s[8:11], s61 offen lds
  v_add_u32 v52, 256, v2
  v_mul_u32_u24 v53, 205, v52
  v_lshrrev_b32 v53, 11, v53
  v_mul_u32_u24 v54, 10, v53
  v_sub_u32 v54, v52, v54
  v_mul_lo_u32 v53, v53, s53
  v_lshl_add_u32 v53, v54, 4, v53
  s_add_u32 m0, s43, 4096
  s_nop 0
  buffer_load_dwordx4 v53, s[8:11], s61 offen lds
  s_branch L_apC_p1done
L_apC_nb3:
  s_mov_b32 s11, 0x00020000
  s_mov_b32 s63, 3
  s_mul_hi_u32 s59, s52, s57
  s_mul_i32 s60, s59, s55
  s_sub_u32 s60, s52, s60
  s_lshl_b32 s61, s59, 5
  s_mul_i32 s61, s61, s53
  s_mul_i32 s62, s60, 96
  s_add_u32 s61, s61, s62
  v_add_u32 v52, 0, v2
  v_mul_u32_u24 v53, 171, v52
  v_lshrrev_b32 v53, 10, v53
  v_mul_u32_u24 v54, 6, v53
  v_sub_u32 v54, v52, v54
  v_mul_lo_u32 v53, v53, s53
  v_lshl_add_u32 v53, v54, 4, v53
  s_add_u32 m0, s43, 0
  s_nop 0
  buffer_load_dwordx4 v53, s[8:11], s61 offen lds
  v_add_u32 v52, 64, v2
  v_mul_u32_u24 v53, 171, v52
  v_lshrrev_b32 v53, 10, v53
  v_mul_u32_u24 v54, 6, v53
  v_sub_u32 v54, v52, v54
  v_mul_lo_u32 v53, v53, s53
  v_lshl_add_u32 v53, v54, 4, v53
  s_add_u32 m0, s43, 1024
  s_nop 0
  buffer_load_dwordx4 v53, s[8:11], s61 offen lds
  v_add_u32 v52, 128, v2
  v_mul_u32_u24 v53, 171, v52
  v_lshrrev_b32 v53, 10, v53
  v_mul_u32_u24 v54, 6, v53
  v_sub_u32 v54, v52, v54
  v_mul_lo_u32 v53, v53, s53
  v_lshl_add_u32 v53, v54, 4, v53
  s_add_u32 m0, s43, 2048
  s_nop 0
  buffer_load_dwordx4 v53, s[8:11], s61 offen lds
L_apC_p1done:
  s_waitcnt vmcnt(5)
  s_cmp_eq_u32 s63, 5
  s_cbranch_scc1 L_attn_hw
  s_waitcnt vmcnt(3)
  s_cmp_eq_u32 s63, 3
  s_cbranch_scc1 L_attn_hw
  s_waitcnt vmcnt(0)
L_attn_hw:
  s_barrier
  s_cmp_eq_u32 s63, 0
  s_cbranch_scc1 L_apC_p2done
  s_waitcnt vmcnt(0)
  s_cmp_eq_u32 s63, 3
  s_cbranch_scc1 L_apC_q3
  v_lshrrev_b32 v52, 4, v2
  v_bfe_u32 v53, v2, 2, 2
  v_lshl_add_u32 v52, v52, 2, v53
  v_mul_u32_u24 v52, 160, v52
  v_and_b32 v53, 3, v2
  v_lshl_add_u32 v52, v53, 3, v52
  v_add_u32 v52, s43, v52
  s_mul_i32 s61, s60, 5
  s_mul_i32 s61, s61, s54
  s_add_u32 s61, s61, s59
  s_lshl_b32 s61, s61, 10
  s_add_u32 s61, s61, s56
  s_lshl_b32 s62, s54, 10
  ds_read_b64_tr_b16 v[56:57], v52 offset:0
  ds_read_b64_tr_b16 v[58:59], v52 offset:2560
  ds_read_b64_tr_b16 v[60:61], v52 offset:32
  ds_read_b64_tr_b16 v[62:63], v52 offset:2592
  ds_read_b64_tr_b16 v[64:65], v52 offset:64
  ds_read_b64_tr_b16 v[66:67], v52 offset:2624
  ds_read_b64_tr_b16 v[68:69], v52 offset:96
  ds_read_b64_tr_b16 v[70:71], v52 offset:2656
  ds_read_b64_tr_b16 v[72:73], v52 offset:128
  ds_read_b64_tr_b16 v[74:75], v52 offset:2688
  s_waitcnt lgkmcnt(0)
  buffer_store_dwordx4 v[56:59], v3, s[12:15], s61 offen sc0 sc1
  s_add_u32 s61, s61, s62
  buffer_store_dwordx4 v[60:63], v3, s[12:15], s61 offen sc0 sc1
  s_add_u32 s61, s61, s62
  buffer_store_dwordx4 v[64:67], v3, s[12:15], s61 offen sc0 sc1
  s_add_u32 s61, s61, s62
  buffer_store_dwordx4 v[68:71], v3, s[12:15], s61 offen sc0 sc1
  s_add_u32 s61, s61, s62
  buffer_store_dwordx4 v[72:75], v3, s[12:15], s61 offen sc0 sc1
  s_add_u32 s61, s61, s62
  s_branch L_apC_p2done
L_apC_q3:
  v_lshrrev_b32 v52, 4, v2
  v_bfe_u32 v53, v2, 2, 2
  v_lshl_add_u32 v52, v52, 2, v53
  v_mul_u32_u24 v52, 96, v52
  v_and_b32 v53, 3, v2
  v_lshl_add_u32 v52, v53, 3, v52
  v_add_u32 v52, s43, v52
  s_mul_i32 s61, s60, 3
  s_mul_i32 s61, s61, s54
  s_add_u32 s61, s61, s59
  s_lshl_b32 s61, s61, 10
  s_add_u32 s61, s61, s56
  s_lshl_b32 s62, s54, 10
  ds_read_b64_tr_b16 v[56:57], v52 offset:0
  ds_read_b64_tr_b16 v[58:59], v52 offset:1536
  ds_read_b64_tr_b16 v[60:61], v52 offset:32
  ds_read_b64_tr_b16 v[62:63], v52 offset:1568
  ds_read_b64_tr_b16 v[64:65], v52 offset:64
  ds_read_b64_tr_b16 v[66:67], v52 offset:1600
  s_waitcnt lgkmcnt(0)
  buffer_store_dwordx4 v[56:59], v3, s[12:15], s61 offen sc0 sc1
  s_add_u32 s61, s61, s62
  buffer_store_dwordx4 v[60:63], v3, s[12:15], s61 offen sc0 sc1
  s_add_u32 s61, s61, s62
  buffer_store_dwordx4 v[64:67], v3, s[12:15], s61 offen sc0 sc1
  s_add_u32 s61, s61, s62
  v_mov_b32 v76, 1065369472
  v_mov_b32 v77, 1065369472
  v_mov_b32 v78, 1065369472
  v_mov_b32 v79, 1065369472
  s_lshl_b32 s61, s59, 1
  s_add_u32 s61, s61, s58
  s_mul_i32 s61, s61, 1728
  s_mul_i32 s62, s60, 48
  s_add_u32 s61, s61, s62
  s_lshl_b32 s61, s61, 2
  s_add_u32 s61, s61, 9912320
  v_lshrrev_b32 v53, 4, v2
  v_lshlrev_b32 v53, 4, v53
  v_and_b32 v54, 15, v2
  v_cmp_eq_u32 vcc, 0, v54
  v_mfma_f32_16x16x32_bf16 v[80:83], v[56:59], v[76:79], 0
  v_mfma_f32_16x16x32_bf16 v[84:87], v[60:63], v[76:79], 0
  v_mfma_f32_16x16x32_bf16 v[88:91], v[64:67], v[76:79], 0
  s_nop 7
  s_and_saveexec_b64 s[52:53], vcc
  buffer_store_dwordx4 v[80:83], v53, s[12:15], s61 offen offset:0
  buffer_store_dwordx4 v[84:87], v53, s[12:15], s61 offen offset:64
  buffer_store_dwordx4 v[88:91], v53, s[12:15], s61 offen offset:128
  s_mov_b64 exec, s[52:53]
L_apC_p2done:
  s_add_u32 s42, s42, 1
  s_mov_b32 s63, 0
  s_cmp_ge_u32 s42, 2032
  s_cbranch_scc1 L_apD_p1done
  s_cmp_lt_u32 s42, 160
  s_cbranch_scc0 L_apD_seg1
  s_mov_b32 s8, s44
  s_and_b32 s9, s45, 0xffff
  s_sub_u32 s52, s42, 0
  s_mov_b32 s10, 819200
  s_mov_b32 s53, 1280
  s_mov_b32 s54, 20
  s_mov_b32 s55, 8
  s_mov_b32 s56, 2457600
  s_mov_b32 s57, 536870913
  s_mov_b32 s58, 0
  s_branch L_apD_nb5
L_apD_seg1:
  s_cmp_lt_u32 s42, 592
  s_cbranch_scc0 L_apD_seg2
  s_mov_b32 s8, s46
  s_and_b32 s9, s47, 0xffff
  s_sub_u32 s52, s42, 160
  s_mov_b32 s10, 2211840
  s_mov_b32 s53, 1280
  s_mov_b32 s54, 54
  s_mov_b32 s55, 8
  s_mov_b32 s56, 7700480
  s_mov_b32 s57, 536870913
  s_mov_b32 s58, 0
  s_branch L_apD_nb5
L_apD_seg2:
  s_cmp_lt_u32 s42, 1312
  s_cbranch_scc0 L_apD_seg3
  s_mov_b32 s8, s48
  s_and_b32 s9, s49, 0xffff
  s_sub_u32 s52, s42, 592
  s_mov_b32 s10, 2211840
  s_mov_b32 s53, 3456
  s_mov_b32 s54, 20
  s_mov_b32 s55, 36
  s_mov_b32 s56, 3276800
  s_mov_b32 s57, 119304648
  s_mov_b32 s58, 0
  s_branch L_apD_nb3
L_apD_seg3:
  s_mov_b32 s8, s50
  s_and_b32 s9, s51, 0xffff
  s_sub_u32 s52, s42, 1312
  s_mov_b32 s10, 2211840
  s_mov_b32 s53, 3456
  s_mov_b32 s54, 20
  s_mov_b32 s55, 36
  s_mov_b32 s56, 5488640
  s_mov_b32 s57, 119304648
  s_mov_b32 s58, 1
  s_branch L_apD_nb3
L_apD_seg4:
L_apD_nb5:
  s_mov_b32 s11, 0x00020000
  s_mov_b32 s63, 5
  s_mul_hi_u32 s59, s52, s57
  s_mul_i32 s60, s59, s55
  s_sub_u32 s60, s52, s60
  s_lshl_b32 s61, s59, 5
  s_mul_i32 s61, s61, s53
  s_mul_i32 s62, s60, 160
  s_add_u32 s61, s61, s62
  v_add_u32 v52, 0, v2
  v_mul_u32_u24 v53, 205, v52
  v_lshrrev_b32 v53, 11, v53
  v_mul_u32_u24 v54, 10, v53
  v_sub_u32 v54, v52, v54
  v_mul_lo_u32 v53, v53, s53
  v_lshl_add_u32 v53, v54, 4, v53
  s_add_u32 m0, s43, 0
  s_nop 0
  buffer_load_dwordx4 v53, s[8:11], s61 offen lds
  v_add_u32 v52, 64, v2
  v_mul_u32_u24 v53, 205, v52
  v_lshrrev_b32 v53, 11, v53
  v_mul_u32_u24 v54, 10, v53
  v_sub_u32 v54, v52, v54
  v_mul_lo_u32 v53, v53, s53
  v_lshl_add_u32 v53, v54, 4, v53
  s_add_u32 m0, s43, 1024
  s_nop 0
  buffer_load_dwordx4 v53, s[8:11], s61 offen lds
  v_add_u32 v52, 128, v2
  v_mul_u32_u24 v53, 205, v52
  v_lshrrev_b32 v53, 11, v53
  v_mul_u32_u24 v54, 10, v53
  v_sub_u32 v54, v52, v54
  v_mul_lo_u32 v53, v53, s53
  v_lshl_add_u32 v53, v54, 4, v53
  s_add_u32 m0, s43, 2048
  s_nop 0
  buffer_load_dwordx4 v53, s[8:11], s61 offen lds
  v_add_u32 v52, 192, v2
  v_mul_u32_u24 v53, 205, v52
  v_lshrrev_b32 v53, 11, v53
  v_mul_u32_u24 v54, 10, v53
  v_sub_u32 v54, v52, v54
  v_mul_lo_u32 v53, v53, s53
  v_lshl_add_u32 v53, v54, 4, v53
  s_add_u32 m0, s43, 3072
  s_nop 0
  buffer_load_dwordx4 v53, s[8:11], s61 offen lds
  v_add_u32 v52, 256, v2
  v_mul_u32_u24 v53, 205, v52
  v_lshrrev_b32 v53, 11, v53
  v_mul_u32_u24 v54, 10, v53
  v_sub_u32 v54, v52, v54
  v_mul_lo_u32 v53, v53, s53
  v_lshl_add_u32 v53, v54, 4, v53
  s_add_u32 m0, s43, 4096
  s_nop 0
  buffer_load_dwordx4 v53, s[8:11], s61 offen lds
  s_branch L_apD_p1done
L_apD_nb3:
  s_mov_b32 s11, 0x00020000
  s_mov_b32 s63, 3
  s_mul_hi_u32 s59, s52, s57
  s_mul_i32 s60, s59, s55
  s_sub_u32 s60, s52, s60
  s_lshl_b32 s61, s59, 5
  s_mul_i32 s61, s61, s53
  s_mul_i32 s62, s60, 96
  s_add_u32 s61, s61, s62
  v_add_u32 v52, 0, v2
  v_mul_u32_u24 v53, 171, v52
  v_lshrrev_b32 v53, 10, v53
  v_mul_u32_u24 v54, 6, v53
  v_sub_u32 v54, v52, v54
  v_mul_lo_u32 v53, v53, s53
  v_lshl_add_u32 v53, v54, 4, v53
  s_add_u32 m0, s43, 0
  s_nop 0
  buffer_load_dwordx4 v53, s[8:11], s61 offen lds
  v_add_u32 v52, 64, v2
  v_mul_u32_u24 v53, 171, v52
  v_lshrrev_b32 v53, 10, v53
  v_mul_u32_u24 v54, 6, v53
  v_sub_u32 v54, v52, v54
  v_mul_lo_u32 v53, v53, s53
  v_lshl_add_u32 v53, v54, 4, v53
  s_add_u32 m0, s43, 1024
  s_nop 0
  buffer_load_dwordx4 v53, s[8:11], s61 offen lds
  v_add_u32 v52, 128, v2
  v_mul_u32_u24 v53, 171, v52
  v_lshrrev_b32 v53, 10, v53
  v_mul_u32_u24 v54, 6, v53
  v_sub_u32 v54, v52, v54
  v_mul_lo_u32 v53, v53, s53
  v_lshl_add_u32 v53, v54, 4, v53
  s_add_u32 m0, s43, 2048
  s_nop 0
  buffer_load_dwordx4 v53, s[8:11], s61 offen lds
L_apD_p1done:
  s_cmp_eq_u32 s63, 0
  s_cbranch_scc1 L_apD_p2done
  s_waitcnt vmcnt(0)
  s_cmp_eq_u32 s63, 3
  s_cbranch_scc1 L_apD_q3
  v_lshrrev_b32 v52, 4, v2
  v_bfe_u32 v53, v2, 2, 2
  v_lshl_add_u32 v52, v52, 2, v53
  v_mul_u32_u24 v52, 160, v52
  v_and_b32 v53, 3, v2
  v_lshl_add_u32 v52, v53, 3, v52
  v_add_u32 v52, s43, v52
  s_mul_i32 s61, s60, 5
  s_mul_i32 s61, s61, s54
  s_add_u32 s61, s61, s59
  s_lshl_b32 s61, s61, 10
  s_add_u32 s61, s61, s56
  s_lshl_b32 s62, s54, 10
  ds_read_b64_tr_b16 v[56:57], v52 offset:0
  ds_read_b64_tr_b16 v[58:59], v52 offset:2560
  ds_read_b64_tr_b16 v[60:61], v52 offset:32
  ds_read_b64_tr_b16 v[62:63], v52 offset:2592
  ds_read_b64_tr_b16 v[64:65], v52 offset:64
  ds_read_b64_tr_b16 v[66:67], v52 offset:2624
  ds_read_b64_tr_b16 v[68:69], v52 offset:96
  ds_read_b64_tr_b16 v[70:71], v52 offset:2656
  ds_read_b64_tr_b16 v[72:73], v52 offset:128
  ds_read_b64_tr_b16 v[74:75], v52 offset:2688
  s_waitcnt lgkmcnt(0)
  buffer_store_dwordx4 v[56:59], v3, s[12:15], s61 offen sc0 sc1
  s_add_u32 s61, s61, s62
  buffer_store_dwordx4 v[60:63], v3, s[12:15], s61 offen sc0 sc1
  s_add_u32 s61, s61, s62
  buffer_store_dwordx4 v[64:67], v3, s[12:15], s61 offen sc0 sc1
  s_add_u32 s61, s61, s62
  buffer_store_dwordx4 v[68:71], v3, s[12:15], s61 offen sc0 sc1
  s_add_u32 s61, s61, s62
  buffer_store_dwordx4 v[72:75], v3, s[12:15], s61 offen sc0 sc1
  s_add_u32 s61, s61, s62
  s_branch L_apD_p2done
L_apD_q3:
  v_lshrrev_b32 v52, 4, v2
  v_bfe_u32 v53, v2, 2, 2
  v_lshl_add_u32 v52, v52, 2, v53
  v_mul_u32_u24 v52, 96, v52
  v_and_b32 v53, 3, v2
  v_lshl_add_u32 v52, v53, 3, v52
  v_add_u32 v52, s43, v52
  s_mul_i32 s61, s60, 3
  s_mul_i32 s61, s61, s54
  s_add_u32 s61, s61, s59
  s_lshl_b32 s61, s61, 10
  s_add_u32 s61, s61, s56
  s_lshl_b32 s62, s54, 10
  ds_read_b64_tr_b16 v[56:57], v52 offset:0
  ds_read_b64_tr_b16 v[58:59], v52 offset:1536
  ds_read_b64_tr_b16 v[60:61], v52 offset:32
  ds_read_b64_tr_b16 v[62:63], v52 offset:1568
  ds_read_b64_tr_b16 v[64:65], v52 offset:64
  ds_read_b64_tr_b16 v[66:67], v52 offset:1600
  s_waitcnt lgkmcnt(0)
  buffer_store_dwordx4 v[56:59], v3, s[12:15], s61 offen sc0 sc1
  s_add_u32 s61, s61, s62
  buffer_store_dwordx4 v[60:63], v3, s[12:15], s61 offen sc0 sc1
  s_add_u32 s61, s61, s62
  buffer_store_dwordx4 v[64:67], v3, s[12:15], s61 offen sc0 sc1
  s_add_u32 s61, s61, s62
  v_mov_b32 v76, 1065369472
  v_mov_b32 v77, 1065369472
  v_mov_b32 v78, 1065369472
  v_mov_b32 v79, 1065369472
  s_lshl_b32 s61, s59, 1
  s_add_u32 s61, s61, s58
  s_mul_i32 s61, s61, 1728
  s_mul_i32 s62, s60, 48
  s_add_u32 s61, s61, s62
  s_lshl_b32 s61, s61, 2
  s_add_u32 s61, s61, 9912320
  v_lshrrev_b32 v53, 4, v2
  v_lshlrev_b32 v53, 4, v53
  v_and_b32 v54, 15, v2
  v_cmp_eq_u32 vcc, 0, v54
  v_mfma_f32_16x16x32_bf16 v[80:83], v[56:59], v[76:79], 0
  v_mfma_f32_16x16x32_bf16 v[84:87], v[60:63], v[76:79], 0
  v_mfma_f32_16x16x32_bf16 v[88:91], v[64:67], v[76:79], 0
  s_nop 7
  s_and_saveexec_b64 s[52:53], vcc
  buffer_store_dwordx4 v[80:83], v53, s[12:15], s61 offen offset:0
  buffer_store_dwordx4 v[84:87], v53, s[12:15], s61 offen offset:64
  buffer_store_dwordx4 v[88:91], v53, s[12:15], s61 offen offset:128
  s_mov_b64 exec, s[52:53]
L_apD_p2done:
  s_lshr_b32 s58, s2, 3
  s_cmp_lg_u32 s58, 0
  s_cbranch_scc1 L_attn_kernel_cpf_1
  s_getpc_b64 s[58:59]
L_attn_kernel_pc_2:
  s_add_u32 s58, s58, oproj_kernel-L_attn_kernel_pc_2
  s_addc_u32 s59, s59, 0
  global_load_dwordx4 v[100:103], v3, s[58:59] offset:0
  global_load_dwordx4 v[104:107], v3, s[58:59] offset:1024
  global_load_dwordx4 v[108:111], v3, s[58:59] offset:2048
  global_load_dwordx4 v[112:115], v3, s[58:59] offset:3072
  s_add_u32 s58, s58, 4096
  s_addc_u32 s59, s59, 0
  global_load_dwordx4 v[116:119], v3, s[58:59] offset:0
  global_load_dwordx4 v[120:123], v3, s[58:59] offset:1024
  global_load_dwordx4 v[124:127], v3, s[58:59] offset:2048
  global_load_dwordx4 v[128:131], v3, s[58:59] offset:3072
  s_add_u32 s58, s58, 4096
  s_addc_u32 s59, s59, 0
  global_load_dwordx4 v[100:103], v3, s[58:59] offset:0
  global_load_dwordx4 v[104:107], v3, s[58:59] offset:1024
  global_load_dwordx4 v[108:111], v3, s[58:59] offset:2048
  global_load_dwordx4 v[112:115], v3, s[58:59] offset:3072
  s_add_u32 s58, s58, 4096
  s_addc_u32 s59, s59, 0
  global_load_dwordx4 v[116:119], v3, s[58:59] offset:0
  global_load_dwordx4 v[120:123], v3, s[58:59] offset:1024
  global_load_dwordx4 v[124:127], v3, s[58:59] offset:2048
  global_load_dwordx4 v[128:131], v3, s[58:59] offset:3072
  s_add_u32 s58, s58, 4096
  s_addc_u32 s59, s59, 0
  global_load_dwordx4 v[100:103], v3, s[58:59] offset:0
  global_load_dwordx4 v[104:107], v3, s[58:59] offset:1024
  global_load_dwordx4 v[108:111], v3, s[58:59] offset:2048
  global_load_dwordx4 v[112:115], v3, s[58:59] offset:3072
  s_add_u32 s58, s58, 4096
  s_addc_u32 s59, s59, 0
  global_load_dwordx4 v[116:119], v3, s[58:59] offset:0
  global_load_dwordx4 v[120:123], v3, s[58:59] offset:1024
  global_load_dwordx4 v[124:127], v3, s[58:59] offset:2048
  global_load_dwordx4 v[128:131], v3, s[58:59] offset:3072
  s_add_u32 s58, s58, 4096
  s_addc_u32 s59, s59, 0
  global_load_dwordx4 v[100:103], v3, s[58:59] offset:0
  global_load_dwordx4 v[104:107], v3, s[58:59] offset:1024
L_attn_kernel_cpf_1:
  s_endpgm
L_attn_prep_else:
  s_and_b32 s20, s3, 3
  s_lshr_b32 s21, s3, 2
  s_lshl_b32 s26, s19, 3
  s_lshl_b32 s27, s20, 1
  s_add_u32 s26, s26, s27
  s_mul_i32 s27, s18, 98304
  s_mul_i32 s28, s26, 1536
  s_add_u32 s27, s27, s28
  s_add_u32 s27, s27, 10190848
  v_lshlrev_b32 v4, 3, v2
  s_mov_b32 s14, 32751616
  s_mov_b32 s15, 0x00020000
  s_waitcnt lgkmcnt(0)
  s_and_b32 s13, s13, 0xffff
  buffer_load_dwordx4 v[8:11], v3, s[12:15], s27 offen
  buffer_load_dwordx4 v[12:15], v3, s[12:15], s27 offen offset:1536
  buffer_load_dwordx2 v[16:17], v4, s[12:15], s27 offen offset:1024
  buffer_load_dwordx2 v[18:19], v4, s[12:15], s27 offen offset:2560
  s_mul_i32 s29, s21, 23040
  v_add_u32 v132, s29, v3
  v_add_u32 v133, s29, v4
  v_and_b32 v5, 31, v2
  v_lshrrev_b32 v6, 5, v2
  v_subrev_u32 v7, 16, v5
  v_cmp_lt_u32 vcc, 20, v5
  s_nop 1
  v_cndmask_b32 v5, v5, v7, vcc
  v_mul_u32_u24 v7, 21, v6
  v_add_u32 v5, v5, v7
  v_lshlrev_b32 v5, 4, v5
  v_add_u32 v134, s29, v5
  v_cmp_lt_u32 s[30:31], 31, v2
  v_add_u32 v135, 49152, v132
  v_add_u32 v136, 49152, v133
  v_add_u32 v137, 49152, v134
  s_mov_b32 s32, 0
  v_mov_b32 v100, 0
  v_mov_b32 v116, 0
  v_mov_b32 v101, 0
  v_mov_b32 v117, 0
  v_mov_b32 v102, 0
  v_mov_b32 v118, 0
  v_mov_b32 v103, 0
  v_mov_b32 v119, 0
  v_mov_b32 v104, 0
  v_mov_b32 v120, 0
  v_mov_b32 v105, 0
  v_mov_b32 v121, 0
  v_mov_b32 v106, 0
  v_mov_b32 v122, 0
  v_mov_b32 v107, 0
  v_mov_b32 v123, 0
  v_mov_b32 v108, 0
  v_mov_b32 v124, 0
  v_mov_b32 v109, 0
  v_mov_b32 v125, 0
  v_mov_b32 v110, 0
  v_mov_b32 v126, 0
  v_mov_b32 v111, 0
  v_mov_b32 v127, 0
  v_mov_b32 v92, 0
  v_mov_b32 v44, 0
  v_mov_b32 v36, 0
  v_mov_b32 v93, 0
  v_mov_b32 v45, 0
  v_mov_b32 v37, 0
  v_mov_b32 v94, 0
  v_mov_b32 v46, 0
  v_mov_b32 v38, 0
  v_mov_b32 v95, 0
  v_mov_b32 v47, 0
  v_mov_b32 v39, 0
  v_mov_b32 v96, 0
  v_mov_b32 v48, 0
  v_mov_b32 v40, 0
  v_mov_b32 v97, 0
  v_mov_b32 v49, 0
  v_mov_b32 v41, 0
  v_mov_b32 v98, 0
  v_mov_b32 v50, 0
  v_mov_b32 v42, 0
  v_mov_b32 v99, 0
  v_mov_b32 v51, 0
  v_mov_b32 v43, 0
  s_mov_b32 s34, 0x001fffff
  s_mov_b32 s35, 0x001fffff
  s_waitcnt vmcnt(0)
  v_cndmask_b32 v16, v16, 0, s[30:31]
  v_cndmask_b32 v17, v17, 0, s[30:31]
  v_cndmask_b32 v18, v18, 0, s[30:31]
  v_cndmask_b32 v19, v19, 0, s[30:31]
  s_barrier
  ds_read_b128 v[28:31], v3
  ds_read_b64 v[32:33], v4 offset:1024
  ds_read_b128 v[20:23], v132
  ds_read_b64 v[24:25], v133 offset:1024
  s_mov_b64 exec, s[34:35]
  ds_read_b128 v[36:39], v134 offset:1536
  ds_read_b128 v[40:43], v134 offset:2208
  s_mov_b64 exec, -1
  s_waitcnt lgkmcnt(4)
  s_nop 2
  v_mfma_f32_32x32x16_bf16 v[52:67], v[28:31], v[8:11], 0
  v_mfma_f32_32x32x8_bf16 v[52:67], v[32:33], v[16:17], v[52:67]
  v_mfma_f32_32x32x16_bf16 v[68:83], v[28:31], v[12:15], 0
  v_mfma_f32_32x32x8_bf16 v[68:83], v[32:33], v[18:19], v[68:83]
  s_nop 8
  s_nop 0
  v_max3_f32 v140, v52, v53, v54
  v_max3_f32 v140, v140, v55, v56
  v_max3_f32 v140, v140, v57, v58
  v_max3_f32 v140, v140, v59, v60
  v_max3_f32 v140, v140, v61, v62
  v_max3_f32 v140, v140, v63, v64
  v_max3_f32 v140, v140, v65, v66
  v_max_f32 v140, v140, v67
  v_mov_b32 v142, v140
  s_nop 1
  v_permlane32_swap_b32 v142, v140
  s_nop 1
  v_max_f32 v140, v140, v142
  v_cvt_pk_bf16_f32 v143, v140, v140
  v_lshlrev_b32 v143, 16, v143
  v_sub_f32 v144, v143, v140
  v_sub_f32 v143, 0, v143
  v_cvt_pk_bf16_f32 v143, v143, v144
  v_cndmask_b32 v16, v16, v143, s[30:31]
  v_max3_f32 v141, v68, v69, v70
  v_max3_f32 v141, v141, v71, v72
  v_max3_f32 v141, v141, v73, v74
  v_max3_f32 v141, v141, v75, v76
  v_max3_f32 v141, v141, v77, v78
  v_max3_f32 v141, v141, v79, v80
  v_max3_f32 v141, v141, v81, v82
  v_max_f32 v141, v141, v83
  v_mov_b32 v142, v141
  s_nop 1
  v_permlane32_swap_b32 v142, v141
  s_nop 1
  v_max_f32 v141, v141, v142
  v_cvt_pk_bf16_f32 v143, v141, v141
  v_lshlrev_b32 v143, 16, v143
  v_sub_f32 v144, v143, v141
  v_sub_f32 v143, 0, v143
  v_cvt_pk_bf16_f32 v143, v143, v144
  v_cndmask_b32 v18, v18, v143, s[30:31]
  s_waitcnt lgkmcnt(0)
  v_mfma_f32_32x32x16_bf16 v[52:67], v[20:23], v[8:11], 0
  v_mfma_f32_32x32x8_bf16 v[52:67], v[24:25], v[16:17], v[52:67]
  s_nop 7
L_attn_round:
  v_mfma_f32_32x32x16_bf16 v[68:83], v[20:23], v[12:15], 0
  s_nop 1
  s_nop 0
  v_exp_f32 v52, v52
  ds_read_b128 v[28:31], v132 offset:2880
  ds_read_b64 v[32:33], v133 offset:3904
  v_exp_f32 v53, v53
  v_exp_f32 v54, v54
  v_exp_f32 v55, v55
  v_mfma_f32_32x32x8_bf16 v[68:83], v[24:25], v[18:19], v[68:83]
  v_cvt_pk_bf16_f32 v84, v52, v53
  v_exp_f32 v56, v56
  v_exp_f32 v57, v57
  v_cvt_pk_bf16_f32 v85, v54, v55
  v_exp_f32 v58, v58
  v_exp_f32 v59, v59
  v_mfma_f32_32x32x16_bf16 v[116:131], v[44:47], v[92:95], v[116:131]
  v_cvt_pk_bf16_f32 v86, v56, v57
  v_exp_f32 v60, v60
  v_exp_f32 v61, v61
  v_cvt_pk_bf16_f32 v87, v58, v59
  v_exp_f32 v62, v62
  v_exp_f32 v63, v63
  v_mfma_f32_32x32x16_bf16 v[116:131], v[48:51], v[96:99], v[116:131]
  v_cvt_pk_bf16_f32 v88, v60, v61
  v_exp_f32 v64, v64
  s_mov_b64 exec, s[34:35]
  ds_read_b128 v[44:47], v134 offset:4416
  ds_read_b128 v[48:51], v134 offset:5088
  s_mov_b64 exec, -1
  v_exp_f32 v65, v65
  v_cvt_pk_bf16_f32 v89, v62, v63
  v_exp_f32 v66, v66
  v_exp_f32 v67, v67
  v_cvt_pk_bf16_f32 v90, v64, v65
  v_cvt_pk_bf16_f32 v91, v66, v67
  s_waitcnt lgkmcnt(2)
  v_mfma_f32_32x32x16_bf16 v[52:67], v[28:31], v[8:11], 0
  v_exp_f32 v68, v68
  v_exp_f32 v69, v69
  v_exp_f32 v70, v70
  v_exp_f32 v71, v71
  v_mfma_f32_32x32x8_bf16 v[52:67], v[32:33], v[16:17], v[52:67]
  v_cvt_pk_bf16_f32 v92, v68, v69
  v_exp_f32 v72, v72
  v_exp_f32 v73, v73
  v_cvt_pk_bf16_f32 v93, v70, v71
  v_exp_f32 v74, v74
  v_exp_f32 v75, v75
  v_mfma_f32_32x32x16_bf16 v[100:115], v[36:39], v[84:87], v[100:115]
  v_cvt_pk_bf16_f32 v94, v72, v73
  v_exp_f32 v76, v76
  v_exp_f32 v77, v77
  v_cvt_pk_bf16_f32 v95, v74, v75
  v_exp_f32 v78, v78
  v_exp_f32 v79, v79
  v_mfma_f32_32x32x16_bf16 v[100:115], v[40:43], v[88:91], v[100:115]
  v_cvt_pk_bf16_f32 v96, v76, v77
  v_exp_f32 v80, v80
  v_exp_f32 v81, v81
  v_cvt_pk_bf16_f32 v97, v78, v79
  v_exp_f32 v82, v82
  v_exp_f32 v83, v83
  s_waitcnt lgkmcnt(0)
  v_cvt_pk_bf16_f32 v98, v80, v81
  v_cvt_pk_bf16_f32 v99, v82, v83
  v_mfma_f32_32x32x16_bf16 v[68:83], v[28:31], v[12:15], 0
  v_exp_f32 v52, v52
  ds_read_b128 v[20:23], v132 offset:5760
  ds_read_b64 v[24:25], v133 offset:6784
  v_exp_f32 v53, v53
  v_exp_f32 v54, v54
  v_exp_f32 v55, v55
  v_mfma_f32_32x32x8_bf16 v[68:83], v[32:33], v[18:19], v[68:83]
  v_cvt_pk_bf16_f32 v84, v52, v53
  v_exp_f32 v56, v56
  v_exp_f32 v57, v57
  v_cvt_pk_bf16_f32 v85, v54, v55
  v_exp_f32 v58, v58
  v_exp_f32 v59, v59
  v_mfma_f32_32x32x16_bf16 v[116:131], v[36:39], v[92:95], v[116:131]
  v_cvt_pk_bf16_f32 v86, v56, v57
  v_exp_f32 v60, v60
  v_exp_f32 v61, v61
  v_cvt_pk_bf16_f32 v87, v58, v59
  v_exp_f32 v62, v62
  v_exp_f32 v63, v63
  v_mfma_f32_32x32x16_bf16 v[116:131], v[40:43], v[96:99], v[116:131]
  v_cvt_pk_bf16_f32 v88, v60, v61
  v_exp_f32 v64, v64
  s_mov_b64 exec, s[34:35]
  ds_read_b128 v[36:39], v134 offset:7296
  ds_read_b128 v[40:43], v134 offset:7968
  s_mov_b64 exec, -1
  v_exp_f32 v65, v65
  v_cvt_pk_bf16_f32 v89, v62, v63
  v_exp_f32 v66, v66
  v_exp_f32 v67, v67
  v_cvt_pk_bf16_f32 v90, v64, v65
  v_cvt_pk_bf16_f32 v91, v66, v67
  s_waitcnt lgkmcnt(2)
  v_mfma_f32_32x32x16_bf16 v[52:67], v[20:23], v[8:11], 0
  v_exp_f32 v68, v68
  v_exp_f32 v69, v69
  v_exp_f32 v70, v70
  v_exp_f32 v71, v71
  v_mfma_f32_32x32x8_bf16 v[52:67], v[24:25], v[16:17], v[52:67]
  v_cvt_pk_bf16_f32 v92, v68, v69
  v_exp_f32 v72, v72
  v_exp_f32 v73, v73
  v_cvt_pk_bf16_f32 v93, v70, v71
  v_exp_f32 v74, v74
  v_exp_f32 v75, v75
  v_mfma_f32_32x32x16_bf16 v[100:115], v[44:47], v[84:87], v[100:115]
  v_cvt_pk_bf16_f32 v94, v72, v73
  v_exp_f32 v76, v76
  v_exp_f32 v77, v77
  v_cvt_pk_bf16_f32 v95, v74, v75
  v_exp_f32 v78, v78
  v_exp_f32 v79, v79
  v_mfma_f32_32x32x16_bf16 v[100:115], v[48:51], v[88:91], v[100:115]
  v_cvt_pk_bf16_f32 v96, v76, v77
  v_exp_f32 v80, v80
  v_exp_f32 v81, v81
  v_cvt_pk_bf16_f32 v97, v78, v79
  v_exp_f32 v82, v82
  v_exp_f32 v83, v83
  s_waitcnt lgkmcnt(0)
  v_cvt_pk_bf16_f32 v98, v80, v81
  v_cvt_pk_bf16_f32 v99, v82, v83
  v_mfma_f32_32x32x16_bf16 v[68:83], v[20:23], v[12:15], 0
  v_exp_f32 v52, v52
  ds_read_b128 v[28:31], v132 offset:8640
  ds_read_b64 v[32:33], v133 offset:9664
  v_exp_f32 v53, v53
  v_exp_f32 v54, v54
  v_exp_f32 v55, v55
  v_mfma_f32_32x32x8_bf16 v[68:83], v[24:25], v[18:19], v[68:83]
  v_cvt_pk_bf16_f32 v84, v52, v53
  v_exp_f32 v56, v56
  v_exp_f32 v57, v57
  v_cvt_pk_bf16_f32 v85, v54, v55
  v_exp_f32 v58, v58
  v_exp_f32 v59, v59
  v_mfma_f32_32x32x16_bf16 v[116:131], v[44:47], v[92:95], v[116:131]
  v_cvt_pk_bf16_f32 v86, v56, v57
  v_exp_f32 v60, v60
  v_exp_f32 v61, v61
  v_cvt_pk_bf16_f32 v87, v58, v59
  v_exp_f32 v62, v62
  v_exp_f32 v63, v63
  v_mfma_f32_32x32x16_bf16 v[116:131], v[48:51], v[96:99], v[116:131]
  v_cvt_pk_bf16_f32 v88, v60, v61
  v_exp_f32 v64, v64
  s_mov_b64 exec, s[34:35]
  ds_read_b128 v[44:47], v134 offset:10176
  ds_read_b128 v[48:51], v134 offset:10848
  s_mov_b64 exec, -1
  v_exp_f32 v65, v65
  v_cvt_pk_bf16_f32 v89, v62, v63
  v_exp_f32 v66, v66
  v_exp_f32 v67, v67
  v_cvt_pk_bf16_f32 v90, v64, v65
  v_cvt_pk_bf16_f32 v91, v66, v67
  s_waitcnt lgkmcnt(2)
  v_mfma_f32_32x32x16_bf16 v[52:67], v[28:31], v[8:11], 0
  v_exp_f32 v68, v68
  v_exp_f32 v69, v69
  v_exp_f32 v70, v70
  v_exp_f32 v71, v71
  v_mfma_f32_32x32x8_bf16 v[52:67], v[32:33], v[16:17], v[52:67]
  v_cvt_pk_bf16_f32 v92, v68, v69
  v_exp_f32 v72, v72
  v_exp_f32 v73, v73
  v_cvt_pk_bf16_f32 v93, v70, v71
  v_exp_f32 v74, v74
  v_exp_f32 v75, v75
  v_mfma_f32_32x32x16_bf16 v[100:115], v[36:39], v[84:87], v[100:115]
  v_cvt_pk_bf16_f32 v94, v72, v73
  v_exp_f32 v76, v76
  v_exp_f32 v77, v77
  v_cvt_pk_bf16_f32 v95, v74, v75
  v_exp_f32 v78, v78
  v_exp_f32 v79, v79
  v_mfma_f32_32x32x16_bf16 v[100:115], v[40:43], v[88:91], v[100:115]
  v_cvt_pk_bf16_f32 v96, v76, v77
  v_exp_f32 v80, v80
  v_exp_f32 v81, v81
  v_cvt_pk_bf16_f32 v97, v78, v79
  v_exp_f32 v82, v82
  v_exp_f32 v83, v83
  s_waitcnt lgkmcnt(0)
  v_cvt_pk_bf16_f32 v98, v80, v81
  v_cvt_pk_bf16_f32 v99, v82, v83
  v_mfma_f32_32x32x16_bf16 v[68:83], v[28:31], v[12:15], 0
  v_exp_f32 v52, v52
  ds_read_b128 v[20:23], v132 offset:11520
  ds_read_b64 v[24:25], v133 offset:12544
  v_exp_f32 v53, v53
  v_exp_f32 v54, v54
  v_exp_f32 v55, v55
  v_mfma_f32_32x32x8_bf16 v[68:83], v[32:33], v[18:19], v[68:83]
  v_cvt_pk_bf16_f32 v84, v52, v53
  v_exp_f32 v56, v56
  v_exp_f32 v57, v57
  v_cvt_pk_bf16_f32 v85, v54, v55
  v_exp_f32 v58, v58
  v_exp_f32 v59, v59
  v_mfma_f32_32x32x16_bf16 v[116:131], v[36:39], v[92:95], v[116:131]
  v_cvt_pk_bf16_f32 v86, v56, v57
  v_exp_f32 v60, v60
  v_exp_f32 v61, v61
  v_cvt_pk_bf16_f32 v87, v58, v59
  v_exp_f32 v62, v62
  v_exp_f32 v63, v63
  v_mfma_f32_32x32x16_bf16 v[116:131], v[40:43], v[96:99], v[116:131]
  v_cvt_pk_bf16_f32 v88, v60, v61
  v_exp_f32 v64, v64
  s_mov_b64 exec, s[34:35]
  ds_read_b128 v[36:39], v134 offset:13056
  ds_read_b128 v[40:43], v134 offset:13728
  s_mov_b64 exec, -1
  v_exp_f32 v65, v65
  v_cvt_pk_bf16_f32 v89, v62, v63
  v_exp_f32 v66, v66
  v_exp_f32 v67, v67
  v_cvt_pk_bf16_f32 v90, v64, v65
  v_cvt_pk_bf16_f32 v91, v66, v67
  s_waitcnt lgkmcnt(2)
  v_mfma_f32_32x32x16_bf16 v[52:67], v[20:23], v[8:11], 0
  v_exp_f32 v68, v68
  v_exp_f32 v69, v69
  v_exp_f32 v70, v70
  v_exp_f32 v71, v71
  v_mfma_f32_32x32x8_bf16 v[52:67], v[24:25], v[16:17], v[52:67]
  v_cvt_pk_bf16_f32 v92, v68, v69
  v_exp_f32 v72, v72
  v_exp_f32 v73, v73
  v_cvt_pk_bf16_f32 v93, v70, v71
  v_exp_f32 v74, v74
  v_exp_f32 v75, v75
  v_mfma_f32_32x32x16_bf16 v[100:115], v[44:47], v[84:87], v[100:115]
  v_cvt_pk_bf16_f32 v94, v72, v73
  v_exp_f32 v76, v76
  v_exp_f32 v77, v77
  v_cvt_pk_bf16_f32 v95, v74, v75
  v_exp_f32 v78, v78
  v_exp_f32 v79, v79
  v_mfma_f32_32x32x16_bf16 v[100:115], v[48:51], v[88:91], v[100:115]
  v_cvt_pk_bf16_f32 v96, v76, v77
  v_exp_f32 v80, v80
  v_exp_f32 v81, v81
  v_cvt_pk_bf16_f32 v97, v78, v79
  v_exp_f32 v82, v82
  v_exp_f32 v83, v83
  s_waitcnt lgkmcnt(0)
  v_cvt_pk_bf16_f32 v98, v80, v81
  v_cvt_pk_bf16_f32 v99, v82, v83
  v_mfma_f32_32x32x16_bf16 v[68:83], v[20:23], v[12:15], 0
  v_exp_f32 v52, v52
  ds_read_b128 v[28:31], v132 offset:14400
  ds_read_b64 v[32:33], v133 offset:15424
  v_exp_f32 v53, v53
  v_exp_f32 v54, v54
  v_exp_f32 v55, v55
  v_mfma_f32_32x32x8_bf16 v[68:83], v[24:25], v[18:19], v[68:83]
  v_cvt_pk_bf16_f32 v84, v52, v53
  v_exp_f32 v56, v56
  v_exp_f32 v57, v57
  v_cvt_pk_bf16_f32 v85, v54, v55
  v_exp_f32 v58, v58
  v_exp_f32 v59, v59
  v_mfma_f32_32x32x16_bf16 v[116:131], v[44:47], v[92:95], v[116:131]
  v_cvt_pk_bf16_f32 v86, v56, v57
  v_exp_f32 v60, v60
  v_exp_f32 v61, v61
  v_cvt_pk_bf16_f32 v87, v58, v59
  v_exp_f32 v62, v62
  v_exp_f32 v63, v63
  v_mfma_f32_32x32x16_bf16 v[116:131], v[48:51], v[96:99], v[116:131]
  v_cvt_pk_bf16_f32 v88, v60, v61
  v_exp_f32 v64, v64
  s_mov_b64 exec, s[34:35]
  ds_read_b128 v[44:47], v134 offset:15936
  ds_read_b128 v[48:51], v134 offset:16608
  s_mov_b64 exec, -1
  v_exp_f32 v65, v65
  v_cvt_pk_bf16_f32 v89, v62, v63
  v_exp_f32 v66, v66
  v_exp_f32 v67, v67
  v_cvt_pk_bf16_f32 v90, v64, v65
  v_cvt_pk_bf16_f32 v91, v66, v67
  s_waitcnt lgkmcnt(2)
  v_mfma_f32_32x32x16_bf16 v[52:67], v[28:31], v[8:11], 0
  v_exp_f32 v68, v68
  v_exp_f32 v69, v69
  v_exp_f32 v70, v70
  v_exp_f32 v71, v71
  v_mfma_f32_32x32x8_bf16 v[52:67], v[32:33], v[16:17], v[52:67]
  v_cvt_pk_bf16_f32 v92, v68, v69
  v_exp_f32 v72, v72
  v_exp_f32 v73, v73
  v_cvt_pk_bf16_f32 v93, v70, v71
  v_exp_f32 v74, v74
  v_exp_f32 v75, v75
  v_mfma_f32_32x32x16_bf16 v[100:115], v[36:39], v[84:87], v[100:115]
  v_cvt_pk_bf16_f32 v94, v72, v73
  v_exp_f32 v76, v76
  v_exp_f32 v77, v77
  v_cvt_pk_bf16_f32 v95, v74, v75
  v_exp_f32 v78, v78
  v_exp_f32 v79, v79
  v_mfma_f32_32x32x16_bf16 v[100:115], v[40:43], v[88:91], v[100:115]
  v_cvt_pk_bf16_f32 v96, v76, v77
  v_exp_f32 v80, v80
  v_exp_f32 v81, v81
  v_cvt_pk_bf16_f32 v97, v78, v79
  v_exp_f32 v82, v82
  v_exp_f32 v83, v83
  s_waitcnt lgkmcnt(0)
  v_cvt_pk_bf16_f32 v98, v80, v81
  v_cvt_pk_bf16_f32 v99, v82, v83
  v_mfma_f32_32x32x16_bf16 v[68:83], v[28:31], v[12:15], 0
  v_exp_f32 v52, v52
  ds_read_b128 v[20:23], v132 offset:17280
  ds_read_b64 v[24:25], v133 offset:18304
  v_exp_f32 v53, v53
  v_exp_f32 v54, v54
  v_exp_f32 v55, v55
  v_mfma_f32_32x32x8_bf16 v[68:83], v[32:33], v[18:19], v[68:83]
  v_cvt_pk_bf16_f32 v84, v52, v53
  v_exp_f32 v56, v56
  v_exp_f32 v57, v57
  v_cvt_pk_bf16_f32 v85, v54, v55
  v_exp_f32 v58, v58
  v_exp_f32 v59, v59
  v_mfma_f32_32x32x16_bf16 v[116:131], v[36:39], v[92:95], v[116:131]
  v_cvt_pk_bf16_f32 v86, v56, v57
  v_exp_f32 v60, v60
  v_exp_f32 v61, v61
  v_cvt_pk_bf16_f32 v87, v58, v59
  v_exp_f32 v62, v62
  v_exp_f32 v63, v63
  v_mfma_f32_32x32x16_bf16 v[116:131], v[40:43], v[96:99], v[116:131]
  v_cvt_pk_bf16_f32 v88, v60, v61
  v_exp_f32 v64, v64
  s_mov_b64 exec, s[34:35]
  ds_read_b128 v[36:39], v134 offset:18816
  ds_read_b128 v[40:43], v134 offset:19488
  s_mov_b64 exec, -1
  v_exp_f32 v65, v65
  v_cvt_pk_bf16_f32 v89, v62, v63
  v_exp_f32 v66, v66
  v_exp_f32 v67, v67
  v_cvt_pk_bf16_f32 v90, v64, v65
  v_cvt_pk_bf16_f32 v91, v66, v67
  s_waitcnt lgkmcnt(2)
  v_mfma_f32_32x32x16_bf16 v[52:67], v[20:23], v[8:11], 0
  v_exp_f32 v68, v68
  v_exp_f32 v69, v69
  v_exp_f32 v70, v70
  v_exp_f32 v71, v71
  v_mfma_f32_32x32x8_bf16 v[52:67], v[24:25], v[16:17], v[52:67]
  v_cvt_pk_bf16_f32 v92, v68, v69
  v_exp_f32 v72, v72
  v_exp_f32 v73, v73
  v_cvt_pk_bf16_f32 v93, v70, v71
  v_exp_f32 v74, v74
  v_exp_f32 v75, v75
  v_mfma_f32_32x32x16_bf16 v[100:115], v[44:47], v[84:87], v[100:115]
  v_cvt_pk_bf16_f32 v94, v72, v73
  v_exp_f32 v76, v76
  v_exp_f32 v77, v77
  v_cvt_pk_bf16_f32 v95, v74, v75
  v_exp_f32 v78, v78
  v_exp_f32 v79, v79
  v_mfma_f32_32x32x16_bf16 v[100:115], v[48:51], v[88:91], v[100:115]
  v_cvt_pk_bf16_f32 v96, v76, v77
  v_exp_f32 v80, v80
  v_exp_f32 v81, v81
  v_cvt_pk_bf16_f32 v97, v78, v79
  v_exp_f32 v82, v82
  v_exp_f32 v83, v83
  s_waitcnt lgkmcnt(0)
  v_cvt_pk_bf16_f32 v98, v80, v81
  v_cvt_pk_bf16_f32 v99, v82, v83
  v_mfma_f32_32x32x16_bf16 v[68:83], v[20:23], v[12:15], 0
  v_exp_f32 v52, v52
  ds_read_b128 v[28:31], v132 offset:20160
  ds_read_b64 v[32:33], v133 offset:21184
  v_exp_f32 v53, v53
  v_exp_f32 v54, v54
  v_exp_f32 v55, v55
  v_mfma_f32_32x32x8_bf16 v[68:83], v[24:25], v[18:19], v[68:83]
  v_cvt_pk_bf16_f32 v84, v52, v53
  v_exp_f32 v56, v56
  v_exp_f32 v57, v57
  v_cvt_pk_bf16_f32 v85, v54, v55
  v_exp_f32 v58, v58
  v_exp_f32 v59, v59
  v_mfma_f32_32x32x16_bf16 v[116:131], v[44:47], v[92:95], v[116:131]
  v_cvt_pk_bf16_f32 v86, v56, v57
  v_exp_f32 v60, v60
  v_exp_f32 v61, v61
  v_cvt_pk_bf16_f32 v87, v58, v59
  v_exp_f32 v62, v62
  v_exp_f32 v63, v63
  v_mfma_f32_32x32x16_bf16 v[116:131], v[48:51], v[96:99], v[116:131]
  v_cvt_pk_bf16_f32 v88, v60, v61
  v_exp_f32 v64, v64
  s_mov_b64 exec, s[34:35]
  ds_read_b128 v[44:47], v134 offset:21696
  ds_read_b128 v[48:51], v134 offset:22368
  s_mov_b64 exec, -1
  v_exp_f32 v65, v65
  v_cvt_pk_bf16_f32 v89, v62, v63
  v_exp_f32 v66, v66
  v_exp_f32 v67, v67
  v_cvt_pk_bf16_f32 v90, v64, v65
  v_cvt_pk_bf16_f32 v91, v66, v67
  s_waitcnt lgkmcnt(2)
  v_mfma_f32_32x32x16_bf16 v[52:67], v[28:31], v[8:11], 0
  v_exp_f32 v68, v68
  v_exp_f32 v69, v69
  v_exp_f32 v70, v70
  v_exp_f32 v71, v71
  v_mfma_f32_32x32x8_bf16 v[52:67], v[32:33], v[16:17], v[52:67]
  v_cvt_pk_bf16_f32 v92, v68, v69
  v_exp_f32 v72, v72
  v_exp_f32 v73, v73
  v_cvt_pk_bf16_f32 v93, v70, v71
  v_exp_f32 v74, v74
  v_exp_f32 v75, v75
  v_mfma_f32_32x32x16_bf16 v[100:115], v[36:39], v[84:87], v[100:115]
  v_cvt_pk_bf16_f32 v94, v72, v73
  v_exp_f32 v76, v76
  v_exp_f32 v77, v77
  v_cvt_pk_bf16_f32 v95, v74, v75
  v_exp_f32 v78, v78
  v_exp_f32 v79, v79
  v_mfma_f32_32x32x16_bf16 v[100:115], v[40:43], v[88:91], v[100:115]
  v_cvt_pk_bf16_f32 v96, v76, v77
  v_exp_f32 v80, v80
  v_exp_f32 v81, v81
  v_cvt_pk_bf16_f32 v97, v78, v79
  v_exp_f32 v82, v82
  v_exp_f32 v83, v83
  s_waitcnt lgkmcnt(0)
  v_cvt_pk_bf16_f32 v98, v80, v81
  v_cvt_pk_bf16_f32 v99, v82, v83
  s_barrier
  v_mfma_f32_32x32x16_bf16 v[68:83], v[28:31], v[12:15], 0
  v_exp_f32 v52, v52
  ds_read_b128 v[20:23], v135 offset:0
  ds_read_b64 v[24:25], v136 offset:1024
  v_exp_f32 v53, v53
  v_exp_f32 v54, v54
  v_exp_f32 v55, v55
  v_mfma_f32_32x32x8_bf16 v[68:83], v[32:33], v[18:19], v[68:83]
  v_cvt_pk_bf16_f32 v84, v52, v53
  v_exp_f32 v56, v56
  v_exp_f32 v57, v57
  v_cvt_pk_bf16_f32 v85, v54, v55
  v_exp_f32 v58, v58
  v_exp_f32 v59, v59
  v_mfma_f32_32x32x16_bf16 v[116:131], v[36:39], v[92:95], v[116:131]
  v_cvt_pk_bf16_f32 v86, v56, v57
  v_exp_f32 v60, v60
  v_exp_f32 v61, v61
  v_cvt_pk_bf16_f32 v87, v58, v59
  v_exp_f32 v62, v62
  v_exp_f32 v63, v63
  v_mfma_f32_32x32x16_bf16 v[116:131], v[40:43], v[96:99], v[116:131]
  v_cvt_pk_bf16_f32 v88, v60, v61
  v_exp_f32 v64, v64
  s_mov_b64 exec, s[34:35]
  ds_read_b128 v[36:39], v137 offset:1536
  ds_read_b128 v[40:43], v137 offset:2208
  s_mov_b64 exec, -1
  v_exp_f32 v65, v65
  v_cvt_pk_bf16_f32 v89, v62, v63
  v_exp_f32 v66, v66
  v_exp_f32 v67, v67
  v_cvt_pk_bf16_f32 v90, v64, v65
  v_cvt_pk_bf16_f32 v91, v66, v67
  s_waitcnt lgkmcnt(2)
  v_mfma_f32_32x32x16_bf16 v[52:67], v[20:23], v[8:11], 0
  v_exp_f32 v68, v68
  v_exp_f32 v69, v69
  v_exp_f32 v70, v70
  v_exp_f32 v71, v71
  v_mfma_f32_32x32x8_bf16 v[52:67], v[24:25], v[16:17], v[52:67]
  v_cvt_pk_bf16_f32 v92, v68, v69
  v_exp_f32 v72, v72
  v_exp_f32 v73, v73
  v_cvt_pk_bf16_f32 v93, v70, v71
  v_exp_f32 v74, v74
  v_exp_f32 v75, v75
  v_mfma_f32_32x32x16_bf16 v[100:115], v[44:47], v[84:87], v[100:115]
  v_cvt_pk_bf16_f32 v94, v72, v73
  v_exp_f32 v76, v76
  v_exp_f32 v77, v77
  v_cvt_pk_bf16_f32 v95, v74, v75
  v_exp_f32 v78, v78
  v_exp_f32 v79, v79
  v_mfma_f32_32x32x16_bf16 v[100:115], v[48:51], v[88:91], v[100:115]
  v_cvt_pk_bf16_f32 v96, v76, v77
  v_exp_f32 v80, v80
  v_exp_f32 v81, v81
  v_cvt_pk_bf16_f32 v97, v78, v79
  v_exp_f32 v82, v82
  v_exp_f32 v83, v83
  s_waitcnt lgkmcnt(0)
  v_cvt_pk_bf16_f32 v98, v80, v81
  v_cvt_pk_bf16_f32 v99, v82, v83
  s_add_u32 s32, s32, 1
  v_mov_b32 v132, v135
  v_mov_b32 v133, v136
  v_mov_b32 v134, v137
  s_mov_b32 s33, 49152
  s_cmp_eq_u32 s32, 2
  s_cselect_b32 s33, 4294868992, s33
  v_add_u32 v135, s33, v135
  v_add_u32 v136, s33, v136
  v_add_u32 v137, s33, v137
  s_cmp_lt_u32 s32, 4
  s_cbranch_scc1 L_attn_round
  v_mfma_f32_32x32x16_bf16 v[116:131], v[44:47], v[92:95], v[116:131]
  v_mfma_f32_32x32x16_bf16 v[116:131], v[48:51], v[96:99], v[116:131]
  s_lshl_b32 s34, s20, 1
  s_add_u32 s34, s34, s21
  s_mul_i32 s35, s34, 3072
  s_xor_b32 s36, s34, 1
  s_mul_i32 s36, s36, 3072
  v_add_u32 v6, s35, v3
  v_add_u32 v6, 49152, v6
  v_add_u32 v7, s36, v3
  v_add_u32 v7, 49152, v7
  s_cmp_eq_u32 s21, 0
  s_cbranch_scc0 L_attn_c1
  s_nop 7
  s_nop 3
  ds_write_b128 v6, v[116:119] offset:0
  ds_write_b128 v6, v[120:123] offset:1024
  ds_write_b128 v6, v[124:127] offset:2048
  s_branch L_attn_m
L_attn_c1:
  ds_write_b128 v6, v[100:103] offset:0
  ds_write_b128 v6, v[104:107] offset:1024
  ds_write_b128 v6, v[108:111] offset:2048
  s_nop 7
  v_mov_b32 v100, v116
  v_mov_b32 v101, v117
  v_mov_b32 v102, v118
  v_mov_b32 v103, v119
  v_mov_b32 v104, v120
  v_mov_b32 v105, v121
  v_mov_b32 v106, v122
  v_mov_b32 v107, v123
  v_mov_b32 v108, v124
  v_mov_b32 v109, v125
  v_mov_b32 v110, v126
  v_mov_b32 v111, v127
  v_mov_b32 v8, v12
  v_mov_b32 v9, v13
  v_mov_b32 v10, v14
  v_mov_b32 v11, v15
  v_mov_b32 v16, v18
  v_mov_b32 v17, v19
L_attn_m:
  s_waitcnt lgkmcnt(0)
  s_barrier
  ds_read_b128 v[52:55], v7 offset:0
  ds_read_b128 v[56:59], v7 offset:1024
  ds_read_b128 v[60:63], v7 offset:2048
  s_mov_b32 s39, 0
  s_waitcnt lgkmcnt(0)
  v_add_f32 v100, v100, v52
  v_add_f32 v101, v101, v53
  v_add_f32 v102, v102, v54
  v_add_f32 v103, v103, v55
  v_add_f32 v104, v104, v56
  v_add_f32 v105, v105, v57
  v_add_f32 v106, v106, v58
  v_add_f32 v107, v107, v59
  v_add_f32 v108, v108, v60
  v_add_f32 v109, v109, v61
  v_add_f32 v110, v110, v62
  v_add_f32 v111, v111, v63
L_attn_norm:
  v_mov_b32 v140, v108
  v_mov_b32 v141, v108
  s_nop 1
  v_permlane32_swap_b32 v140, v141
  s_mov_b32 s40, 0x5f800000
  s_nop 0
  v_cmp_lt_f32 vcc, v141, s40
  s_nop 4
  s_cmp_eq_u64 vcc, exec
  s_cbranch_scc1 L_attn_ok
  s_cmp_eq_u32 s39, 0
  s_cbranch_scc1 L_attn_fb
L_attn_ok:
  v_rcp_f32 v140, v141
  s_nop 0
  v_mul_f32 v100, v100, v140
  v_mul_f32 v101, v101, v140
  v_mul_f32 v102, v102, v140
  v_mul_f32 v103, v103, v140
  v_mul_f32 v104, v104, v140
  v_mul_f32 v105, v105, v140
  v_mul_f32 v106, v106, v140
  v_mul_f32 v107, v107, v140
  v_mul_f32 v108, v108, v140
  v_mul_f32 v109, v109, v140
  v_mul_f32 v110, v110, v140
  v_mul_f32 v111, v111, v140
  v_cvt_pk_bf16_f32 v68, v100, v101
  v_cvt_pk_bf16_f32 v69, v102, v103
  v_cvt_pk_bf16_f32 v70, v104, v105
  v_cvt_pk_bf16_f32 v71, v106, v107
  v_cvt_pk_bf16_f32 v72, v108, v109
  v_cvt_pk_bf16_f32 v73, v110, v111
  s_lshl_b32 s34, s19, 8
  s_lshl_b32 s35, s20, 6
  s_add_u32 s34, s34, s35
  s_lshl_b32 s35, s21, 5
  s_add_u32 s34, s34, s35
  v_and_b32 v4, 31, v2
  v_add_u32 v4, s34, v4
  v_lshrrev_b32 v5, 4, v4
  v_mul_u32_u24 v5, 20480, v5
  v_and_b32 v4, 15, v4
  v_lshl_add_u32 v5, v4, 4, v5
  v_lshrrev_b32 v6, 5, v2
  s_mov_b32 s38, 19243008
  s_mul_i32 s35, s18, 5
  v_add_u32 v6, s35, v6
  v_add_u32 v7, 0, v6
  v_lshrrev_b32 v8, 3, v7
  v_lshlrev_b32 v8, 10, v8
  v_and_b32 v9, 3, v7
  v_lshl_add_u32 v8, v9, 8, v8
  v_bfe_u32 v9, v7, 2, 1
  v_lshl_add_u32 v8, v9, 3, v8
  v_add_u32 v8, v8, v5
  buffer_store_dwordx2 v[68:69], v8, s[12:15], s38 offen
  v_add_u32 v7, 2, v6
  v_lshrrev_b32 v8, 3, v7
  v_lshlrev_b32 v8, 10, v8
  v_and_b32 v9, 3, v7
  v_lshl_add_u32 v8, v9, 8, v8
  v_bfe_u32 v9, v7, 2, 1
  v_lshl_add_u32 v8, v9, 3, v8
  v_add_u32 v8, v8, v5
  buffer_store_dwordx2 v[70:71], v8, s[12:15], s38 offen
  v_add_u32 v7, 4, v6
  v_lshrrev_b32 v8, 3, v7
  v_lshlrev_b32 v8, 10, v8
  v_and_b32 v9, 3, v7
  v_lshl_add_u32 v8, v9, 8, v8
  v_bfe_u32 v9, v7, 2, 1
  v_lshl_add_u32 v8, v9, 3, v8
  v_add_u32 v8, v8, v5
  s_mov_b32 exec_lo, -1
  s_mov_b32 exec_hi, 0
  buffer_store_dwordx2 v[72:73], v8, s[12:15], s38 offen
  s_endpgm
L_attn_fb:
  s_mov_b32 s39, 1
  v_cndmask_b32 v16, v16, 0, s[30:31]
  v_mov_b32 v140, 0xff800000
  v_lshlrev_b32 v4, 3, v2
  s_mov_b32 s40, s22
  s_mov_b32 s41, 0
L_attn_fb1:
  buffer_load_dwordx4 v[20:23], v3, s[12:15], s40 offen
  buffer_load_dwordx2 v[24:25], v4, s[12:15], s40 offen offset:1024
  s_waitcnt vmcnt(0)
  v_mfma_f32_32x32x16_bf16 v[52:67], v[20:23], v[8:11], 0
  v_mfma_f32_32x32x8_bf16 v[52:67], v[24:25], v[16:17], v[52:67]
  s_nop 7
  s_nop 7
  v_max3_f32 v140, v140, v52, v53
  v_max3_f32 v140, v140, v54, v55
  v_max3_f32 v140, v140, v56, v57
  v_max3_f32 v140, v140, v58, v59
  v_max3_f32 v140, v140, v60, v61
  v_max3_f32 v140, v140, v62, v63
  v_max3_f32 v140, v140, v64, v65
  v_max3_f32 v140, v140, v66, v67
  s_add_u32 s40, s40, 2880
  s_add_u32 s41, s41, 1
  s_cmp_lt_u32 s41, 64
  s_cbranch_scc1 L_attn_fb1
  v_mov_b32 v142, v140
  s_nop 1
  v_permlane32_swap_b32 v142, v140
  s_nop 1
  v_max_f32 v140, v140, v142
  v_cvt_pk_bf16_f32 v143, v140, v140
  v_lshlrev_b32 v143, 16, v143
  v_sub_f32 v144, v143, v140
  v_sub_f32 v143, 0, v143
  v_cvt_pk_bf16_f32 v143, v143, v144
  v_cndmask_b32 v16, v16, v143, s[30:31]
  v_mov_b32 v100, 0
  v_mov_b32 v101, 0
  v_mov_b32 v102, 0
  v_mov_b32 v103, 0
  v_mov_b32 v104, 0
  v_mov_b32 v105, 0
  v_mov_b32 v106, 0
  v_mov_b32 v107, 0
  v_mov_b32 v108, 0
  v_mov_b32 v109, 0
  v_mov_b32 v110, 0
  v_mov_b32 v111, 0
  v_mov_b32 v112, 0
  v_mov_b32 v113, 0
  v_mov_b32 v114, 0
  v_mov_b32 v115, 0
  s_mov_b32 s40, s22
  s_mov_b32 s41, 0
L_attn_fb2:
  buffer_load_dwordx4 v[20:23], v3, s[12:15], s40 offen
  buffer_load_dwordx2 v[24:25], v4, s[12:15], s40 offen offset:1024
  buffer_load_dwordx4 v[36:39], v5, s[12:15], s40 offen offset:1536
  buffer_load_dwordx4 v[40:43], v5, s[12:15], s40 offen offset:2208
  s_waitcnt vmcnt(0)
  v_mfma_f32_32x32x16_bf16 v[52:67], v[20:23], v[8:11], 0
  v_mfma_f32_32x32x8_bf16 v[52:67], v[24:25], v[16:17], v[52:67]
  s_nop 7
  s_nop 7
  v_exp_f32 v52, v52
  v_exp_f32 v53, v53
  v_exp_f32 v54, v54
  v_exp_f32 v55, v55
  v_cvt_pk_bf16_f32 v84, v52, v53
  v_exp_f32 v56, v56
  v_exp_f32 v57, v57
  v_cvt_pk_bf16_f32 v85, v54, v55
  v_exp_f32 v58, v58
  v_exp_f32 v59, v59
  v_cvt_pk_bf16_f32 v86, v56, v57
  v_exp_f32 v60, v60
  v_exp_f32 v61, v61
  v_cvt_pk_bf16_f32 v87, v58, v59
  v_exp_f32 v62, v62
  v_exp_f32 v63, v63
  v_cvt_pk_bf16_f32 v88, v60, v61
  v_exp_f32 v64, v64
  v_exp_f32 v65, v65
  v_cvt_pk_bf16_f32 v89, v62, v63
  v_exp_f32 v66, v66
  v_exp_f32 v67, v67
  v_cvt_pk_bf16_f32 v90, v64, v65
  v_cvt_pk_bf16_f32 v91, v66, v67
  s_nop 1
  v_mfma_f32_32x32x16_bf16 v[100:115], v[36:39], v[84:87], v[100:115]
  v_mfma_f32_32x32x16_bf16 v[100:115], v[40:43], v[88:91], v[100:115]
  s_add_u32 s40, s40, 2880
  s_add_u32 s41, s41, 1
  s_cmp_lt_u32 s41, 64
  s_cbranch_scc1 L_attn_fb2
  s_nop 7
  s_nop 7
  s_branch L_attn_norm
L_attn_end:
  s_endpgm
.globl oproj_kernel
.p2align 8
.type oproj_kernel,@function
oproj_kernel:
  s_cmp_ge_u32 s2, 256
  s_cbranch_scc1 L_oproj_kernel_end
  s_load_dwordx2 s[12:13], s[0:1], 72
  s_load_dwordx2 s[4:5], s[0:1], 0
  v_lshrrev_b32 v1, 6, v0
  v_and_b32 v2, 63, v0
  s_and_b32 s16, s2, 7
  v_readfirstlane_b32 s3, v1
  s_lshr_b32 s17, s2, 3
  s_and_b32 s18, s16, 1
  s_lshl_b32 s18, s18, 2
  s_and_b32 s19, s17, 3
  s_add_u32 s18, s18, s19
  s_lshr_b32 s19, s16, 1
  s_lshl_b32 s19, s19, 3
  s_lshr_b32 s20, s17, 2
  s_add_u32 s19, s19, s20
  v_lshlrev_b32 v3, 4, v2
  s_and_b32 s50, s17, 3
  s_mul_i32 s50, s50, 0
  s_lshr_b32 s51, s17, 2
  s_mul_i32 s51, s51, 0
  s_add_u32 s50, s50, s51
  s_mul_hi_u32 s51, s50, 429496730
  s_mul_i32 s51, s51, 10
  s_sub_u32 s50, s50, s51
  s_waitcnt lgkmcnt(0)
  s_and_b32 s13, s13, 0xffff
  s_mov_b32 s14, 32751616
  s_mov_b32 s15, 0x00020000
  s_and_b32 s5, s5, 0xffff
  s_mov_b32 s6, 2621440
  s_mov_b32 s7, 0x00020000
  s_cmp_ge_u32 s3, 4
  s_cbranch_scc0 L_oproj_kernel_loader_else
  s_sub_u32 s20, s3, 4
  s_mul_i32 s24, s18, 100
  s_lshl_b32 s24, s24, 10
  s_add_u32 s24, s24, 2457600
  s_add_u32 s25, s24, 0
  v_add_u32 v8, s25, v3
  s_add_u32 s25, s24, 20480
  v_add_u32 v9, s25, v3
  s_add_u32 s25, s24, 40960
  v_add_u32 v10, s25, v3
  s_add_u32 s25, s24, 61440
  v_add_u32 v11, s25, v3
  s_add_u32 s25, s24, 81920
  v_add_u32 v12, s25, v3
  s_lshl_b32 s26, s20, 10
  s_add_u32 s46, s26, 20480
  s_lshl_b32 s47, s50, 11
  s_add_u32 s26, s26, s47
  s_mul_i32 s27, s20, 5120
  s_add_u32 m0, s27, 0
  s_nop 0
  buffer_load_dwordx4 v8, s[12:15], s26 offen lds
  s_add_u32 m0, s27, 1024
  s_nop 0
  buffer_load_dwordx4 v9, s[12:15], s26 offen lds
  s_add_u32 m0, s27, 2048
  s_nop 0
  buffer_load_dwordx4 v10, s[12:15], s26 offen lds
  s_add_u32 m0, s27, 3072
  s_nop 0
  buffer_load_dwordx4 v11, s[12:15], s26 offen lds
  s_add_u32 m0, s27, 4096
  s_nop 0
  buffer_load_dwordx4 v12, s[12:15], s26 offen lds
  s_add_u32 s26, s26, 2048
  s_sub_u32 s47, s26, 20480
  s_cmp_ge_u32 s26, s46
  s_cselect_b32 s26, s47, s26
  s_add_u32 m0, s27, 10240
  s_nop 0
  buffer_load_dwordx4 v8, s[12:15], s26 offen lds
  s_add_u32 m0, s27, 11264
  s_nop 0
  buffer_load_dwordx4 v9, s[12:15], s26 offen lds
  s_add_u32 m0, s27, 12288
  s_nop 0
  buffer_load_dwordx4 v10, s[12:15], s26 offen lds
  s_add_u32 m0, s27, 13312
  s_nop 0
  buffer_load_dwordx4 v11, s[12:15], s26 offen lds
  s_add_u32 m0, s27, 14336
  s_nop 0
  buffer_load_dwordx4 v12, s[12:15], s26 offen lds
  s_add_u32 s26, s26, 2048
  s_sub_u32 s47, s26, 20480
  s_cmp_ge_u32 s26, s46
  s_cselect_b32 s26, s47, s26
  s_add_u32 m0, s27, 20480
  s_nop 0
  buffer_load_dwordx4 v8, s[12:15], s26 offen lds
  s_add_u32 m0, s27, 21504
  s_nop 0
  buffer_load_dwordx4 v9, s[12:15], s26 offen lds
  s_add_u32 m0, s27, 22528
  s_nop 0
  buffer_load_dwordx4 v10, s[12:15], s26 offen lds
  s_add_u32 m0, s27, 23552
  s_nop 0
  buffer_load_dwordx4 v11, s[12:15], s26 offen lds
  s_add_u32 m0, s27, 24576
  s_nop 0
  buffer_load_dwordx4 v12, s[12:15], s26 offen lds
  s_add_u32 s26, s26, 2048
  s_sub_u32 s47, s26, 20480
  s_cmp_ge_u32 s26, s46
  s_cselect_b32 s26, s47, s26
  s_waitcnt vmcnt(10)
  s_barrier
  s_add_u32 m0, s27, 30720
  s_nop 0
  buffer_load_dwordx4 v8, s[12:15], s26 offen lds
  s_add_u32 m0, s27, 31744
  s_nop 0
  buffer_load_dwordx4 v9, s[12:15], s26 offen lds
  s_add_u32 m0, s27, 32768
  s_nop 0
  buffer_load_dwordx4 v10, s[12:15], s26 offen lds
  s_add_u32 m0, s27, 33792
  s_nop 0
  buffer_load_dwordx4 v11, s[12:15], s26 offen lds
  s_add_u32 m0, s27, 34816
  s_nop 0
  buffer_load_dwordx4 v12, s[12:15], s26 offen lds
  s_add_u32 s26, s26, 2048
  s_sub_u32 s47, s26, 20480
  s_cmp_ge_u32 s26, s46
  s_cselect_b32 s26, s47, s26
  s_add_u32 m0, s27, 40960
  s_nop 0
  buffer_load_dwordx4 v8, s[12:15], s26 offen lds
  s_add_u32 m0, s27, 41984
  s_nop 0
  buffer_load_dwordx4 v9, s[12:15], s26 offen lds
  s_add_u32 m0, s27, 43008
  s_nop 0
  buffer_load_dwordx4 v10, s[12:15], s26 offen lds
  s_add_u32 m0, s27, 44032
  s_nop 0
  buffer_load_dwordx4 v11, s[12:15], s26 offen lds
  s_add_u32 m0, s27, 45056
  s_nop 0
  buffer_load_dwordx4 v12, s[12:15], s26 offen lds
  s_add_u32 s26, s26, 2048
  s_sub_u32 s47, s26, 20480
  s_cmp_ge_u32 s26, s46
  s_cselect_b32 s26, s47, s26
  s_add_u32 m0, s27, 51200
  s_nop 0
  buffer_load_dwordx4 v8, s[12:15], s26 offen lds
  s_add_u32 m0, s27, 52224
  s_nop 0
  buffer_load_dwordx4 v9, s[12:15], s26 offen lds
  s_add_u32 m0, s27, 53248
  s_nop 0
  buffer_load_dwordx4 v10, s[12:15], s26 offen lds
  s_add_u32 m0, s27, 54272
  s_nop 0
  buffer_load_dwordx4 v11, s[12:15], s26 offen lds
  s_add_u32 m0, s27, 55296
  s_nop 0
  buffer_load_dwordx4 v12, s[12:15], s26 offen lds
  s_add_u32 s26, s26, 2048
  s_sub_u32 s47, s26, 20480
  s_cmp_ge_u32 s26, s46
  s_cselect_b32 s26, s47, s26
  s_waitcnt vmcnt(20)
  s_barrier
  s_add_u32 m0, s27, 61440
  s_nop 0
  buffer_load_dwordx4 v8, s[12:15], s26 offen lds
  s_add_u32 m0, s27, 62464
  s_nop 0
  buffer_load_dwordx4 v9, s[12:15], s26 offen lds
  s_add_u32 m0, s27, 63488
  s_nop 0
  buffer_load_dwordx4 v10, s[12:15], s26 offen lds
  s_add_u32 m0, s27, 64512
  s_nop 0
  buffer_load_dwordx4 v11, s[12:15], s26 offen lds
  s_add_u32 m0, s27, 65536
  s_nop 0
  buffer_load_dwordx4 v12, s[12:15], s26 offen lds
  s_add_u32 s26, s26, 2048
  s_sub_u32 s47, s26, 20480
  s_cmp_ge_u32 s26, s46
  s_cselect_b32 s26, s47, s26
  s_add_u32 m0, s27, 71680
  s_nop 0
  buffer_load_dwordx4 v8, s[12:15], s26 offen lds
  s_add_u32 m0, s27, 72704
  s_nop 0
  buffer_load_dwordx4 v9, s[12:15], s26 offen lds
  s_add_u32 m0, s27, 73728
  s_nop 0
  buffer_load_dwordx4 v10, s[12:15], s26 offen lds
  s_add_u32 m0, s27, 74752
  s_nop 0
  buffer_load_dwordx4 v11, s[12:15], s26 offen lds
  s_add_u32 m0, s27, 75776
  s_nop 0
  buffer_load_dwordx4 v12, s[12:15], s26 offen lds
  s_add_u32 s26, s26, 2048
  s_sub_u32 s47, s26, 20480
  s_cmp_ge_u32 s26, s46
  s_cselect_b32 s26, s47, s26
  s_add_u32 m0, s27, 81920
  s_nop 0
  buffer_load_dwordx4 v8, s[12:15], s26 offen lds
  s_add_u32 m0, s27, 82944
  s_nop 0
  buffer_load_dwordx4 v9, s[12:15], s26 offen lds
  s_add_u32 m0, s27, 83968
  s_nop 0
  buffer_load_dwordx4 v10, s[12:15], s26 offen lds
  s_add_u32 m0, s27, 84992
  s_nop 0
  buffer_load_dwordx4 v11, s[12:15], s26 offen lds
  s_add_u32 m0, s27, 86016
  s_nop 0
  buffer_load_dwordx4 v12, s[12:15], s26 offen lds
  s_add_u32 s26, s26, 2048
  s_sub_u32 s47, s26, 20480
  s_cmp_ge_u32 s26, s46
  s_cselect_b32 s26, s47, s26
  s_waitcnt vmcnt(30)
  s_barrier
  s_add_u32 m0, s27, 92160
  s_nop 0
  buffer_load_dwordx4 v8, s[12:15], s26 offen lds
  s_add_u32 m0, s27, 93184
  s_nop 0
  buffer_load_dwordx4 v9, s[12:15], s26 offen lds
  s_add_u32 m0, s27, 94208
  s_nop 0
  buffer_load_dwordx4 v10, s[12:15], s26 offen lds
  s_add_u32 m0, s27, 95232
  s_nop 0
  buffer_load_dwordx4 v11, s[12:15], s26 offen lds
  s_add_u32 m0, s27, 96256
  s_nop 0
  buffer_load_dwordx4 v12, s[12:15], s26 offen lds
  s_add_u32 s26, s26, 2048
  s_sub_u32 s47, s26, 20480
  s_cmp_ge_u32 s26, s46
  s_cselect_b32 s26, s47, s26
  s_waitcnt vmcnt(30)
  s_barrier
  s_waitcnt vmcnt(25)
  s_barrier
  s_waitcnt vmcnt(20)
  s_barrier
  s_waitcnt vmcnt(15)
  s_barrier
  s_waitcnt vmcnt(10)
  s_barrier
  s_waitcnt vmcnt(5)
  s_barrier
  s_waitcnt vmcnt(0)
  s_barrier
  s_endpgm
  s_endpgm
L_oproj_kernel_loader_else:
  s_and_b32 s20, s3, 1
  s_lshr_b32 s21, s3, 1
  s_lshl_b32 s22, s19, 2
  s_lshl_b32 s23, s20, 1
  s_add_u32 s22, s22, s23
  s_mul_i32 s22, s22, 20
  s_add_u32 s22, s22, s21
  s_lshl_b32 s22, s22, 10
  s_add_u32 s22, s22, 19243008
  s_add_u32 s46, s22, 20480
  s_lshl_b32 s47, s50, 11
  s_add_u32 s22, s22, s47
  v_add_u32 v4, 20480, v3
  buffer_load_dwordx4 v[132:135], v3, s[12:15], s22 offen
  buffer_load_dwordx4 v[136:139], v4, s[12:15], s22 offen
  s_add_u32 s22, s22, 2048
  s_sub_u32 s47, s22, 20480
  s_cmp_ge_u32 s22, s46
  s_cselect_b32 s22, s47, s22
  buffer_load_dwordx4 v[140:143], v3, s[12:15], s22 offen
  buffer_load_dwordx4 v[144:147], v4, s[12:15], s22 offen
  s_add_u32 s22, s22, 2048
  s_sub_u32 s47, s22, 20480
  s_cmp_ge_u32 s22, s46
  s_cselect_b32 s22, s47, s22
  buffer_load_dwordx4 v[148:151], v3, s[12:15], s22 offen
  buffer_load_dwordx4 v[152:155], v4, s[12:15], s22 offen
  s_add_u32 s22, s22, 2048
  s_sub_u32 s47, s22, 20480
  s_cmp_ge_u32 s22, s46
  s_cselect_b32 s22, s47, s22
  buffer_load_dwordx4 v[156:159], v3, s[12:15], s22 offen
  buffer_load_dwordx4 v[160:163], v4, s[12:15], s22 offen
  s_add_u32 s22, s22, 2048
  s_sub_u32 s47, s22, 20480
  s_cmp_ge_u32 s22, s46
  s_cselect_b32 s22, s47, s22
  buffer_load_dwordx4 v[164:167], v3, s[12:15], s22 offen
  buffer_load_dwordx4 v[168:171], v4, s[12:15], s22 offen
  s_add_u32 s22, s22, 2048
  s_sub_u32 s47, s22, 20480
  s_cmp_ge_u32 s22, s46
  s_cselect_b32 s22, s47, s22
  v_and_b32 v5, 15, v2
  v_lshrrev_b32 v6, 4, v2
  s_lshl_b32 s24, s20, 1
  s_add_u32 s24, s24, s21
  s_lshl_b32 s30, s19, 6
  s_lshl_b32 s31, s24, 4
  s_add_u32 s30, s30, s31
  v_add_u32 v7, s30, v5
  v_mul_u32_u24 v36, 1280, v7
  s_mul_i32 s31, s18, 160
  v_lshl_add_u32 v36, v6, 3, v36
  v_add_u32 v36, s31, v36
  s_lshl_b32 s32, s19, 2
  s_add_u32 s32, s32, s24
  s_mul_i32 s32, s32, 20480
  s_add_u32 s32, s32, 21864448
  s_mul_i32 s33, s18, 5
  s_add_u32 s34, s33, 0
  s_lshr_b32 s35, s34, 1
  s_lshl_b32 s35, s35, 10
  s_and_b32 s34, s34, 1
  s_lshl_b32 s34, s34, 3
  s_add_u32 s35, s35, s34
  s_add_u32 s40, s35, s32
  buffer_load_dwordx2 v[40:41], v36, s[4:7], 0 offen offset:0
  s_add_u32 s34, s33, 1
  s_lshr_b32 s35, s34, 1
  s_lshl_b32 s35, s35, 10
  s_and_b32 s34, s34, 1
  s_lshl_b32 s34, s34, 3
  s_add_u32 s35, s35, s34
  s_add_u32 s41, s35, s32
  buffer_load_dwordx2 v[42:43], v36, s[4:7], 0 offen offset:32
  s_add_u32 s34, s33, 2
  s_lshr_b32 s35, s34, 1
  s_lshl_b32 s35, s35, 10
  s_and_b32 s34, s34, 1
  s_lshl_b32 s34, s34, 3
  s_add_u32 s35, s35, s34
  s_add_u32 s42, s35, s32
  buffer_load_dwordx2 v[44:45], v36, s[4:7], 0 offen offset:64
  s_add_u32 s34, s33, 3
  s_lshr_b32 s35, s34, 1
  s_lshl_b32 s35, s35, 10
  s_and_b32 s34, s34, 1
  s_lshl_b32 s34, s34, 3
  s_add_u32 s35, s35, s34
  s_add_u32 s43, s35, s32
  buffer_load_dwordx2 v[46:47], v36, s[4:7], 0 offen offset:96
  s_add_u32 s34, s33, 4
  s_lshr_b32 s35, s34, 1
  s_lshl_b32 s35, s35, 10
  s_and_b32 s34, s34, 1
  s_lshl_b32 s34, s34, 3
  s_add_u32 s35, s35, s34
  s_add_u32 s44, s35, s32
  buffer_load_dwordx2 v[48:49], v36, s[4:7], 0 offen offset:128
  v_mov_b32 v52, 0
  v_mov_b32 v53, 0
  v_mov_b32 v54, 0
  v_mov_b32 v55, 0
  v_mov_b32 v56, 0
  v_mov_b32 v57, 0
  v_mov_b32 v58, 0
  v_mov_b32 v59, 0
  v_mov_b32 v60, 0
  v_mov_b32 v61, 0
  v_mov_b32 v62, 0
  v_mov_b32 v63, 0
  v_mov_b32 v64, 0
  v_mov_b32 v65, 0
  v_mov_b32 v66, 0
  v_mov_b32 v67, 0
  v_mov_b32 v68, 0
  v_mov_b32 v69, 0
  v_mov_b32 v70, 0
  v_mov_b32 v71, 0
  v_mov_b32 v72, 0
  v_mov_b32 v73, 0
  v_mov_b32 v74, 0
  v_mov_b32 v75, 0
  v_mov_b32 v76, 0
  v_mov_b32 v77, 0
  v_mov_b32 v78, 0
  v_mov_b32 v79, 0
  v_mov_b32 v80, 0
  v_mov_b32 v81, 0
  v_mov_b32 v82, 0
  v_mov_b32 v83, 0
  v_mov_b32 v84, 0
  v_mov_b32 v85, 0
  v_mov_b32 v86, 0
  v_mov_b32 v87, 0
  v_mov_b32 v88, 0
  v_mov_b32 v89, 0
  v_mov_b32 v90, 0
  v_mov_b32 v91, 0
  s_mul_i32 s25, s21, 5120
  v_add_u32 v8, s25, v3
  v_add_u32 v9, 61440, v8
  v_add_u32 v12, 122880, v8
  s_barrier
  ds_read_b128 v[92:95], v8 offset:0
  ds_read_b128 v[96:99], v8 offset:1024
  ds_read_b128 v[100:103], v8 offset:2048
  ds_read_b128 v[104:107], v8 offset:3072
  ds_read_b128 v[108:111], v8 offset:4096
  s_waitcnt lgkmcnt(0)
  s_barrier
  ds_read_b128 v[112:115], v8 offset:10240
  ds_read_b128 v[116:119], v8 offset:11264
  ds_read_b128 v[120:123], v8 offset:12288
  ds_read_b128 v[124:127], v8 offset:13312
  ds_read_b128 v[128:131], v8 offset:14336
  s_waitcnt vmcnt(13)
  v_mfma_f32_16x16x32_bf16 v[52:55], v[92:95], v[132:135], v[52:55]
  v_mfma_f32_16x16x32_bf16 v[56:59], v[96:99], v[132:135], v[56:59]
  v_mfma_f32_16x16x32_bf16 v[60:63], v[100:103], v[132:135], v[60:63]
  v_mfma_f32_16x16x32_bf16 v[64:67], v[104:107], v[132:135], v[64:67]
  v_mfma_f32_16x16x32_bf16 v[68:71], v[108:111], v[132:135], v[68:71]
  v_mfma_f32_16x16x32_bf16 v[72:75], v[92:95], v[136:139], v[72:75]
  v_mfma_f32_16x16x32_bf16 v[76:79], v[96:99], v[136:139], v[76:79]
  v_mfma_f32_16x16x32_bf16 v[80:83], v[100:103], v[136:139], v[80:83]
  v_mfma_f32_16x16x32_bf16 v[84:87], v[104:107], v[136:139], v[84:87]
  v_mfma_f32_16x16x32_bf16 v[88:91], v[108:111], v[136:139], v[88:91]
  buffer_load_dwordx4 v[132:135], v3, s[12:15], s22 offen
  buffer_load_dwordx4 v[136:139], v4, s[12:15], s22 offen
  s_add_u32 s22, s22, 2048
  s_sub_u32 s47, s22, 20480
  s_cmp_ge_u32 s22, s46
  s_cselect_b32 s22, s47, s22
  s_waitcnt lgkmcnt(0)
  s_barrier
  ds_read_b128 v[92:95], v8 offset:20480
  ds_read_b128 v[96:99], v8 offset:21504
  ds_read_b128 v[100:103], v8 offset:22528
  ds_read_b128 v[104:107], v8 offset:23552
  ds_read_b128 v[108:111], v8 offset:24576
  s_waitcnt vmcnt(13)
  v_mfma_f32_16x16x32_bf16 v[52:55], v[112:115], v[140:143], v[52:55]
  v_mfma_f32_16x16x32_bf16 v[56:59], v[116:119], v[140:143], v[56:59]
  v_mfma_f32_16x16x32_bf16 v[60:63], v[120:123], v[140:143], v[60:63]
  v_mfma_f32_16x16x32_bf16 v[64:67], v[124:127], v[140:143], v[64:67]
  v_mfma_f32_16x16x32_bf16 v[68:71], v[128:131], v[140:143], v[68:71]
  v_mfma_f32_16x16x32_bf16 v[72:75], v[112:115], v[144:147], v[72:75]
  v_mfma_f32_16x16x32_bf16 v[76:79], v[116:119], v[144:147], v[76:79]
  v_mfma_f32_16x16x32_bf16 v[80:83], v[120:123], v[144:147], v[80:83]
  v_mfma_f32_16x16x32_bf16 v[84:87], v[124:127], v[144:147], v[84:87]
  v_mfma_f32_16x16x32_bf16 v[88:91], v[128:131], v[144:147], v[88:91]
  buffer_load_dwordx4 v[140:143], v3, s[12:15], s22 offen
  buffer_load_dwordx4 v[144:147], v4, s[12:15], s22 offen
  s_add_u32 s22, s22, 2048
  s_sub_u32 s47, s22, 20480
  s_cmp_ge_u32 s22, s46
  s_cselect_b32 s22, s47, s22
  s_waitcnt lgkmcnt(0)
  s_barrier
  ds_read_b128 v[112:115], v8 offset:30720
  ds_read_b128 v[116:119], v8 offset:31744
  ds_read_b128 v[120:123], v8 offset:32768
  ds_read_b128 v[124:127], v8 offset:33792
  ds_read_b128 v[128:131], v8 offset:34816
  s_waitcnt vmcnt(13)
  v_mfma_f32_16x16x32_bf16 v[52:55], v[92:95], v[148:151], v[52:55]
  v_mfma_f32_16x16x32_bf16 v[56:59], v[96:99], v[148:151], v[56:59]
  v_mfma_f32_16x16x32_bf16 v[60:63], v[100:103], v[148:151], v[60:63]
  v_mfma_f32_16x16x32_bf16 v[64:67], v[104:107], v[148:151], v[64:67]
  v_mfma_f32_16x16x32_bf16 v[68:71], v[108:111], v[148:151], v[68:71]
  v_mfma_f32_16x16x32_bf16 v[72:75], v[92:95], v[152:155], v[72:75]
  v_mfma_f32_16x16x32_bf16 v[76:79], v[96:99], v[152:155], v[76:79]
  v_mfma_f32_16x16x32_bf16 v[80:83], v[100:103], v[152:155], v[80:83]
  v_mfma_f32_16x16x32_bf16 v[84:87], v[104:107], v[152:155], v[84:87]
  v_mfma_f32_16x16x32_bf16 v[88:91], v[108:111], v[152:155], v[88:91]
  buffer_load_dwordx4 v[148:151], v3, s[12:15], s22 offen
  buffer_load_dwordx4 v[152:155], v4, s[12:15], s22 offen
  s_add_u32 s22, s22, 2048
  s_sub_u32 s47, s22, 20480
  s_cmp_ge_u32 s22, s46
  s_cselect_b32 s22, s47, s22
  s_waitcnt lgkmcnt(0)
  s_barrier
  ds_read_b128 v[92:95], v8 offset:40960
  ds_read_b128 v[96:99], v8 offset:41984
  ds_read_b128 v[100:103], v8 offset:43008
  ds_read_b128 v[104:107], v8 offset:44032
  ds_read_b128 v[108:111], v8 offset:45056
  s_waitcnt vmcnt(13)
  v_mfma_f32_16x16x32_bf16 v[52:55], v[112:115], v[156:159], v[52:55]
  v_mfma_f32_16x16x32_bf16 v[56:59], v[116:119], v[156:159], v[56:59]
  v_mfma_f32_16x16x32_bf16 v[60:63], v[120:123], v[156:159], v[60:63]
  v_mfma_f32_16x16x32_bf16 v[64:67], v[124:127], v[156:159], v[64:67]
  v_mfma_f32_16x16x32_bf16 v[68:71], v[128:131], v[156:159], v[68:71]
  v_mfma_f32_16x16x32_bf16 v[72:75], v[112:115], v[160:163], v[72:75]
  v_mfma_f32_16x16x32_bf16 v[76:79], v[116:119], v[160:163], v[76:79]
  v_mfma_f32_16x16x32_bf16 v[80:83], v[120:123], v[160:163], v[80:83]
  v_mfma_f32_16x16x32_bf16 v[84:87], v[124:127], v[160:163], v[84:87]
  v_mfma_f32_16x16x32_bf16 v[88:91], v[128:131], v[160:163], v[88:91]
  buffer_load_dwordx4 v[156:159], v3, s[12:15], s22 offen
  buffer_load_dwordx4 v[160:163], v4, s[12:15], s22 offen
  s_add_u32 s22, s22, 2048
  s_sub_u32 s47, s22, 20480
  s_cmp_ge_u32 s22, s46
  s_cselect_b32 s22, s47, s22
  s_waitcnt lgkmcnt(0)
  s_barrier
  ds_read_b128 v[112:115], v8 offset:51200
  ds_read_b128 v[116:119], v8 offset:52224
  ds_read_b128 v[120:123], v8 offset:53248
  ds_read_b128 v[124:127], v8 offset:54272
  ds_read_b128 v[128:131], v8 offset:55296
  s_waitcnt vmcnt(13)
  v_mfma_f32_16x16x32_bf16 v[52:55], v[92:95], v[164:167], v[52:55]
  v_mfma_f32_16x16x32_bf16 v[56:59], v[96:99], v[164:167], v[56:59]
  v_mfma_f32_16x16x32_bf16 v[60:63], v[100:103], v[164:167], v[60:63]
  v_mfma_f32_16x16x32_bf16 v[64:67], v[104:107], v[164:167], v[64:67]
  v_mfma_f32_16x16x32_bf16 v[68:71], v[108:111], v[164:167], v[68:71]
  v_mfma_f32_16x16x32_bf16 v[72:75], v[92:95], v[168:171], v[72:75]
  v_mfma_f32_16x16x32_bf16 v[76:79], v[96:99], v[168:171], v[76:79]
  v_mfma_f32_16x16x32_bf16 v[80:83], v[100:103], v[168:171], v[80:83]
  v_mfma_f32_16x16x32_bf16 v[84:87], v[104:107], v[168:171], v[84:87]
  v_mfma_f32_16x16x32_bf16 v[88:91], v[108:111], v[168:171], v[88:91]
  buffer_load_dwordx4 v[164:167], v3, s[12:15], s22 offen
  buffer_load_dwordx4 v[168:171], v4, s[12:15], s22 offen
  s_add_u32 s22, s22, 2048
  s_sub_u32 s47, s22, 20480
  s_cmp_ge_u32 s22, s46
  s_cselect_b32 s22, s47, s22
  s_waitcnt lgkmcnt(0)
  s_barrier
  ds_read_b128 v[92:95], v9 offset:0
  ds_read_b128 v[96:99], v9 offset:1024
  ds_read_b128 v[100:103], v9 offset:2048
  ds_read_b128 v[104:107], v9 offset:3072
  ds_read_b128 v[108:111], v9 offset:4096
  s_waitcnt vmcnt(8)
  v_mfma_f32_16x16x32_bf16 v[52:55], v[112:115], v[132:135], v[52:55]
  v_mfma_f32_16x16x32_bf16 v[56:59], v[116:119], v[132:135], v[56:59]
  v_mfma_f32_16x16x32_bf16 v[60:63], v[120:123], v[132:135], v[60:63]
  v_mfma_f32_16x16x32_bf16 v[64:67], v[124:127], v[132:135], v[64:67]
  v_mfma_f32_16x16x32_bf16 v[68:71], v[128:131], v[132:135], v[68:71]
  v_mfma_f32_16x16x32_bf16 v[72:75], v[112:115], v[136:139], v[72:75]
  v_mfma_f32_16x16x32_bf16 v[76:79], v[116:119], v[136:139], v[76:79]
  v_mfma_f32_16x16x32_bf16 v[80:83], v[120:123], v[136:139], v[80:83]
  v_mfma_f32_16x16x32_bf16 v[84:87], v[124:127], v[136:139], v[84:87]
  v_mfma_f32_16x16x32_bf16 v[88:91], v[128:131], v[136:139], v[88:91]
  s_waitcnt lgkmcnt(0)
  s_barrier
  ds_read_b128 v[112:115], v9 offset:10240
  ds_read_b128 v[116:119], v9 offset:11264
  ds_read_b128 v[120:123], v9 offset:12288
  ds_read_b128 v[124:127], v9 offset:13312
  ds_read_b128 v[128:131], v9 offset:14336
  s_waitcnt vmcnt(6)
  v_mfma_f32_16x16x32_bf16 v[52:55], v[92:95], v[140:143], v[52:55]
  v_mfma_f32_16x16x32_bf16 v[56:59], v[96:99], v[140:143], v[56:59]
  v_mfma_f32_16x16x32_bf16 v[60:63], v[100:103], v[140:143], v[60:63]
  v_mfma_f32_16x16x32_bf16 v[64:67], v[104:107], v[140:143], v[64:67]
  v_mfma_f32_16x16x32_bf16 v[68:71], v[108:111], v[140:143], v[68:71]
  v_mfma_f32_16x16x32_bf16 v[72:75], v[92:95], v[144:147], v[72:75]
  v_mfma_f32_16x16x32_bf16 v[76:79], v[96:99], v[144:147], v[76:79]
  v_mfma_f32_16x16x32_bf16 v[80:83], v[100:103], v[144:147], v[80:83]
  v_mfma_f32_16x16x32_bf16 v[84:87], v[104:107], v[144:147], v[84:87]
  v_mfma_f32_16x16x32_bf16 v[88:91], v[108:111], v[144:147], v[88:91]
  s_waitcnt lgkmcnt(0)
  s_barrier
  ds_read_b128 v[92:95], v9 offset:20480
  ds_read_b128 v[96:99], v9 offset:21504
  ds_read_b128 v[100:103], v9 offset:22528
  ds_read_b128 v[104:107], v9 offset:23552
  ds_read_b128 v[108:111], v9 offset:24576
  s_waitcnt vmcnt(4)
  v_mfma_f32_16x16x32_bf16 v[52:55], v[112:115], v[148:151], v[52:55]
  v_mfma_f32_16x16x32_bf16 v[56:59], v[116:119], v[148:151], v[56:59]
  v_mfma_f32_16x16x32_bf16 v[60:63], v[120:123], v[148:151], v[60:63]
  v_mfma_f32_16x16x32_bf16 v[64:67], v[124:127], v[148:151], v[64:67]
  v_mfma_f32_16x16x32_bf16 v[68:71], v[128:131], v[148:151], v[68:71]
  v_mfma_f32_16x16x32_bf16 v[72:75], v[112:115], v[152:155], v[72:75]
  v_mfma_f32_16x16x32_bf16 v[76:79], v[116:119], v[152:155], v[76:79]
  v_mfma_f32_16x16x32_bf16 v[80:83], v[120:123], v[152:155], v[80:83]
  v_mfma_f32_16x16x32_bf16 v[84:87], v[124:127], v[152:155], v[84:87]
  v_mfma_f32_16x16x32_bf16 v[88:91], v[128:131], v[152:155], v[88:91]
  s_waitcnt lgkmcnt(0)
  s_barrier
  ds_read_b128 v[112:115], v9 offset:30720
  ds_read_b128 v[116:119], v9 offset:31744
  ds_read_b128 v[120:123], v9 offset:32768
  ds_read_b128 v[124:127], v9 offset:33792
  ds_read_b128 v[128:131], v9 offset:34816
  s_waitcnt vmcnt(2)
  v_mfma_f32_16x16x32_bf16 v[52:55], v[92:95], v[156:159], v[52:55]
  v_mfma_f32_16x16x32_bf16 v[56:59], v[96:99], v[156:159], v[56:59]
  v_mfma_f32_16x16x32_bf16 v[60:63], v[100:103], v[156:159], v[60:63]
  v_mfma_f32_16x16x32_bf16 v[64:67], v[104:107], v[156:159], v[64:67]
  v_mfma_f32_16x16x32_bf16 v[68:71], v[108:111], v[156:159], v[68:71]
  v_mfma_f32_16x16x32_bf16 v[72:75], v[92:95], v[160:163], v[72:75]
  v_mfma_f32_16x16x32_bf16 v[76:79], v[96:99], v[160:163], v[76:79]
  v_mfma_f32_16x16x32_bf16 v[80:83], v[100:103], v[160:163], v[80:83]
  v_mfma_f32_16x16x32_bf16 v[84:87], v[104:107], v[160:163], v[84:87]
  v_mfma_f32_16x16x32_bf16 v[88:91], v[108:111], v[160:163], v[88:91]
  s_waitcnt lgkmcnt(0)
  s_waitcnt vmcnt(0)
  v_mfma_f32_16x16x32_bf16 v[52:55], v[112:115], v[164:167], v[52:55]
  v_mfma_f32_16x16x32_bf16 v[56:59], v[116:119], v[164:167], v[56:59]
  v_mfma_f32_16x16x32_bf16 v[60:63], v[120:123], v[164:167], v[60:63]
  v_mfma_f32_16x16x32_bf16 v[64:67], v[124:127], v[164:167], v[64:67]
  v_mfma_f32_16x16x32_bf16 v[68:71], v[128:131], v[164:167], v[68:71]
  v_mfma_f32_16x16x32_bf16 v[72:75], v[112:115], v[168:171], v[72:75]
  v_mfma_f32_16x16x32_bf16 v[76:79], v[116:119], v[168:171], v[76:79]
  v_mfma_f32_16x16x32_bf16 v[80:83], v[120:123], v[168:171], v[80:83]
  v_mfma_f32_16x16x32_bf16 v[84:87], v[124:127], v[168:171], v[84:87]
  v_mfma_f32_16x16x32_bf16 v[88:91], v[128:131], v[168:171], v[88:91]
  s_mul_i32 s26, s3, 5120
  s_xor_b32 s27, s3, 2
  s_mul_i32 s27, s27, 5120
  s_add_u32 s26, s26, 122880
  s_add_u32 s27, s27, 122880
  v_add_u32 v10, s26, v3
  v_add_u32 v11, s27, v3
  s_cmp_eq_u32 s21, 0
  s_cbranch_scc0 L_oproj_kernel_k1
  s_nop 2
  ds_write_b128 v10, v[72:75] offset:0
  ds_write_b128 v10, v[76:79] offset:1024
  ds_write_b128 v10, v[80:83] offset:2048
  ds_write_b128 v10, v[84:87] offset:3072
  ds_write_b128 v10, v[88:91] offset:4096
  s_waitcnt lgkmcnt(0)
  s_barrier
  ds_read_b128 v[72:75], v11 offset:0
  ds_read_b128 v[76:79], v11 offset:1024
  ds_read_b128 v[80:83], v11 offset:2048
  ds_read_b128 v[84:87], v11 offset:3072
  ds_read_b128 v[88:91], v11 offset:4096
  s_waitcnt lgkmcnt(0) vmcnt(0)
  v_add_f32 v16, v52, v72
  v_add_f32 v17, v53, v73
  v_add_f32 v18, v54, v74
  v_add_f32 v19, v55, v75
  v_add_f32 v20, v56, v76
  v_add_f32 v21, v57, v77
  v_add_f32 v22, v58, v78
  v_add_f32 v23, v59, v79
  v_add_f32 v24, v60, v80
  v_add_f32 v25, v61, v81
  v_add_f32 v26, v62, v82
  v_add_f32 v27, v63, v83
  v_add_f32 v28, v64, v84
  v_add_f32 v29, v65, v85
  v_add_f32 v30, v66, v86
  v_add_f32 v31, v67, v87
  v_add_f32 v32, v68, v88
  v_add_f32 v33, v69, v89
  v_add_f32 v34, v70, v90
  v_add_f32 v35, v71, v91
  s_branch L_oproj_kernel_k2
L_oproj_kernel_k1:
  s_nop 2
  ds_write_b128 v10, v[52:55] offset:0
  ds_write_b128 v10, v[56:59] offset:1024
  ds_write_b128 v10, v[60:63] offset:2048
  ds_write_b128 v10, v[64:67] offset:3072
  ds_write_b128 v10, v[68:71] offset:4096
  s_waitcnt lgkmcnt(0)
  s_barrier
  ds_read_b128 v[52:55], v11 offset:0
  ds_read_b128 v[56:59], v11 offset:1024
  ds_read_b128 v[60:63], v11 offset:2048
  ds_read_b128 v[64:67], v11 offset:3072
  ds_read_b128 v[68:71], v11 offset:4096
  s_waitcnt lgkmcnt(0) vmcnt(0)
  v_add_f32 v16, v72, v52
  v_add_f32 v17, v73, v53
  v_add_f32 v18, v74, v54
  v_add_f32 v19, v75, v55
  v_add_f32 v20, v76, v56
  v_add_f32 v21, v77, v57
  v_add_f32 v22, v78, v58
  v_add_f32 v23, v79, v59
  v_add_f32 v24, v80, v60
  v_add_f32 v25, v81, v61
  v_add_f32 v26, v82, v62
  v_add_f32 v27, v83, v63
  v_add_f32 v28, v84, v64
  v_add_f32 v29, v85, v65
  v_add_f32 v30, v86, v66
  v_add_f32 v31, v87, v67
  v_add_f32 v32, v88, v68
  v_add_f32 v33, v89, v69
  v_add_f32 v34, v90, v70
  v_add_f32 v35, v91, v71
L_oproj_kernel_k2:
  v_cvt_pk_bf16_f32 v8, v16, v17
  v_lshlrev_b32 v9, 16, v40
  v_and_b32 v10, 0xffff0000, v40
  v_lshlrev_b32 v16, 16, v8
  v_and_b32 v17, 0xffff0000, v8
  v_add_f32 v16, v16, v9
  v_add_f32 v17, v17, v10
  v_cvt_pk_bf16_f32 v40, v16, v17
  v_cvt_pk_bf16_f32 v8, v18, v19
  v_lshlrev_b32 v9, 16, v41
  v_and_b32 v10, 0xffff0000, v41
  v_lshlrev_b32 v18, 16, v8
  v_and_b32 v19, 0xffff0000, v8
  v_add_f32 v18, v18, v9
  v_add_f32 v19, v19, v10
  v_cvt_pk_bf16_f32 v41, v18, v19
  buffer_store_dwordx2 v[40:41], v3, s[12:15], s40 offen
  v_cvt_pk_bf16_f32 v8, v20, v21
  v_lshlrev_b32 v9, 16, v42
  v_and_b32 v10, 0xffff0000, v42
  v_lshlrev_b32 v20, 16, v8
  v_and_b32 v21, 0xffff0000, v8
  v_add_f32 v20, v20, v9
  v_add_f32 v21, v21, v10
  v_cvt_pk_bf16_f32 v42, v20, v21
  v_cvt_pk_bf16_f32 v8, v22, v23
  v_lshlrev_b32 v9, 16, v43
  v_and_b32 v10, 0xffff0000, v43
  v_lshlrev_b32 v22, 16, v8
  v_and_b32 v23, 0xffff0000, v8
  v_add_f32 v22, v22, v9
  v_add_f32 v23, v23, v10
  v_cvt_pk_bf16_f32 v43, v22, v23
  buffer_store_dwordx2 v[42:43], v3, s[12:15], s41 offen
  v_cvt_pk_bf16_f32 v8, v24, v25
  v_lshlrev_b32 v9, 16, v44
  v_and_b32 v10, 0xffff0000, v44
  v_lshlrev_b32 v24, 16, v8
  v_and_b32 v25, 0xffff0000, v8
  v_add_f32 v24, v24, v9
  v_add_f32 v25, v25, v10
  v_cvt_pk_bf16_f32 v44, v24, v25
  v_cvt_pk_bf16_f32 v8, v26, v27
  v_lshlrev_b32 v9, 16, v45
  v_and_b32 v10, 0xffff0000, v45
  v_lshlrev_b32 v26, 16, v8
  v_and_b32 v27, 0xffff0000, v8
  v_add_f32 v26, v26, v9
  v_add_f32 v27, v27, v10
  v_cvt_pk_bf16_f32 v45, v26, v27
  buffer_store_dwordx2 v[44:45], v3, s[12:15], s42 offen
  v_cvt_pk_bf16_f32 v8, v28, v29
  v_lshlrev_b32 v9, 16, v46
  v_and_b32 v10, 0xffff0000, v46
  v_lshlrev_b32 v28, 16, v8
  v_and_b32 v29, 0xffff0000, v8
  v_add_f32 v28, v28, v9
  v_add_f32 v29, v29, v10
  v_cvt_pk_bf16_f32 v46, v28, v29
  v_cvt_pk_bf16_f32 v8, v30, v31
  v_lshlrev_b32 v9, 16, v47
  v_and_b32 v10, 0xffff0000, v47
  v_lshlrev_b32 v30, 16, v8
  v_and_b32 v31, 0xffff0000, v8
  v_add_f32 v30, v30, v9
  v_add_f32 v31, v31, v10
  v_cvt_pk_bf16_f32 v47, v30, v31
  buffer_store_dwordx2 v[46:47], v3, s[12:15], s43 offen
  v_cvt_pk_bf16_f32 v8, v32, v33
  v_lshlrev_b32 v9, 16, v48
  v_and_b32 v10, 0xffff0000, v48
  v_lshlrev_b32 v32, 16, v8
  v_and_b32 v33, 0xffff0000, v8
  v_add_f32 v32, v32, v9
  v_add_f32 v33, v33, v10
  v_cvt_pk_bf16_f32 v48, v32, v33
  v_cvt_pk_bf16_f32 v8, v34, v35
  v_lshlrev_b32 v9, 16, v49
  v_and_b32 v10, 0xffff0000, v49
  v_lshlrev_b32 v34, 16, v8
  v_and_b32 v35, 0xffff0000, v8
  v_add_f32 v34, v34, v9
  v_add_f32 v35, v35, v10
  v_cvt_pk_bf16_f32 v49, v34, v35
  buffer_store_dwordx2 v[48:49], v3, s[12:15], s44 offen
  v_mov_b32 v8, 0
  v_mov_b32 v9, 0
  v_mov_b32 v10, 1065369472
  v_dot2c_f32_bf16 v8, v40, v10
  v_dot2c_f32_bf16 v9, v40, v40
  v_dot2c_f32_bf16 v8, v41, v10
  v_dot2c_f32_bf16 v9, v41, v41
  v_dot2c_f32_bf16 v8, v42, v10
  v_dot2c_f32_bf16 v9, v42, v42
  v_dot2c_f32_bf16 v8, v43, v10
  v_dot2c_f32_bf16 v9, v43, v43
  v_dot2c_f32_bf16 v8, v44, v10
  v_dot2c_f32_bf16 v9, v44, v44
  v_dot2c_f32_bf16 v8, v45, v10
  v_dot2c_f32_bf16 v9, v45, v45
  v_dot2c_f32_bf16 v8, v46, v10
  v_dot2c_f32_bf16 v9, v46, v46
  v_dot2c_f32_bf16 v8, v47, v10
  v_dot2c_f32_bf16 v9, v47, v47
  v_dot2c_f32_bf16 v8, v48, v10
  v_dot2c_f32_bf16 v9, v48, v48
  v_dot2c_f32_bf16 v8, v49, v10
  v_dot2c_f32_bf16 v9, v49, v49
  s_nop 2
  ds_swizzle_b32 v11, v8 offset:0x401F
  ds_swizzle_b32 v12, v9 offset:0x401F
  s_waitcnt lgkmcnt(0)
  v_add_f32 v8, v8, v11
  v_add_f32 v9, v9, v12
  v_mov_b32 v11, v8
  v_mov_b32 v12, v9
  s_nop 1
  v_permlane32_swap_b32 v11, v8
  v_permlane32_swap_b32 v12, v9
  s_nop 1
  v_add_f32 v8, v8, v11
  v_add_f32 v9, v9, v12
  v_lshlrev_b32 v4, 6, v7
  s_lshl_b32 s34, s18, 3
  s_add_u32 s34, s34, 24485888
  v_cmp_gt_u32 vcc, 16, v2
  s_nop 2
  s_and_saveexec_b64 s[36:37], vcc
  buffer_store_dwordx2 v[8:9], v4, s[12:15], s34 offen
  s_endpgm
L_oproj_kernel_end:
  s_endpgm
.globl gateup_kernel
.p2align 8
.type gateup_kernel,@function
gateup_kernel:
  s_cmp_ge_u32 s2, 256
  s_cbranch_scc1 L_gu_end
  s_load_dwordx2 s[12:13], s[0:1], 72
  v_lshrrev_b32 v1, 6, v0
  v_and_b32 v95, 63, v0
  v_mov_b32 v94, v0
  s_and_b32 s16, s2, 7
  v_readfirstlane_b32 s3, v1
  s_lshr_b32 s17, s2, 3
  s_and_b32 s18, s16, 3
  s_lshl_b32 s18, s18, 2
  s_and_b32 s19, s17, 3
  s_add_u32 s18, s18, s19
  s_lshr_b32 s19, s16, 2
  s_lshl_b32 s19, s19, 3
  s_lshr_b32 s20, s17, 2
  s_add_u32 s19, s19, s20
  v_lshlrev_b32 v0, 4, v95
  s_mul_i32 s21, s18, 7
  s_sub_u32 s22, s18, 12
  s_max_i32 s22, s22, 0
  s_sub_u32 s21, s21, s22
  s_cmp_ge_u32 s18, 12
  s_cselect_b32 s22, 6, 7
  s_mov_b32 s14, 32751616
  s_mov_b32 s15, 0x00020000
  s_cmp_ge_u32 s3, 4
  s_cbranch_scc0 L_gu_loader_else
  s_mul_i32 s23, s21, 20480
  s_mov_b32 s24, 3276800
  s_cmp_eq_u32 s3, 5
  s_cselect_b32 s24, 5488640, s24
  s_add_u32 s23, s23, s24
  s_sub_u32 s25, s3, 4
  s_mul_i32 s25, s25, 10240
  s_waitcnt lgkmcnt(0)
  s_and_b32 s13, s13, 0xffff
  s_mul_i32 s40, s17, 69120
  s_sub_u32 s41, s3, 4
  s_mul_i32 s42, s41, 34816
  s_add_u32 s40, s40, s42
  s_add_u32 s40, s40, 7700480
  s_lshl_b32 s41, s41, 10
  s_add_u32 s41, s41, 144384
  s_add_u32 m0, s25, 0
  s_add_u32 s28, s23, 0
  buffer_load_dwordx4 v0, s[12:15], s28 offen lds
  buffer_load_dwordx4 v0, s[12:15], s28 offen offset:1024 lds
  buffer_load_dwordx4 v0, s[12:15], s28 offen offset:2048 lds
  buffer_load_dwordx4 v0, s[12:15], s28 offen offset:3072 lds
  s_add_u32 m0, s25, 4096
  s_add_u32 s28, s23, 4096
  buffer_load_dwordx4 v0, s[12:15], s28 offen lds
  buffer_load_dwordx4 v0, s[12:15], s28 offen offset:1024 lds
  buffer_load_dwordx4 v0, s[12:15], s28 offen offset:2048 lds
  buffer_load_dwordx4 v0, s[12:15], s28 offen offset:3072 lds
  s_add_u32 m0, s25, 8192
  s_add_u32 s28, s23, 8192
  buffer_load_dwordx4 v0, s[12:15], s28 offen lds
  buffer_load_dwordx4 v0, s[12:15], s28 offen offset:1024 lds
  s_add_u32 m0, s25, 20480
  s_add_u32 s28, s23, 20480
  buffer_load_dwordx4 v0, s[12:15], s28 offen lds
  buffer_load_dwordx4 v0, s[12:15], s28 offen offset:1024 lds
  buffer_load_dwordx4 v0, s[12:15], s28 offen offset:2048 lds
  buffer_load_dwordx4 v0, s[12:15], s28 offen offset:3072 lds
  s_add_u32 m0, s25, 24576
  s_add_u32 s28, s23, 24576
  buffer_load_dwordx4 v0, s[12:15], s28 offen lds
  buffer_load_dwordx4 v0, s[12:15], s28 offen offset:1024 lds
  buffer_load_dwordx4 v0, s[12:15], s28 offen offset:2048 lds
  buffer_load_dwordx4 v0, s[12:15], s28 offen offset:3072 lds
  s_add_u32 m0, s25, 28672
  s_add_u32 s28, s23, 28672
  buffer_load_dwordx4 v0, s[12:15], s28 offen lds
  buffer_load_dwordx4 v0, s[12:15], s28 offen offset:1024 lds
  s_add_u32 m0, s25, 40960
  s_add_u32 s28, s23, 10240
  buffer_load_dwordx4 v0, s[12:15], s28 offen lds
  buffer_load_dwordx4 v0, s[12:15], s28 offen offset:1024 lds
  buffer_load_dwordx4 v0, s[12:15], s28 offen offset:2048 lds
  buffer_load_dwordx4 v0, s[12:15], s28 offen offset:3072 lds
  s_add_u32 m0, s25, 45056
  s_add_u32 s28, s23, 14336
  buffer_load_dwordx4 v0, s[12:15], s28 offen lds
  buffer_load_dwordx4 v0, s[12:15], s28 offen offset:1024 lds
  buffer_load_dwordx4 v0, s[12:15], s28 offen offset:2048 lds
  buffer_load_dwordx4 v0, s[12:15], s28 offen offset:3072 lds
  s_add_u32 m0, s25, 49152
  s_add_u32 s28, s23, 18432
  buffer_load_dwordx4 v0, s[12:15], s28 offen lds
  buffer_load_dwordx4 v0, s[12:15], s28 offen offset:1024 lds
  s_waitcnt vmcnt(20)
  s_barrier
  s_add_u32 m0, s25, 61440
  s_add_u32 s28, s23, 30720
  buffer_load_dwordx4 v0, s[12:15], s28 offen lds
  buffer_load_dwordx4 v0, s[12:15], s28 offen offset:1024 lds
  buffer_load_dwordx4 v0, s[12:15], s28 offen offset:2048 lds
  buffer_load_dwordx4 v0, s[12:15], s28 offen offset:3072 lds
  s_add_u32 m0, s25, 65536
  s_add_u32 s28, s23, 34816
  buffer_load_dwordx4 v0, s[12:15], s28 offen lds
  buffer_load_dwordx4 v0, s[12:15], s28 offen offset:1024 lds
  buffer_load_dwordx4 v0, s[12:15], s28 offen offset:2048 lds
  buffer_load_dwordx4 v0, s[12:15], s28 offen offset:3072 lds
  s_add_u32 m0, s25, 69632
  s_add_u32 s28, s23, 38912
  buffer_load_dwordx4 v0, s[12:15], s28 offen lds
  buffer_load_dwordx4 v0, s[12:15], s28 offen offset:1024 lds
  s_add_u32 m0, s25, 81920
  s_add_u32 s28, s23, 40960
  buffer_load_dwordx4 v0, s[12:15], s28 offen lds
  buffer_load_dwordx4 v0, s[12:15], s28 offen offset:1024 lds
  buffer_load_dwordx4 v0, s[12:15], s28 offen offset:2048 lds
  buffer_load_dwordx4 v0, s[12:15], s28 offen offset:3072 lds
  s_add_u32 m0, s25, 86016
  s_add_u32 s28, s23, 45056
  buffer_load_dwordx4 v0, s[12:15], s28 offen lds
  buffer_load_dwordx4 v0, s[12:15], s28 offen offset:1024 lds
  buffer_load_dwordx4 v0, s[12:15], s28 offen offset:2048 lds
  buffer_load_dwordx4 v0, s[12:15], s28 offen offset:3072 lds
  s_add_u32 m0, s25, 90112
  s_add_u32 s28, s23, 49152
  buffer_load_dwordx4 v0, s[12:15], s28 offen lds
  buffer_load_dwordx4 v0, s[12:15], s28 offen offset:1024 lds
  s_waitcnt vmcnt(30)
  s_barrier
  s_waitcnt vmcnt(20)
  s_barrier
  s_waitcnt vmcnt(10)
  s_barrier
  s_waitcnt vmcnt(0)
  s_barrier
  s_add_u32 m0, s25, 102400
  s_add_u32 s28, s23, 51200
  buffer_load_dwordx4 v0, s[12:15], s28 offen lds
  buffer_load_dwordx4 v0, s[12:15], s28 offen offset:1024 lds
  buffer_load_dwordx4 v0, s[12:15], s28 offen offset:2048 lds
  buffer_load_dwordx4 v0, s[12:15], s28 offen offset:3072 lds
  s_add_u32 m0, s25, 106496
  s_add_u32 s28, s23, 55296
  buffer_load_dwordx4 v0, s[12:15], s28 offen lds
  buffer_load_dwordx4 v0, s[12:15], s28 offen offset:1024 lds
  buffer_load_dwordx4 v0, s[12:15], s28 offen offset:2048 lds
  buffer_load_dwordx4 v0, s[12:15], s28 offen offset:3072 lds
  s_add_u32 m0, s25, 110592
  s_add_u32 s28, s23, 59392
  buffer_load_dwordx4 v0, s[12:15], s28 offen lds
  buffer_load_dwordx4 v0, s[12:15], s28 offen offset:1024 lds
  s_add_u32 m0, s25, 122880
  s_add_u32 s28, s23, 61440
  buffer_load_dwordx4 v0, s[12:15], s28 offen lds
  buffer_load_dwordx4 v0, s[12:15], s28 offen offset:1024 lds
  buffer_load_dwordx4 v0, s[12:15], s28 offen offset:2048 lds
  buffer_load_dwordx4 v0, s[12:15], s28 offen offset:3072 lds
  s_add_u32 m0, s25, 126976
  s_add_u32 s28, s23, 65536
  buffer_load_dwordx4 v0, s[12:15], s28 offen lds
  buffer_load_dwordx4 v0, s[12:15], s28 offen offset:1024 lds
  buffer_load_dwordx4 v0, s[12:15], s28 offen offset:2048 lds
  buffer_load_dwordx4 v0, s[12:15], s28 offen offset:3072 lds
  s_add_u32 m0, s25, 131072
  s_add_u32 s28, s23, 69632
  buffer_load_dwordx4 v0, s[12:15], s28 offen lds
  buffer_load_dwordx4 v0, s[12:15], s28 offen offset:1024 lds
  s_waitcnt vmcnt(10)
  s_barrier
  s_add_u32 m0, s25, 0
  s_add_u32 s28, s23, 71680
  buffer_load_dwordx4 v0, s[12:15], s28 offen lds
  buffer_load_dwordx4 v0, s[12:15], s28 offen offset:1024 lds
  buffer_load_dwordx4 v0, s[12:15], s28 offen offset:2048 lds
  buffer_load_dwordx4 v0, s[12:15], s28 offen offset:3072 lds
  s_add_u32 m0, s25, 4096
  s_add_u32 s28, s23, 75776
  buffer_load_dwordx4 v0, s[12:15], s28 offen lds
  buffer_load_dwordx4 v0, s[12:15], s28 offen offset:1024 lds
  buffer_load_dwordx4 v0, s[12:15], s28 offen offset:2048 lds
  buffer_load_dwordx4 v0, s[12:15], s28 offen offset:3072 lds
  s_add_u32 m0, s25, 8192
  s_add_u32 s28, s23, 79872
  buffer_load_dwordx4 v0, s[12:15], s28 offen lds
  buffer_load_dwordx4 v0, s[12:15], s28 offen offset:1024 lds
  s_add_u32 m0, s25, 20480
  s_add_u32 s28, s23, 81920
  buffer_load_dwordx4 v0, s[12:15], s28 offen lds
  buffer_load_dwordx4 v0, s[12:15], s28 offen offset:1024 lds
  buffer_load_dwordx4 v0, s[12:15], s28 offen offset:2048 lds
  buffer_load_dwordx4 v0, s[12:15], s28 offen offset:3072 lds
  s_add_u32 m0, s25, 24576
  s_add_u32 s28, s23, 86016
  buffer_load_dwordx4 v0, s[12:15], s28 offen lds
  buffer_load_dwordx4 v0, s[12:15], s28 offen offset:1024 lds
  buffer_load_dwordx4 v0, s[12:15], s28 offen offset:2048 lds
  buffer_load_dwordx4 v0, s[12:15], s28 offen offset:3072 lds
  s_add_u32 m0, s25, 28672
  s_add_u32 s28, s23, 90112
  buffer_load_dwordx4 v0, s[12:15], s28 offen lds
  buffer_load_dwordx4 v0, s[12:15], s28 offen offset:1024 lds
  s_mov_b32 m0, s41
  s_add_u32 s28, s40, 0
  buffer_load_dwordx4 v0, s[12:15], s28 offen lds
  s_mov_b32 m0, s41
  s_add_u32 s28, s40, 1024
  buffer_load_dwordx4 v0, s[12:15], s28 offen lds
  s_mov_b32 m0, s41
  s_add_u32 s28, s40, 2048
  buffer_load_dwordx4 v0, s[12:15], s28 offen lds
  s_mov_b32 m0, s41
  s_add_u32 s28, s40, 3072
  buffer_load_dwordx4 v0, s[12:15], s28 offen lds
  s_waitcnt vmcnt(24)
  s_barrier
  s_add_u32 m0, s25, 40960
  s_add_u32 s28, s23, 92160
  buffer_load_dwordx4 v0, s[12:15], s28 offen lds
  buffer_load_dwordx4 v0, s[12:15], s28 offen offset:1024 lds
  buffer_load_dwordx4 v0, s[12:15], s28 offen offset:2048 lds
  buffer_load_dwordx4 v0, s[12:15], s28 offen offset:3072 lds
  s_add_u32 m0, s25, 45056
  s_add_u32 s28, s23, 96256
  buffer_load_dwordx4 v0, s[12:15], s28 offen lds
  buffer_load_dwordx4 v0, s[12:15], s28 offen offset:1024 lds
  buffer_load_dwordx4 v0, s[12:15], s28 offen offset:2048 lds
  buffer_load_dwordx4 v0, s[12:15], s28 offen offset:3072 lds
  s_add_u32 m0, s25, 49152
  s_add_u32 s28, s23, 100352
  buffer_load_dwordx4 v0, s[12:15], s28 offen lds
  buffer_load_dwordx4 v0, s[12:15], s28 offen offset:1024 lds
  s_add_u32 m0, s25, 61440
  s_add_u32 s28, s23, 102400
  buffer_load_dwordx4 v0, s[12:15], s28 offen lds
  buffer_load_dwordx4 v0, s[12:15], s28 offen offset:1024 lds
  buffer_load_dwordx4 v0, s[12:15], s28 offen offset:2048 lds
  buffer_load_dwordx4 v0, s[12:15], s28 offen offset:3072 lds
  s_add_u32 m0, s25, 65536
  s_add_u32 s28, s23, 106496
  buffer_load_dwordx4 v0, s[12:15], s28 offen lds
  buffer_load_dwordx4 v0, s[12:15], s28 offen offset:1024 lds
  buffer_load_dwordx4 v0, s[12:15], s28 offen offset:2048 lds
  buffer_load_dwordx4 v0, s[12:15], s28 offen offset:3072 lds
  s_add_u32 m0, s25, 69632
  s_add_u32 s28, s23, 110592
  buffer_load_dwordx4 v0, s[12:15], s28 offen lds
  buffer_load_dwordx4 v0, s[12:15], s28 offen offset:1024 lds
  s_mov_b32 m0, s41
  s_add_u32 s28, s40, 4096
  buffer_load_dwordx4 v0, s[12:15], s28 offen lds
  s_mov_b32 m0, s41
  s_add_u32 s28, s40, 5120
  buffer_load_dwordx4 v0, s[12:15], s28 offen lds
  s_mov_b32 m0, s41
  s_add_u32 s28, s40, 6144
  buffer_load_dwordx4 v0, s[12:15], s28 offen lds
  s_mov_b32 m0, s41
  s_add_u32 s28, s40, 7168
  buffer_load_dwordx4 v0, s[12:15], s28 offen lds
  s_waitcnt vmcnt(38)
  s_barrier
  s_add_u32 m0, s25, 81920
  s_add_u32 s28, s23, 112640
  buffer_load_dwordx4 v0, s[12:15], s28 offen lds
  buffer_load_dwordx4 v0, s[12:15], s28 offen offset:1024 lds
  buffer_load_dwordx4 v0, s[12:15], s28 offen offset:2048 lds
  buffer_load_dwordx4 v0, s[12:15], s28 offen offset:3072 lds
  s_add_u32 m0, s25, 86016
  s_add_u32 s28, s23, 116736
  buffer_load_dwordx4 v0, s[12:15], s28 offen lds
  buffer_load_dwordx4 v0, s[12:15], s28 offen offset:1024 lds
  buffer_load_dwordx4 v0, s[12:15], s28 offen offset:2048 lds
  buffer_load_dwordx4 v0, s[12:15], s28 offen offset:3072 lds
  s_add_u32 m0, s25, 90112
  s_add_u32 s28, s23, 120832
  buffer_load_dwordx4 v0, s[12:15], s28 offen lds
  buffer_load_dwordx4 v0, s[12:15], s28 offen offset:1024 lds
  s_add_u32 m0, s25, 102400
  s_add_u32 s28, s23, 122880
  buffer_load_dwordx4 v0, s[12:15], s28 offen lds
  buffer_load_dwordx4 v0, s[12:15], s28 offen offset:1024 lds
  buffer_load_dwordx4 v0, s[12:15], s28 offen offset:2048 lds
  buffer_load_dwordx4 v0, s[12:15], s28 offen offset:3072 lds
  s_add_u32 m0, s25, 106496
  s_add_u32 s28, s23, 126976
  buffer_load_dwordx4 v0, s[12:15], s28 offen lds
  buffer_load_dwordx4 v0, s[12:15], s28 offen offset:1024 lds
  buffer_load_dwordx4 v0, s[12:15], s28 offen offset:2048 lds
  buffer_load_dwordx4 v0, s[12:15], s28 offen offset:3072 lds
  s_add_u32 m0, s25, 110592
  s_add_u32 s28, s23, 131072
  buffer_load_dwordx4 v0, s[12:15], s28 offen lds
  buffer_load_dwordx4 v0, s[12:15], s28 offen offset:1024 lds
  s_mov_b32 m0, s41
  s_add_u32 s28, s40, 8192
  buffer_load_dwordx4 v0, s[12:15], s28 offen lds
  s_mov_b32 m0, s41
  s_add_u32 s28, s40, 9216
  buffer_load_dwordx4 v0, s[12:15], s28 offen lds
  s_mov_b32 m0, s41
  s_add_u32 s28, s40, 10240
  buffer_load_dwordx4 v0, s[12:15], s28 offen lds
  s_mov_b32 m0, s41
  s_add_u32 s28, s40, 11264
  buffer_load_dwordx4 v0, s[12:15], s28 offen lds
  s_waitcnt vmcnt(52)
  s_barrier
  s_add_u32 m0, s25, 122880
  s_add_u32 s28, s23, 133120
  buffer_load_dwordx4 v0, s[12:15], s28 offen lds
  buffer_load_dwordx4 v0, s[12:15], s28 offen offset:1024 lds
  buffer_load_dwordx4 v0, s[12:15], s28 offen offset:2048 lds
  buffer_load_dwordx4 v0, s[12:15], s28 offen offset:3072 lds
  s_add_u32 m0, s25, 126976
  s_add_u32 s28, s23, 137216
  buffer_load_dwordx4 v0, s[12:15], s28 offen lds
  buffer_load_dwordx4 v0, s[12:15], s28 offen offset:1024 lds
  buffer_load_dwordx4 v0, s[12:15], s28 offen offset:2048 lds
  buffer_load_dwordx4 v0, s[12:15], s28 offen offset:3072 lds
  s_add_u32 m0, s25, 131072
  s_add_u32 s28, s23, 141312
  buffer_load_dwordx4 v0, s[12:15], s28 offen lds
  buffer_load_dwordx4 v0, s[12:15], s28 offen offset:1024 lds
  s_mov_b32 m0, s41
  s_add_u32 s28, s40, 12288
  buffer_load_dwordx4 v0, s[12:15], s28 offen lds
  s_mov_b32 m0, s41
  s_add_u32 s28, s40, 13312
  buffer_load_dwordx4 v0, s[12:15], s28 offen lds
  s_mov_b32 m0, s41
  s_add_u32 s28, s40, 14336
  buffer_load_dwordx4 v0, s[12:15], s28 offen lds
  s_mov_b32 m0, s41
  s_add_u32 s28, s40, 15360
  buffer_load_dwordx4 v0, s[12:15], s28 offen lds
  s_waitcnt vmcnt(52)
  s_barrier
  s_mov_b32 m0, s41
  s_add_u32 s28, s40, 16384
  buffer_load_dwordx4 v0, s[12:15], s28 offen lds
  s_mov_b32 m0, s41
  s_add_u32 s28, s40, 17408
  buffer_load_dwordx4 v0, s[12:15], s28 offen lds
  s_mov_b32 m0, s41
  s_add_u32 s28, s40, 18432
  buffer_load_dwordx4 v0, s[12:15], s28 offen lds
  s_mov_b32 m0, s41
  s_add_u32 s28, s40, 19456
  buffer_load_dwordx4 v0, s[12:15], s28 offen lds
  s_waitcnt vmcnt(46)
  s_barrier
  s_mov_b32 m0, s41
  s_add_u32 s28, s40, 20480
  buffer_load_dwordx4 v0, s[12:15], s28 offen lds
  s_mov_b32 m0, s41
  s_add_u32 s28, s40, 21504
  buffer_load_dwordx4 v0, s[12:15], s28 offen lds
  s_mov_b32 m0, s41
  s_add_u32 s28, s40, 22528
  buffer_load_dwordx4 v0, s[12:15], s28 offen lds
  s_mov_b32 m0, s41
  s_add_u32 s28, s40, 23552
  buffer_load_dwordx4 v0, s[12:15], s28 offen lds
  s_waitcnt vmcnt(36)
  s_barrier
  s_mov_b32 m0, s41
  s_add_u32 s28, s40, 24576
  buffer_load_dwordx4 v0, s[12:15], s28 offen lds
  s_mov_b32 m0, s41
  s_add_u32 s28, s40, 25600
  buffer_load_dwordx4 v0, s[12:15], s28 offen lds
  s_mov_b32 m0, s41
  s_add_u32 s28, s40, 26624
  buffer_load_dwordx4 v0, s[12:15], s28 offen lds
  s_mov_b32 m0, s41
  s_add_u32 s28, s40, 27648
  buffer_load_dwordx4 v0, s[12:15], s28 offen lds
  s_waitcnt vmcnt(30)
  s_barrier
  s_mov_b32 m0, s41
  s_add_u32 s28, s40, 28672
  buffer_load_dwordx4 v0, s[12:15], s28 offen lds
  s_mov_b32 m0, s41
  s_add_u32 s28, s40, 29696
  buffer_load_dwordx4 v0, s[12:15], s28 offen lds
  s_mov_b32 m0, s41
  s_add_u32 s28, s40, 30720
  buffer_load_dwordx4 v0, s[12:15], s28 offen lds
  s_mov_b32 m0, s41
  s_add_u32 s28, s40, 31744
  buffer_load_dwordx4 v0, s[12:15], s28 offen lds
  s_waitcnt vmcnt(20)
  s_barrier
  s_mov_b32 m0, s41
  s_add_u32 s28, s40, 32768
  buffer_load_dwordx4 v0, s[12:15], s28 offen lds
  s_mov_b32 m0, s41
  s_add_u32 s28, s40, 33792
  buffer_load_dwordx4 v0, s[12:15], s28 offen lds
  s_waitcnt vmcnt(0)
  s_barrier
  s_endpgm
L_gu_loader_else:
  s_lshl_b32 s29, s19, 3
  s_lshl_b32 s30, s3, 1
  s_add_u32 s29, s29, s30
  s_mul_i32 s30, s29, 20480
  s_add_u32 s30, s30, 21864448
  v_add_u32 v1, 20480, v0
  s_add_u32 s41, s30, 0
  s_add_u32 s42, s30, 4096
  s_add_u32 s43, s30, 8192
  s_add_u32 s44, s30, 12288
  s_add_u32 s45, s30, 16384
  s_waitcnt lgkmcnt(0)
  s_and_b32 s13, s13, 0xffff
  buffer_load_dwordx4 a[0:3], v0, s[12:15], s41 offen
  buffer_load_dwordx4 a[4:7], v1, s[12:15], s41 offen
  buffer_load_dwordx4 a[8:11], v0, s[12:15], s41 offen offset:1024
  buffer_load_dwordx4 a[12:15], v1, s[12:15], s41 offen offset:1024
  buffer_load_dwordx4 a[16:19], v0, s[12:15], s41 offen offset:2048
  buffer_load_dwordx4 a[20:23], v1, s[12:15], s41 offen offset:2048
  v_and_b32 v5, 15, v95
  v_lshrrev_b32 v6, 4, v95
  s_lshl_b32 s31, s29, 4
  v_add_u32 v7, s31, v5
  v_lshlrev_b32 v7, 6, v7
  v_lshl_add_u32 v80, v6, 4, v7
  v_cmp_le_u32 vcc, 112, v94
  v_subrev_u32 v7, 112, v94
  s_nop 0
  v_cndmask_b32 v7, v94, v7, vcc
  v_mov_b32 v82, 0
  v_mov_b32 v83, 1728
  v_cndmask_b32 v82, v82, v83, vcc
  v_add_u32 v7, v7, v82
  s_lshl_b32 s31, s21, 4
  v_add_u32 v7, s31, v7
  v_lshlrev_b32 v81, 2, v7
  s_mov_b32 s31, 24485888
  s_mov_b32 s32, 9912320
  v_lshlrev_b32 v4, 4, v6
  v_add_u32 v4, 143360, v4
  v_lshlrev_b32 v95, 2, v94
  v_add_u32 v95, 143360, v95
  s_mul_i32 s33, s29, 55296
  s_add_u32 s33, s33, 24616960
  s_mov_b32 s34, 0
  s_mov_b32 s35, 0
  v_cmp_gt_u32 vcc, 224, v94
  s_nop 3
  s_mov_b64 s[46:47], vcc
  s_barrier
  v_add_u32 v2, s35, v0
  s_add_u32 s35, s35, 20480
  s_cmp_eq_u32 s35, 143360
  s_cselect_b32 s35, 0, s35
  s_barrier
  v_add_u32 v3, s35, v0
  s_add_u32 s35, s35, 20480
  s_cmp_eq_u32 s35, 143360
  s_cselect_b32 s35, 0, s35
  ds_read_b128 v[56:59], v2 offset:0
  ds_read_b128 v[60:63], v2 offset:10240
  ds_read_b128 v[64:67], v3 offset:0
  ds_read_b128 v[68:71], v3 offset:10240
  s_waitcnt vmcnt(4)
  s_waitcnt lgkmcnt(2)
  v_mfma_f32_16x16x32_bf16 v[8:11], v[56:59], a[0:3], 0
  ds_read_b128 v[72:75], v2 offset:1024
  v_mfma_f32_16x16x32_bf16 v[12:15], v[56:59], a[4:7], 0
  buffer_load_dwordx4 a[24:27], v0, s[12:15], s41 offen offset:3072
  v_mfma_f32_16x16x32_bf16 v[16:19], v[60:63], a[0:3], 0
  ds_read_b128 v[76:79], v2 offset:11264
  v_mfma_f32_16x16x32_bf16 v[20:23], v[60:63], a[4:7], 0
  buffer_load_dwordx4 a[28:31], v1, s[12:15], s41 offen offset:3072
  s_waitcnt lgkmcnt(2)
  v_mfma_f32_16x16x32_bf16 v[24:27], v[64:67], a[0:3], 0
  ds_read_b128 v[56:59], v3 offset:1024
  v_mfma_f32_16x16x32_bf16 v[28:31], v[64:67], a[4:7], 0
  buffer_load_dwordx4 v[40:43], v80, s[12:15], s31 offen
  v_mfma_f32_16x16x32_bf16 v[32:35], v[68:71], a[0:3], 0
  ds_read_b128 v[60:63], v3 offset:11264
  v_mfma_f32_16x16x32_bf16 v[36:39], v[68:71], a[4:7], 0
  buffer_load_dwordx4 v[44:47], v80, s[12:15], s31 offen offset:1024
  s_waitcnt vmcnt(6)
  s_waitcnt lgkmcnt(2)
  v_mfma_f32_16x16x32_bf16 v[8:11], v[72:75], a[8:11], v[8:11]
  ds_read_b128 v[64:67], v2 offset:2048
  v_mfma_f32_16x16x32_bf16 v[12:15], v[72:75], a[12:15], v[12:15]
  buffer_load_dwordx4 a[32:35], v0, s[12:15], s42 offen
  v_mfma_f32_16x16x32_bf16 v[16:19], v[76:79], a[8:11], v[16:19]
  ds_read_b128 v[68:71], v2 offset:12288
  v_mfma_f32_16x16x32_bf16 v[20:23], v[76:79], a[12:15], v[20:23]
  buffer_load_dwordx4 a[36:39], v1, s[12:15], s42 offen
  s_waitcnt lgkmcnt(2)
  v_mfma_f32_16x16x32_bf16 v[24:27], v[56:59], a[8:11], v[24:27]
  ds_read_b128 v[72:75], v3 offset:2048
  v_mfma_f32_16x16x32_bf16 v[28:31], v[56:59], a[12:15], v[28:31]
  buffer_load_dword v48, v81, s[12:15], s32 offen
  s_add_u32 s32, s32, 13824
  v_mfma_f32_16x16x32_bf16 v[32:35], v[60:63], a[8:11], v[32:35]
  ds_read_b128 v[76:79], v3 offset:12288
  v_mfma_f32_16x16x32_bf16 v[36:39], v[60:63], a[12:15], v[36:39]
  buffer_load_dword v49, v81, s[12:15], s32 offen
  s_add_u32 s32, s32, 13824
  s_waitcnt vmcnt(8)
  s_waitcnt lgkmcnt(2)
  v_mfma_f32_16x16x32_bf16 v[8:11], v[64:67], a[16:19], v[8:11]
  ds_read_b128 v[56:59], v2 offset:3072
  v_mfma_f32_16x16x32_bf16 v[12:15], v[64:67], a[20:23], v[12:15]
  buffer_load_dwordx4 a[40:43], v0, s[12:15], s42 offen offset:1024
  v_mfma_f32_16x16x32_bf16 v[16:19], v[68:71], a[16:19], v[16:19]
  ds_read_b128 v[60:63], v2 offset:13312
  v_mfma_f32_16x16x32_bf16 v[20:23], v[68:71], a[20:23], v[20:23]
  buffer_load_dwordx4 a[44:47], v1, s[12:15], s42 offen offset:1024
  s_waitcnt lgkmcnt(2)
  v_mfma_f32_16x16x32_bf16 v[24:27], v[72:75], a[16:19], v[24:27]
  ds_read_b128 v[64:67], v3 offset:3072
  v_mfma_f32_16x16x32_bf16 v[28:31], v[72:75], a[20:23], v[28:31]
  buffer_load_dword v50, v81, s[12:15], s32 offen
  s_add_u32 s32, s32, 13824
  v_mfma_f32_16x16x32_bf16 v[32:35], v[76:79], a[16:19], v[32:35]
  ds_read_b128 v[68:71], v3 offset:13312
  v_mfma_f32_16x16x32_bf16 v[36:39], v[76:79], a[20:23], v[36:39]
  buffer_load_dword v51, v81, s[12:15], s32 offen
  s_add_u32 s32, s32, 13824
  s_waitcnt vmcnt(10)
  s_waitcnt lgkmcnt(2)
  v_mfma_f32_16x16x32_bf16 v[8:11], v[56:59], a[24:27], v[8:11]
  ds_read_b128 v[72:75], v2 offset:4096
  v_mfma_f32_16x16x32_bf16 v[12:15], v[56:59], a[28:31], v[12:15]
  buffer_load_dwordx4 a[48:51], v0, s[12:15], s42 offen offset:2048
  v_mfma_f32_16x16x32_bf16 v[16:19], v[60:63], a[24:27], v[16:19]
  ds_read_b128 v[76:79], v2 offset:14336
  v_mfma_f32_16x16x32_bf16 v[20:23], v[60:63], a[28:31], v[20:23]
  buffer_load_dwordx4 a[52:55], v1, s[12:15], s42 offen offset:2048
  s_waitcnt lgkmcnt(2)
  v_mfma_f32_16x16x32_bf16 v[24:27], v[64:67], a[24:27], v[24:27]
  ds_read_b128 v[56:59], v3 offset:4096
  v_mfma_f32_16x16x32_bf16 v[28:31], v[64:67], a[28:31], v[28:31]
  buffer_load_dword v52, v81, s[12:15], s32 offen
  s_add_u32 s32, s32, 13824
  v_mfma_f32_16x16x32_bf16 v[32:35], v[68:71], a[24:27], v[32:35]
  ds_read_b128 v[60:63], v3 offset:14336
  v_mfma_f32_16x16x32_bf16 v[36:39], v[68:71], a[28:31], v[36:39]
  buffer_load_dword v53, v81, s[12:15], s32 offen
  s_add_u32 s32, s32, 13824
  s_waitcnt vmcnt(10)
  s_waitcnt lgkmcnt(2)
  v_mfma_f32_16x16x32_bf16 v[8:11], v[72:75], a[32:35], v[8:11]
  ds_read_b128 v[64:67], v2 offset:5120
  v_mfma_f32_16x16x32_bf16 v[12:15], v[72:75], a[36:39], v[12:15]
  buffer_load_dwordx4 a[56:59], v0, s[12:15], s42 offen offset:3072
  v_mfma_f32_16x16x32_bf16 v[16:19], v[76:79], a[32:35], v[16:19]
  ds_read_b128 v[68:71], v2 offset:15360
  v_mfma_f32_16x16x32_bf16 v[20:23], v[76:79], a[36:39], v[20:23]
  buffer_load_dwordx4 a[60:63], v1, s[12:15], s42 offen offset:3072
  s_waitcnt lgkmcnt(2)
  v_mfma_f32_16x16x32_bf16 v[24:27], v[56:59], a[32:35], v[24:27]
  ds_read_b128 v[72:75], v3 offset:5120
  v_mfma_f32_16x16x32_bf16 v[28:31], v[56:59], a[36:39], v[28:31]
  buffer_load_dword v54, v81, s[12:15], s32 offen
  s_add_u32 s32, s32, 13824
  v_mfma_f32_16x16x32_bf16 v[32:35], v[60:63], a[32:35], v[32:35]
  ds_read_b128 v[76:79], v3 offset:15360
  v_mfma_f32_16x16x32_bf16 v[36:39], v[60:63], a[36:39], v[36:39]
  buffer_load_dword v55, v81, s[12:15], s32 offen
  s_add_u32 s32, s32, 13824
  s_waitcnt vmcnt(10)
  s_waitcnt lgkmcnt(2)
  v_mfma_f32_16x16x32_bf16 v[8:11], v[64:67], a[40:43], v[8:11]
  ds_read_b128 v[56:59], v2 offset:6144
  v_mfma_f32_16x16x32_bf16 v[12:15], v[64:67], a[44:47], v[12:15]
  buffer_load_dwordx4 a[64:67], v0, s[12:15], s43 offen
  v_mfma_f32_16x16x32_bf16 v[16:19], v[68:71], a[40:43], v[16:19]
  ds_read_b128 v[60:63], v2 offset:16384
  v_mfma_f32_16x16x32_bf16 v[20:23], v[68:71], a[44:47], v[20:23]
  buffer_load_dwordx4 a[68:71], v1, s[12:15], s43 offen
  s_waitcnt lgkmcnt(2)
  v_mfma_f32_16x16x32_bf16 v[24:27], v[72:75], a[40:43], v[24:27]
  ds_read_b128 v[64:67], v3 offset:6144
  v_mfma_f32_16x16x32_bf16 v[28:31], v[72:75], a[44:47], v[28:31]
  buffer_load_dword v84, v81, s[12:15], s32 offen
  s_add_u32 s32, s32, 13824
  v_mfma_f32_16x16x32_bf16 v[32:35], v[76:79], a[40:43], v[32:35]
  ds_read_b128 v[68:71], v3 offset:16384
  v_mfma_f32_16x16x32_bf16 v[36:39], v[76:79], a[44:47], v[36:39]
  buffer_load_dword v85, v81, s[12:15], s32 offen
  s_add_u32 s32, s32, 13824
  s_waitcnt vmcnt(10)
  s_waitcnt lgkmcnt(2)
  v_mfma_f32_16x16x32_bf16 v[8:11], v[56:59], a[48:51], v[8:11]
  ds_read_b128 v[72:75], v2 offset:7168
  v_mfma_f32_16x16x32_bf16 v[12:15], v[56:59], a[52:55], v[12:15]
  buffer_load_dwordx4 a[72:75], v0, s[12:15], s43 offen offset:1024
  v_mfma_f32_16x16x32_bf16 v[16:19], v[60:63], a[48:51], v[16:19]
  ds_read_b128 v[76:79], v2 offset:17408
  v_mfma_f32_16x16x32_bf16 v[20:23], v[60:63], a[52:55], v[20:23]
  buffer_load_dwordx4 a[76:79], v1, s[12:15], s43 offen offset:1024
  s_waitcnt lgkmcnt(2)
  v_mfma_f32_16x16x32_bf16 v[24:27], v[64:67], a[48:51], v[24:27]
  ds_read_b128 v[56:59], v3 offset:7168
  v_mfma_f32_16x16x32_bf16 v[28:31], v[64:67], a[52:55], v[28:31]
  buffer_load_dword v86, v81, s[12:15], s32 offen
  s_add_u32 s32, s32, 13824
  v_mfma_f32_16x16x32_bf16 v[32:35], v[68:71], a[48:51], v[32:35]
  ds_read_b128 v[60:63], v3 offset:17408
  v_mfma_f32_16x16x32_bf16 v[36:39], v[68:71], a[52:55], v[36:39]
  buffer_load_dword v87, v81, s[12:15], s32 offen
  s_add_u32 s32, s32, 13824
  s_waitcnt vmcnt(10)
  s_waitcnt lgkmcnt(2)
  v_mfma_f32_16x16x32_bf16 v[8:11], v[72:75], a[56:59], v[8:11]
  ds_read_b128 v[64:67], v2 offset:8192
  v_mfma_f32_16x16x32_bf16 v[12:15], v[72:75], a[60:63], v[12:15]
  buffer_load_dwordx4 a[80:83], v0, s[12:15], s43 offen offset:2048
  v_mfma_f32_16x16x32_bf16 v[16:19], v[76:79], a[56:59], v[16:19]
  ds_read_b128 v[68:71], v2 offset:18432
  v_mfma_f32_16x16x32_bf16 v[20:23], v[76:79], a[60:63], v[20:23]
  buffer_load_dwordx4 a[84:87], v1, s[12:15], s43 offen offset:2048
  s_waitcnt lgkmcnt(2)
  v_mfma_f32_16x16x32_bf16 v[24:27], v[56:59], a[56:59], v[24:27]
  ds_read_b128 v[72:75], v3 offset:8192
  v_mfma_f32_16x16x32_bf16 v[28:31], v[56:59], a[60:63], v[28:31]
  buffer_load_dword v88, v81, s[12:15], s32 offen
  s_add_u32 s32, s32, 13824
  v_mfma_f32_16x16x32_bf16 v[32:35], v[60:63], a[56:59], v[32:35]
  ds_read_b128 v[76:79], v3 offset:18432
  v_mfma_f32_16x16x32_bf16 v[36:39], v[60:63], a[60:63], v[36:39]
  buffer_load_dword v89, v81, s[12:15], s32 offen
  s_add_u32 s32, s32, 13824
  s_waitcnt vmcnt(10)
  s_waitcnt lgkmcnt(2)
  v_mfma_f32_16x16x32_bf16 v[8:11], v[64:67], a[64:67], v[8:11]
  ds_read_b128 v[56:59], v2 offset:9216
  v_mfma_f32_16x16x32_bf16 v[12:15], v[64:67], a[68:71], v[12:15]
  buffer_load_dwordx4 a[88:91], v0, s[12:15], s43 offen offset:3072
  v_mfma_f32_16x16x32_bf16 v[16:19], v[68:71], a[64:67], v[16:19]
  ds_read_b128 v[60:63], v2 offset:19456
  v_mfma_f32_16x16x32_bf16 v[20:23], v[68:71], a[68:71], v[20:23]
  buffer_load_dwordx4 a[92:95], v1, s[12:15], s43 offen offset:3072
  s_waitcnt lgkmcnt(2)
  v_mfma_f32_16x16x32_bf16 v[24:27], v[72:75], a[64:67], v[24:27]
  ds_read_b128 v[64:67], v3 offset:9216
  v_mfma_f32_16x16x32_bf16 v[28:31], v[72:75], a[68:71], v[28:31]
  buffer_load_dword v90, v81, s[12:15], s32 offen
  s_add_u32 s32, s32, 13824
  v_mfma_f32_16x16x32_bf16 v[32:35], v[76:79], a[64:67], v[32:35]
  ds_read_b128 v[68:71], v3 offset:19456
  v_mfma_f32_16x16x32_bf16 v[36:39], v[76:79], a[68:71], v[36:39]
  buffer_load_dword v91, v81, s[12:15], s32 offen
  s_add_u32 s32, s32, 13824
  s_waitcnt vmcnt(10)
  s_waitcnt lgkmcnt(2)
  v_mfma_f32_16x16x32_bf16 v[8:11], v[56:59], a[72:75], v[8:11]
  s_barrier
  v_add_u32 v2, s35, v0
  s_add_u32 s35, s35, 20480
  s_cmp_eq_u32 s35, 143360
  s_cselect_b32 s35, 0, s35
  ds_read_b128 v[72:75], v2 offset:0
  v_mfma_f32_16x16x32_bf16 v[12:15], v[56:59], a[76:79], v[12:15]
  buffer_load_dwordx4 a[96:99], v0, s[12:15], s44 offen
  v_mfma_f32_16x16x32_bf16 v[16:19], v[60:63], a[72:75], v[16:19]
  ds_read_b128 v[76:79], v2 offset:10240
  v_mfma_f32_16x16x32_bf16 v[20:23], v[60:63], a[76:79], v[20:23]
  buffer_load_dwordx4 a[100:103], v1, s[12:15], s44 offen
  s_waitcnt lgkmcnt(2)
  v_mfma_f32_16x16x32_bf16 v[24:27], v[64:67], a[72:75], v[24:27]
  s_barrier
  v_add_u32 v3, s35, v0
  s_add_u32 s35, s35, 20480
  s_cmp_eq_u32 s35, 143360
  s_cselect_b32 s35, 0, s35
  ds_read_b128 v[56:59], v3 offset:0
  v_mfma_f32_16x16x32_bf16 v[28:31], v[64:67], a[76:79], v[28:31]
  buffer_load_dword v5, v81, s[12:15], s32 offen
  s_add_u32 s32, s32, 13824
  v_mfma_f32_16x16x32_bf16 v[32:35], v[68:71], a[72:75], v[32:35]
  ds_read_b128 v[60:63], v3 offset:10240
  v_mfma_f32_16x16x32_bf16 v[36:39], v[68:71], a[76:79], v[36:39]
  buffer_load_dword v6, v81, s[12:15], s32 offen
  s_add_u32 s32, s32, 13824
  s_waitcnt vmcnt(10)
  s_waitcnt lgkmcnt(2)
  v_mfma_f32_16x16x32_bf16 v[8:11], v[72:75], a[80:83], v[8:11]
  ds_read_b128 v[64:67], v2 offset:1024
  v_mfma_f32_16x16x32_bf16 v[12:15], v[72:75], a[84:87], v[12:15]
  buffer_load_dwordx4 a[104:107], v0, s[12:15], s44 offen offset:1024
  v_mfma_f32_16x16x32_bf16 v[16:19], v[76:79], a[80:83], v[16:19]
  ds_read_b128 v[68:71], v2 offset:11264
  v_mfma_f32_16x16x32_bf16 v[20:23], v[76:79], a[84:87], v[20:23]
  buffer_load_dwordx4 a[108:111], v1, s[12:15], s44 offen offset:1024
  s_waitcnt lgkmcnt(2)
  v_mfma_f32_16x16x32_bf16 v[24:27], v[56:59], a[80:83], v[24:27]
  ds_read_b128 v[72:75], v3 offset:1024
  v_mfma_f32_16x16x32_bf16 v[28:31], v[56:59], a[84:87], v[28:31]
  buffer_load_dword v7, v81, s[12:15], s32 offen
  s_add_u32 s32, s32, 13824
  v_mfma_f32_16x16x32_bf16 v[32:35], v[60:63], a[80:83], v[32:35]
  ds_read_b128 v[76:79], v3 offset:11264
  v_mfma_f32_16x16x32_bf16 v[36:39], v[60:63], a[84:87], v[36:39]
  buffer_load_dword v92, v81, s[12:15], s32 offen
  s_add_u32 s32, s32, 13824
  s_waitcnt vmcnt(10)
  s_waitcnt lgkmcnt(2)
  v_mfma_f32_16x16x32_bf16 v[8:11], v[64:67], a[88:91], v[8:11]
  ds_read_b128 v[56:59], v2 offset:2048
  v_mfma_f32_16x16x32_bf16 v[12:15], v[64:67], a[92:95], v[12:15]
  buffer_load_dwordx4 a[112:115], v0, s[12:15], s44 offen offset:2048
  v_mfma_f32_16x16x32_bf16 v[16:19], v[68:71], a[88:91], v[16:19]
  ds_read_b128 v[60:63], v2 offset:12288
  v_mfma_f32_16x16x32_bf16 v[20:23], v[68:71], a[92:95], v[20:23]
  buffer_load_dwordx4 a[116:119], v1, s[12:15], s44 offen offset:2048
  s_waitcnt lgkmcnt(2)
  v_mfma_f32_16x16x32_bf16 v[24:27], v[72:75], a[88:91], v[24:27]
  ds_read_b128 v[64:67], v3 offset:2048
  v_mfma_f32_16x16x32_bf16 v[28:31], v[72:75], a[92:95], v[28:31]
  v_mfma_f32_16x16x32_bf16 v[32:35], v[76:79], a[88:91], v[32:35]
  ds_read_b128 v[68:71], v3 offset:12288
  v_mfma_f32_16x16x32_bf16 v[36:39], v[76:79], a[92:95], v[36:39]
  s_waitcnt vmcnt(8)
  s_waitcnt lgkmcnt(2)
  v_mfma_f32_16x16x32_bf16 v[8:11], v[56:59], a[96:99], v[8:11]
  ds_read_b128 v[72:75], v2 offset:3072
  v_mfma_f32_16x16x32_bf16 v[12:15], v[56:59], a[100:103], v[12:15]
  buffer_load_dwordx4 a[120:123], v0, s[12:15], s44 offen offset:3072
  v_mfma_f32_16x16x32_bf16 v[16:19], v[60:63], a[96:99], v[16:19]
  ds_read_b128 v[76:79], v2 offset:13312
  v_mfma_f32_16x16x32_bf16 v[20:23], v[60:63], a[100:103], v[20:23]
  buffer_load_dwordx4 a[124:127], v1, s[12:15], s44 offen offset:3072
  s_waitcnt lgkmcnt(2)
  v_mfma_f32_16x16x32_bf16 v[24:27], v[64:67], a[96:99], v[24:27]
  ds_read_b128 v[56:59], v3 offset:3072
  v_mfma_f32_16x16x32_bf16 v[28:31], v[64:67], a[100:103], v[28:31]
  v_mfma_f32_16x16x32_bf16 v[32:35], v[68:71], a[96:99], v[32:35]
  ds_read_b128 v[60:63], v3 offset:13312
  v_mfma_f32_16x16x32_bf16 v[36:39], v[68:71], a[100:103], v[36:39]
  s_waitcnt vmcnt(6)
  s_waitcnt lgkmcnt(2)
  v_mfma_f32_16x16x32_bf16 v[8:11], v[72:75], a[104:107], v[8:11]
  ds_read_b128 v[64:67], v2 offset:4096
  v_mfma_f32_16x16x32_bf16 v[12:15], v[72:75], a[108:111], v[12:15]
  buffer_load_dwordx4 a[128:131], v0, s[12:15], s45 offen
  v_mfma_f32_16x16x32_bf16 v[16:19], v[76:79], a[104:107], v[16:19]
  ds_read_b128 v[68:71], v2 offset:14336
  v_mfma_f32_16x16x32_bf16 v[20:23], v[76:79], a[108:111], v[20:23]
  buffer_load_dwordx4 a[132:135], v1, s[12:15], s45 offen
  s_waitcnt lgkmcnt(2)
  v_mfma_f32_16x16x32_bf16 v[24:27], v[56:59], a[104:107], v[24:27]
  ds_read_b128 v[72:75], v3 offset:4096
  v_mfma_f32_16x16x32_bf16 v[28:31], v[56:59], a[108:111], v[28:31]
  v_mfma_f32_16x16x32_bf16 v[32:35], v[60:63], a[104:107], v[32:35]
  ds_read_b128 v[76:79], v3 offset:14336
  v_mfma_f32_16x16x32_bf16 v[36:39], v[60:63], a[108:111], v[36:39]
  s_waitcnt vmcnt(4)
  s_waitcnt vmcnt(8)
  v_add_f32 v40, v40, v42
  v_add_f32 v41, v41, v43
  ds_swizzle_b32 v42, v40 offset:0x401F
  ds_swizzle_b32 v43, v41 offset:0x401F
  s_waitcnt lgkmcnt(0)
  v_add_f32 v40, v40, v42
  v_add_f32 v41, v41, v43
  v_mov_b32 v42, v40
  v_mov_b32 v43, v41
  s_nop 1
  v_permlane32_swap_b32 v42, v40
  v_permlane32_swap_b32 v43, v41
  s_nop 1
  v_add_f32 v40, v40, v42
  v_add_f32 v41, v41, v43
  v_mul_f32 v40, 986500301, v40
  v_mul_f32 v41, 986500301, v41
  v_fma_f32 v41, -v40, v40, v41
  v_max_f32 v41, 0, v41
  v_add_f32 v41, 925353388, v41
  v_rsq_f32 v80, v41
  s_nop 0
  v_mul_f32 v82, v40, v80
  v_add_f32 v44, v44, v46
  v_add_f32 v45, v45, v47
  ds_swizzle_b32 v46, v44 offset:0x401F
  ds_swizzle_b32 v47, v45 offset:0x401F
  s_waitcnt lgkmcnt(0)
  v_add_f32 v44, v44, v46
  v_add_f32 v45, v45, v47
  v_mov_b32 v46, v44
  v_mov_b32 v47, v45
  s_nop 1
  v_permlane32_swap_b32 v46, v44
  v_permlane32_swap_b32 v47, v45
  s_nop 1
  v_add_f32 v44, v44, v46
  v_add_f32 v45, v45, v47
  v_mul_f32 v44, 986500301, v44
  v_mul_f32 v45, 986500301, v45
  v_fma_f32 v45, -v44, v44, v45
  v_max_f32 v45, 0, v45
  v_add_f32 v45, 925353388, v45
  v_rsq_f32 v81, v45
  s_nop 0
  v_mul_f32 v83, v44, v81
  v_add_f32 v48, v48, v49
  v_add_f32 v48, v48, v50
  v_add_f32 v48, v48, v51
  v_add_f32 v48, v48, v52
  v_add_f32 v48, v48, v53
  v_add_f32 v48, v48, v54
  v_add_f32 v48, v48, v55
  v_add_f32 v48, v48, v84
  v_add_f32 v48, v48, v85
  v_add_f32 v48, v48, v86
  v_add_f32 v48, v48, v87
  v_add_f32 v48, v48, v88
  v_add_f32 v48, v48, v89
  v_add_f32 v48, v48, v90
  v_add_f32 v48, v48, v91
  v_add_f32 v48, v48, v5
  v_add_f32 v48, v48, v6
  v_add_f32 v48, v48, v7
  v_add_f32 v48, v48, v92
  s_mov_b64 exec, s[46:47]
  ds_write_b32 v95, v48
  s_mov_b64 exec, -1
  s_waitcnt lgkmcnt(0)
  s_nop 0
  s_nop 1
  v_mfma_f32_16x16x32_bf16 v[8:11], v[64:67], a[112:115], v[8:11]
  ds_read_b128 v[56:59], v2 offset:5120
  v_mfma_f32_16x16x32_bf16 v[12:15], v[64:67], a[116:119], v[12:15]
  buffer_load_dwordx4 a[136:139], v0, s[12:15], s45 offen offset:1024
  v_mfma_f32_16x16x32_bf16 v[16:19], v[68:71], a[112:115], v[16:19]
  ds_read_b128 v[60:63], v2 offset:15360
  v_mfma_f32_16x16x32_bf16 v[20:23], v[68:71], a[116:119], v[20:23]
  buffer_load_dwordx4 a[140:143], v1, s[12:15], s45 offen offset:1024
  s_waitcnt lgkmcnt(2)
  v_mfma_f32_16x16x32_bf16 v[24:27], v[72:75], a[112:115], v[24:27]
  ds_read_b128 v[64:67], v3 offset:5120
  v_mfma_f32_16x16x32_bf16 v[28:31], v[72:75], a[116:119], v[28:31]
  v_mfma_f32_16x16x32_bf16 v[32:35], v[76:79], a[112:115], v[32:35]
  ds_read_b128 v[68:71], v3 offset:15360
  v_mfma_f32_16x16x32_bf16 v[36:39], v[76:79], a[116:119], v[36:39]
  s_waitcnt vmcnt(4)
  s_waitcnt lgkmcnt(2)
  v_mfma_f32_16x16x32_bf16 v[8:11], v[56:59], a[120:123], v[8:11]
  ds_read_b128 v[72:75], v2 offset:6144
  v_mfma_f32_16x16x32_bf16 v[12:15], v[56:59], a[124:127], v[12:15]
  buffer_load_dwordx4 a[144:147], v0, s[12:15], s45 offen offset:2048
  v_mfma_f32_16x16x32_bf16 v[16:19], v[60:63], a[120:123], v[16:19]
  ds_read_b128 v[76:79], v2 offset:16384
  v_mfma_f32_16x16x32_bf16 v[20:23], v[60:63], a[124:127], v[20:23]
  buffer_load_dwordx4 a[148:151], v1, s[12:15], s45 offen offset:2048
  s_waitcnt lgkmcnt(2)
  v_mfma_f32_16x16x32_bf16 v[24:27], v[64:67], a[120:123], v[24:27]
  ds_read_b128 v[56:59], v3 offset:6144
  v_mfma_f32_16x16x32_bf16 v[28:31], v[64:67], a[124:127], v[28:31]
  v_mfma_f32_16x16x32_bf16 v[32:35], v[68:71], a[120:123], v[32:35]
  ds_read_b128 v[60:63], v3 offset:16384
  v_mfma_f32_16x16x32_bf16 v[36:39], v[68:71], a[124:127], v[36:39]
  s_waitcnt vmcnt(4)
  s_waitcnt lgkmcnt(2)
  v_mfma_f32_16x16x32_bf16 v[8:11], v[72:75], a[128:131], v[8:11]
  ds_read_b128 v[64:67], v2 offset:7168
  v_mfma_f32_16x16x32_bf16 v[12:15], v[72:75], a[132:135], v[12:15]
  buffer_load_dwordx4 a[152:155], v0, s[12:15], s45 offen offset:3072
  v_mfma_f32_16x16x32_bf16 v[16:19], v[76:79], a[128:131], v[16:19]
  ds_read_b128 v[68:71], v2 offset:17408
  v_mfma_f32_16x16x32_bf16 v[20:23], v[76:79], a[132:135], v[20:23]
  buffer_load_dwordx4 a[156:159], v1, s[12:15], s45 offen offset:3072
  s_waitcnt lgkmcnt(2)
  v_mfma_f32_16x16x32_bf16 v[24:27], v[56:59], a[128:131], v[24:27]
  ds_read_b128 v[72:75], v3 offset:7168
  v_mfma_f32_16x16x32_bf16 v[28:31], v[56:59], a[132:135], v[28:31]
  v_mfma_f32_16x16x32_bf16 v[32:35], v[60:63], a[128:131], v[32:35]
  ds_read_b128 v[76:79], v3 offset:17408
  v_mfma_f32_16x16x32_bf16 v[36:39], v[60:63], a[132:135], v[36:39]
  s_waitcnt vmcnt(4)
  s_waitcnt lgkmcnt(2)
  v_mfma_f32_16x16x32_bf16 v[8:11], v[64:67], a[136:139], v[8:11]
  ds_read_b128 v[56:59], v2 offset:8192
  v_mfma_f32_16x16x32_bf16 v[12:15], v[64:67], a[140:143], v[12:15]
  v_mfma_f32_16x16x32_bf16 v[16:19], v[68:71], a[136:139], v[16:19]
  ds_read_b128 v[60:63], v2 offset:18432
  v_mfma_f32_16x16x32_bf16 v[20:23], v[68:71], a[140:143], v[20:23]
  s_waitcnt lgkmcnt(2)
  v_mfma_f32_16x16x32_bf16 v[24:27], v[72:75], a[136:139], v[24:27]
  ds_read_b128 v[64:67], v3 offset:8192
  v_mfma_f32_16x16x32_bf16 v[28:31], v[72:75], a[140:143], v[28:31]
  v_mfma_f32_16x16x32_bf16 v[32:35], v[76:79], a[136:139], v[32:35]
  ds_read_b128 v[68:71], v3 offset:18432
  v_mfma_f32_16x16x32_bf16 v[36:39], v[76:79], a[140:143], v[36:39]
  s_waitcnt vmcnt(2)
  s_waitcnt lgkmcnt(2)
  v_mfma_f32_16x16x32_bf16 v[8:11], v[56:59], a[144:147], v[8:11]
  ds_read_b128 v[72:75], v2 offset:9216
  v_mfma_f32_16x16x32_bf16 v[12:15], v[56:59], a[148:151], v[12:15]
  v_mfma_f32_16x16x32_bf16 v[16:19], v[60:63], a[144:147], v[16:19]
  ds_read_b128 v[76:79], v2 offset:19456
  v_mfma_f32_16x16x32_bf16 v[20:23], v[60:63], a[148:151], v[20:23]
  s_waitcnt lgkmcnt(2)
  v_mfma_f32_16x16x32_bf16 v[24:27], v[64:67], a[144:147], v[24:27]
  ds_read_b128 v[56:59], v3 offset:9216
  v_mfma_f32_16x16x32_bf16 v[28:31], v[64:67], a[148:151], v[28:31]
  v_mfma_f32_16x16x32_bf16 v[32:35], v[68:71], a[144:147], v[32:35]
  ds_read_b128 v[60:63], v3 offset:19456
  v_mfma_f32_16x16x32_bf16 v[36:39], v[68:71], a[148:151], v[36:39]
  s_waitcnt vmcnt(0)
  s_waitcnt lgkmcnt(2)
  v_mfma_f32_16x16x32_bf16 v[8:11], v[72:75], a[152:155], v[8:11]
  s_barrier
  v_add_u32 v2, s35, v0
  s_add_u32 s35, s35, 20480
  s_cmp_eq_u32 s35, 143360
  s_cselect_b32 s35, 0, s35
  ds_read_b128 v[64:67], v2 offset:0
  v_mfma_f32_16x16x32_bf16 v[12:15], v[72:75], a[156:159], v[12:15]
  v_mfma_f32_16x16x32_bf16 v[16:19], v[76:79], a[152:155], v[16:19]
  ds_read_b128 v[68:71], v2 offset:10240
  v_mfma_f32_16x16x32_bf16 v[20:23], v[76:79], a[156:159], v[20:23]
  s_waitcnt lgkmcnt(2)
  v_mfma_f32_16x16x32_bf16 v[24:27], v[56:59], a[152:155], v[24:27]
  ds_read_b128 v[72:75], v2 offset:1024
  v_mfma_f32_16x16x32_bf16 v[28:31], v[56:59], a[156:159], v[28:31]
  v_mfma_f32_16x16x32_bf16 v[32:35], v[60:63], a[152:155], v[32:35]
  ds_read_b128 v[76:79], v2 offset:11264
  v_mfma_f32_16x16x32_bf16 v[36:39], v[60:63], a[156:159], v[36:39]
  s_mov_b32 s40, 0
L_gu_loop:
  s_add_u32 s37, s21, s34
  s_lshr_b32 s38, s37, 1
  s_lshl_b32 s38, s38, 10
  s_and_b32 s37, s37, 1
  s_lshl_b32 s37, s37, 3
  s_add_u32 s38, s38, s37
  s_add_u32 s38, s38, s33
  s_cmp_lt_u32 s34, s22
  s_cselect_b32 s38, s38, 0x7ff00000
  s_add_u32 s39, s38, 55296
  s_lshl_b32 s37, s34, 6
  v_add_u32 v95, s37, v4
  ds_read_b128 v[84:87], v95
  ds_read_b128 v[88:91], v95 offset:448
  s_add_u32 s34, s34, 1
  s_waitcnt lgkmcnt(4)
  v_mfma_f32_16x16x32_bf16 v[40:43], v[64:67], a[0:3], 0
  ds_read_b128 v[56:59], v2 offset:2048
  v_mfma_f32_16x16x32_bf16 v[44:47], v[64:67], a[4:7], 0
  v_mfma_f32_16x16x32_bf16 v[48:51], v[68:71], a[0:3], 0
  ds_read_b128 v[60:63], v2 offset:12288
  v_mfma_f32_16x16x32_bf16 v[52:55], v[68:71], a[4:7], 0
  s_waitcnt lgkmcnt(2)
  v_mfma_f32_16x16x32_bf16 v[40:43], v[72:75], a[8:11], v[40:43]
  ds_read_b128 v[64:67], v2 offset:3072
  v_mfma_f32_16x16x32_bf16 v[44:47], v[72:75], a[12:15], v[44:47]
  v_mfma_f32_16x16x32_bf16 v[48:51], v[76:79], a[8:11], v[48:51]
  ds_read_b128 v[68:71], v2 offset:13312
  v_mfma_f32_16x16x32_bf16 v[52:55], v[76:79], a[12:15], v[52:55]
  s_waitcnt lgkmcnt(2)
  v_mfma_f32_16x16x32_bf16 v[40:43], v[56:59], a[16:19], v[40:43]
  ds_read_b128 v[72:75], v2 offset:4096
  v_mul_f32 v5, v82, v84
  v_mfma_f32_16x16x32_bf16 v[44:47], v[56:59], a[20:23], v[44:47]
  v_mul_f32 v6, v82, v88
  v_fma_f32 v8, v8, v80, -v5
  v_mfma_f32_16x16x32_bf16 v[48:51], v[60:63], a[16:19], v[48:51]
  ds_read_b128 v[76:79], v2 offset:14336
  v_fma_f32 v16, v16, v80, -v6
  v_mfma_f32_16x16x32_bf16 v[52:55], v[60:63], a[20:23], v[52:55]
  v_mul_f32 v7, 3216550459, v8
  v_mul_f32 v16, v16, v8
  s_waitcnt lgkmcnt(2)
  v_mfma_f32_16x16x32_bf16 v[40:43], v[64:67], a[24:27], v[40:43]
  ds_read_b128 v[56:59], v2 offset:5120
  v_mfma_f32_16x16x32_bf16 v[44:47], v[64:67], a[28:31], v[44:47]
  v_exp_f32 v7, v7
  v_mfma_f32_16x16x32_bf16 v[48:51], v[68:71], a[24:27], v[48:51]
  ds_read_b128 v[60:63], v2 offset:15360
  v_add_f32 v7, 1.0, v7
  v_mfma_f32_16x16x32_bf16 v[52:55], v[68:71], a[28:31], v[52:55]
  v_rcp_f32 v7, v7
  s_waitcnt lgkmcnt(2)
  v_mfma_f32_16x16x32_bf16 v[40:43], v[72:75], a[32:35], v[40:43]
  ds_read_b128 v[64:67], v2 offset:6144
  v_mul_f32 v16, v16, v7
  v_mfma_f32_16x16x32_bf16 v[44:47], v[72:75], a[36:39], v[44:47]
  v_mul_f32 v92, v82, v85
  v_mul_f32 v93, v82, v89
  v_mfma_f32_16x16x32_bf16 v[48:51], v[76:79], a[32:35], v[48:51]
  ds_read_b128 v[68:71], v2 offset:16384
  v_fma_f32 v9, v9, v80, -v92
  v_mfma_f32_16x16x32_bf16 v[52:55], v[76:79], a[36:39], v[52:55]
  v_fma_f32 v17, v17, v80, -v93
  v_mul_f32 v94, 3216550459, v9
  s_waitcnt lgkmcnt(2)
  v_mfma_f32_16x16x32_bf16 v[40:43], v[56:59], a[40:43], v[40:43]
  ds_read_b128 v[72:75], v2 offset:7168
  v_mul_f32 v17, v17, v9
  v_mfma_f32_16x16x32_bf16 v[44:47], v[56:59], a[44:47], v[44:47]
  v_exp_f32 v94, v94
  v_mfma_f32_16x16x32_bf16 v[48:51], v[60:63], a[40:43], v[48:51]
  ds_read_b128 v[76:79], v2 offset:17408
  v_add_f32 v94, 1.0, v94
  v_mfma_f32_16x16x32_bf16 v[52:55], v[60:63], a[44:47], v[52:55]
  v_rcp_f32 v94, v94
  s_waitcnt lgkmcnt(2)
  v_mfma_f32_16x16x32_bf16 v[40:43], v[64:67], a[48:51], v[40:43]
  ds_read_b128 v[56:59], v2 offset:8192
  v_mul_f32 v17, v17, v94
  v_mfma_f32_16x16x32_bf16 v[44:47], v[64:67], a[52:55], v[44:47]
  v_mul_f32 v5, v82, v86
  v_mul_f32 v6, v82, v90
  v_mfma_f32_16x16x32_bf16 v[48:51], v[68:71], a[48:51], v[48:51]
  ds_read_b128 v[60:63], v2 offset:18432
  v_fma_f32 v10, v10, v80, -v5
  v_mfma_f32_16x16x32_bf16 v[52:55], v[68:71], a[52:55], v[52:55]
  v_fma_f32 v18, v18, v80, -v6
  v_mul_f32 v7, 3216550459, v10
  s_waitcnt lgkmcnt(2)
  v_mfma_f32_16x16x32_bf16 v[40:43], v[72:75], a[56:59], v[40:43]
  ds_read_b128 v[64:67], v2 offset:9216
  v_mul_f32 v18, v18, v10
  v_mfma_f32_16x16x32_bf16 v[44:47], v[72:75], a[60:63], v[44:47]
  v_exp_f32 v7, v7
  v_mfma_f32_16x16x32_bf16 v[48:51], v[76:79], a[56:59], v[48:51]
  ds_read_b128 v[68:71], v2 offset:19456
  v_add_f32 v7, 1.0, v7
  v_mfma_f32_16x16x32_bf16 v[52:55], v[76:79], a[60:63], v[52:55]
  v_rcp_f32 v7, v7
  s_waitcnt lgkmcnt(2)
  v_mfma_f32_16x16x32_bf16 v[40:43], v[56:59], a[64:67], v[40:43]
  s_barrier
  v_add_u32 v2, s35, v0
  s_add_u32 s35, s35, 20480
  s_cmp_eq_u32 s35, 143360
  s_cselect_b32 s35, 0, s35
  ds_read_b128 v[72:75], v2 offset:0
  v_mul_f32 v18, v18, v7
  v_mfma_f32_16x16x32_bf16 v[44:47], v[56:59], a[68:71], v[44:47]
  v_mul_f32 v92, v82, v87
  v_mul_f32 v93, v82, v91
  v_mfma_f32_16x16x32_bf16 v[48:51], v[60:63], a[64:67], v[48:51]
  ds_read_b128 v[76:79], v2 offset:10240
  v_fma_f32 v11, v11, v80, -v92
  v_mfma_f32_16x16x32_bf16 v[52:55], v[60:63], a[68:71], v[52:55]
  v_fma_f32 v19, v19, v80, -v93
  v_mul_f32 v94, 3216550459, v11
  s_waitcnt lgkmcnt(2)
  v_mfma_f32_16x16x32_bf16 v[40:43], v[64:67], a[72:75], v[40:43]
  ds_read_b128 v[56:59], v2 offset:1024
  v_mul_f32 v19, v19, v11
  v_mfma_f32_16x16x32_bf16 v[44:47], v[64:67], a[76:79], v[44:47]
  v_exp_f32 v94, v94
  v_mfma_f32_16x16x32_bf16 v[48:51], v[68:71], a[72:75], v[48:51]
  ds_read_b128 v[60:63], v2 offset:11264
  v_add_f32 v94, 1.0, v94
  v_mfma_f32_16x16x32_bf16 v[52:55], v[68:71], a[76:79], v[52:55]
  v_rcp_f32 v94, v94
  s_waitcnt lgkmcnt(2)
  v_mfma_f32_16x16x32_bf16 v[40:43], v[72:75], a[80:83], v[40:43]
  ds_read_b128 v[64:67], v2 offset:2048
  v_mul_f32 v19, v19, v94
  v_mfma_f32_16x16x32_bf16 v[44:47], v[72:75], a[84:87], v[44:47]
  v_cvt_pk_bf16_f32 v8, v16, v17
  v_cvt_pk_bf16_f32 v9, v18, v19
  v_mfma_f32_16x16x32_bf16 v[48:51], v[76:79], a[80:83], v[48:51]
  ds_read_b128 v[68:71], v2 offset:12288
  buffer_store_dwordx2 v[8:9], v0, s[12:15], s38 offen
  v_mfma_f32_16x16x32_bf16 v[52:55], v[76:79], a[84:87], v[52:55]
  v_mul_f32 v5, v83, v84
  v_mul_f32 v6, v83, v88
  s_waitcnt lgkmcnt(2)
  v_mfma_f32_16x16x32_bf16 v[40:43], v[56:59], a[88:91], v[40:43]
  ds_read_b128 v[72:75], v2 offset:3072
  v_fma_f32 v12, v12, v81, -v5
  v_mfma_f32_16x16x32_bf16 v[44:47], v[56:59], a[92:95], v[44:47]
  v_fma_f32 v20, v20, v81, -v6
  v_mul_f32 v7, 3216550459, v12
  v_mfma_f32_16x16x32_bf16 v[48:51], v[60:63], a[88:91], v[48:51]
  ds_read_b128 v[76:79], v2 offset:13312
  v_mul_f32 v20, v20, v12
  v_mfma_f32_16x16x32_bf16 v[52:55], v[60:63], a[92:95], v[52:55]
  v_exp_f32 v7, v7
  s_waitcnt lgkmcnt(2)
  v_mfma_f32_16x16x32_bf16 v[40:43], v[64:67], a[96:99], v[40:43]
  ds_read_b128 v[56:59], v2 offset:4096
  v_add_f32 v7, 1.0, v7
  v_mfma_f32_16x16x32_bf16 v[44:47], v[64:67], a[100:103], v[44:47]
  v_rcp_f32 v7, v7
  v_mfma_f32_16x16x32_bf16 v[48:51], v[68:71], a[96:99], v[48:51]
  ds_read_b128 v[60:63], v2 offset:14336
  v_mul_f32 v20, v20, v7
  v_mfma_f32_16x16x32_bf16 v[52:55], v[68:71], a[100:103], v[52:55]
  v_mul_f32 v92, v83, v85
  v_mul_f32 v93, v83, v89
  s_waitcnt lgkmcnt(2)
  v_mfma_f32_16x16x32_bf16 v[40:43], v[72:75], a[104:107], v[40:43]
  ds_read_b128 v[64:67], v2 offset:5120
  v_fma_f32 v13, v13, v81, -v92
  v_mfma_f32_16x16x32_bf16 v[44:47], v[72:75], a[108:111], v[44:47]
  v_fma_f32 v21, v21, v81, -v93
  v_mul_f32 v94, 3216550459, v13
  v_mfma_f32_16x16x32_bf16 v[48:51], v[76:79], a[104:107], v[48:51]
  ds_read_b128 v[68:71], v2 offset:15360
  v_mul_f32 v21, v21, v13
  v_mfma_f32_16x16x32_bf16 v[52:55], v[76:79], a[108:111], v[52:55]
  v_exp_f32 v94, v94
  s_waitcnt lgkmcnt(2)
  v_mfma_f32_16x16x32_bf16 v[40:43], v[56:59], a[112:115], v[40:43]
  ds_read_b128 v[72:75], v2 offset:6144
  v_add_f32 v94, 1.0, v94
  v_mfma_f32_16x16x32_bf16 v[44:47], v[56:59], a[116:119], v[44:47]
  v_rcp_f32 v94, v94
  v_mfma_f32_16x16x32_bf16 v[48:51], v[60:63], a[112:115], v[48:51]
  ds_read_b128 v[76:79], v2 offset:16384
  v_mul_f32 v21, v21, v94
  v_mfma_f32_16x16x32_bf16 v[52:55], v[60:63], a[116:119], v[52:55]
  v_mul_f32 v5, v83, v86
  v_mul_f32 v6, v83, v90
  s_waitcnt lgkmcnt(2)
  v_mfma_f32_16x16x32_bf16 v[40:43], v[64:67], a[120:123], v[40:43]
  ds_read_b128 v[56:59], v2 offset:7168
  v_fma_f32 v14, v14, v81, -v5
  v_mfma_f32_16x16x32_bf16 v[44:47], v[64:67], a[124:127], v[44:47]
  v_fma_f32 v22, v22, v81, -v6
  v_mul_f32 v7, 3216550459, v14
  v_mfma_f32_16x16x32_bf16 v[48:51], v[68:71], a[120:123], v[48:51]
  ds_read_b128 v[60:63], v2 offset:17408
  v_mul_f32 v22, v22, v14
  v_mfma_f32_16x16x32_bf16 v[52:55], v[68:71], a[124:127], v[52:55]
  v_exp_f32 v7, v7
  s_waitcnt lgkmcnt(2)
  v_mfma_f32_16x16x32_bf16 v[40:43], v[72:75], a[128:131], v[40:43]
  ds_read_b128 v[64:67], v2 offset:8192
  v_add_f32 v7, 1.0, v7
  v_mfma_f32_16x16x32_bf16 v[44:47], v[72:75], a[132:135], v[44:47]
  v_rcp_f32 v7, v7
  v_mfma_f32_16x16x32_bf16 v[48:51], v[76:79], a[128:131], v[48:51]
  ds_read_b128 v[68:71], v2 offset:18432
  v_mul_f32 v22, v22, v7
  v_mfma_f32_16x16x32_bf16 v[52:55], v[76:79], a[132:135], v[52:55]
  v_mul_f32 v92, v83, v87
  v_mul_f32 v93, v83, v91
  s_waitcnt lgkmcnt(2)
  v_mfma_f32_16x16x32_bf16 v[40:43], v[56:59], a[136:139], v[40:43]
  ds_read_b128 v[72:75], v2 offset:9216
  v_fma_f32 v15, v15, v81, -v92
  v_mfma_f32_16x16x32_bf16 v[44:47], v[56:59], a[140:143], v[44:47]
  v_fma_f32 v23, v23, v81, -v93
  v_mul_f32 v94, 3216550459, v15
  v_mfma_f32_16x16x32_bf16 v[48:51], v[60:63], a[136:139], v[48:51]
  ds_read_b128 v[76:79], v2 offset:19456
  v_mul_f32 v23, v23, v15
  v_mfma_f32_16x16x32_bf16 v[52:55], v[60:63], a[140:143], v[52:55]
  v_exp_f32 v94, v94
  s_waitcnt lgkmcnt(2)
  v_mfma_f32_16x16x32_bf16 v[40:43], v[64:67], a[144:147], v[40:43]
  s_barrier
  v_add_u32 v2, s35, v0
  s_add_u32 s35, s35, 20480
  s_cmp_eq_u32 s35, 143360
  s_cselect_b32 s35, 0, s35
  ds_read_b128 v[56:59], v2 offset:0
  v_add_f32 v94, 1.0, v94
  v_mfma_f32_16x16x32_bf16 v[44:47], v[64:67], a[148:151], v[44:47]
  v_rcp_f32 v94, v94
  v_mfma_f32_16x16x32_bf16 v[48:51], v[68:71], a[144:147], v[48:51]
  ds_read_b128 v[60:63], v2 offset:10240
  v_mul_f32 v23, v23, v94
  v_mfma_f32_16x16x32_bf16 v[52:55], v[68:71], a[148:151], v[52:55]
  v_cvt_pk_bf16_f32 v12, v20, v21
  v_cvt_pk_bf16_f32 v13, v22, v23
  s_waitcnt lgkmcnt(2)
  v_mfma_f32_16x16x32_bf16 v[40:43], v[72:75], a[152:155], v[40:43]
  ds_read_b128 v[64:67], v2 offset:1024
  buffer_store_dwordx2 v[12:13], v0, s[12:15], s39 offen
  v_mfma_f32_16x16x32_bf16 v[44:47], v[72:75], a[156:159], v[44:47]
  v_mfma_f32_16x16x32_bf16 v[48:51], v[76:79], a[152:155], v[48:51]
  ds_read_b128 v[68:71], v2 offset:11264
  v_mfma_f32_16x16x32_bf16 v[52:55], v[76:79], a[156:159], v[52:55]
  s_add_u32 s37, s21, s34
  s_lshr_b32 s38, s37, 1
  s_lshl_b32 s38, s38, 10
  s_and_b32 s37, s37, 1
  s_lshl_b32 s37, s37, 3
  s_add_u32 s38, s38, s37
  s_add_u32 s38, s38, s33
  s_cmp_lt_u32 s34, s22
  s_cselect_b32 s38, s38, 0x7ff00000
  s_add_u32 s39, s38, 55296
  s_lshl_b32 s37, s34, 6
  v_add_u32 v95, s37, v4
  ds_read_b128 v[84:87], v95
  ds_read_b128 v[88:91], v95 offset:448
  s_add_u32 s34, s34, 1
  s_waitcnt lgkmcnt(4)
  v_mfma_f32_16x16x32_bf16 v[8:11], v[56:59], a[0:3], 0
  ds_read_b128 v[72:75], v2 offset:2048
  v_mfma_f32_16x16x32_bf16 v[12:15], v[56:59], a[4:7], 0
  v_mfma_f32_16x16x32_bf16 v[16:19], v[60:63], a[0:3], 0
  ds_read_b128 v[76:79], v2 offset:12288
  v_mfma_f32_16x16x32_bf16 v[20:23], v[60:63], a[4:7], 0
  s_waitcnt lgkmcnt(2)
  v_mfma_f32_16x16x32_bf16 v[8:11], v[64:67], a[8:11], v[8:11]
  ds_read_b128 v[56:59], v2 offset:3072
  v_mfma_f32_16x16x32_bf16 v[12:15], v[64:67], a[12:15], v[12:15]
  v_mfma_f32_16x16x32_bf16 v[16:19], v[68:71], a[8:11], v[16:19]
  ds_read_b128 v[60:63], v2 offset:13312
  v_mfma_f32_16x16x32_bf16 v[20:23], v[68:71], a[12:15], v[20:23]
  s_waitcnt lgkmcnt(2)
  v_mfma_f32_16x16x32_bf16 v[8:11], v[72:75], a[16:19], v[8:11]
  ds_read_b128 v[64:67], v2 offset:4096
  v_mul_f32 v5, v82, v84
  v_mfma_f32_16x16x32_bf16 v[12:15], v[72:75], a[20:23], v[12:15]
  v_mul_f32 v6, v82, v88
  v_fma_f32 v24, v24, v80, -v5
  v_mfma_f32_16x16x32_bf16 v[16:19], v[76:79], a[16:19], v[16:19]
  ds_read_b128 v[68:71], v2 offset:14336
  v_fma_f32 v32, v32, v80, -v6
  v_mfma_f32_16x16x32_bf16 v[20:23], v[76:79], a[20:23], v[20:23]
  v_mul_f32 v7, 3216550459, v24
  v_mul_f32 v32, v32, v24
  s_waitcnt lgkmcnt(2)
  v_mfma_f32_16x16x32_bf16 v[8:11], v[56:59], a[24:27], v[8:11]
  ds_read_b128 v[72:75], v2 offset:5120
  v_mfma_f32_16x16x32_bf16 v[12:15], v[56:59], a[28:31], v[12:15]
  v_exp_f32 v7, v7
  v_mfma_f32_16x16x32_bf16 v[16:19], v[60:63], a[24:27], v[16:19]
  ds_read_b128 v[76:79], v2 offset:15360
  v_add_f32 v7, 1.0, v7
  v_mfma_f32_16x16x32_bf16 v[20:23], v[60:63], a[28:31], v[20:23]
  v_rcp_f32 v7, v7
  s_waitcnt lgkmcnt(2)
  v_mfma_f32_16x16x32_bf16 v[8:11], v[64:67], a[32:35], v[8:11]
  ds_read_b128 v[56:59], v2 offset:6144
  v_mul_f32 v32, v32, v7
  v_mfma_f32_16x16x32_bf16 v[12:15], v[64:67], a[36:39], v[12:15]
  v_mul_f32 v92, v82, v85
  v_mul_f32 v93, v82, v89
  v_mfma_f32_16x16x32_bf16 v[16:19], v[68:71], a[32:35], v[16:19]
  ds_read_b128 v[60:63], v2 offset:16384
  v_fma_f32 v25, v25, v80, -v92
  v_mfma_f32_16x16x32_bf16 v[20:23], v[68:71], a[36:39], v[20:23]
  v_fma_f32 v33, v33, v80, -v93
  v_mul_f32 v94, 3216550459, v25
  s_waitcnt lgkmcnt(2)
  v_mfma_f32_16x16x32_bf16 v[8:11], v[72:75], a[40:43], v[8:11]
  ds_read_b128 v[64:67], v2 offset:7168
  v_mul_f32 v33, v33, v25
  v_mfma_f32_16x16x32_bf16 v[12:15], v[72:75], a[44:47], v[12:15]
  v_exp_f32 v94, v94
  v_mfma_f32_16x16x32_bf16 v[16:19], v[76:79], a[40:43], v[16:19]
  ds_read_b128 v[68:71], v2 offset:17408
  v_add_f32 v94, 1.0, v94
  v_mfma_f32_16x16x32_bf16 v[20:23], v[76:79], a[44:47], v[20:23]
  v_rcp_f32 v94, v94
  s_waitcnt lgkmcnt(2)
  v_mfma_f32_16x16x32_bf16 v[8:11], v[56:59], a[48:51], v[8:11]
  ds_read_b128 v[72:75], v2 offset:8192
  v_mul_f32 v33, v33, v94
  v_mfma_f32_16x16x32_bf16 v[12:15], v[56:59], a[52:55], v[12:15]
  v_mul_f32 v5, v82, v86
  v_mul_f32 v6, v82, v90
  v_mfma_f32_16x16x32_bf16 v[16:19], v[60:63], a[48:51], v[16:19]
  ds_read_b128 v[76:79], v2 offset:18432
  v_fma_f32 v26, v26, v80, -v5
  v_mfma_f32_16x16x32_bf16 v[20:23], v[60:63], a[52:55], v[20:23]
  v_fma_f32 v34, v34, v80, -v6
  v_mul_f32 v7, 3216550459, v26
  s_waitcnt lgkmcnt(2)
  v_mfma_f32_16x16x32_bf16 v[8:11], v[64:67], a[56:59], v[8:11]
  ds_read_b128 v[56:59], v2 offset:9216
  v_mul_f32 v34, v34, v26
  v_mfma_f32_16x16x32_bf16 v[12:15], v[64:67], a[60:63], v[12:15]
  v_exp_f32 v7, v7
  v_mfma_f32_16x16x32_bf16 v[16:19], v[68:71], a[56:59], v[16:19]
  ds_read_b128 v[60:63], v2 offset:19456
  v_add_f32 v7, 1.0, v7
  v_mfma_f32_16x16x32_bf16 v[20:23], v[68:71], a[60:63], v[20:23]
  v_rcp_f32 v7, v7
  s_waitcnt lgkmcnt(2)
  v_mfma_f32_16x16x32_bf16 v[8:11], v[72:75], a[64:67], v[8:11]
  s_barrier
  v_add_u32 v2, s35, v0
  s_add_u32 s35, s35, 20480
  s_cmp_eq_u32 s35, 143360
  s_cselect_b32 s35, 0, s35
  ds_read_b128 v[64:67], v2 offset:0
  v_mul_f32 v34, v34, v7
  v_mfma_f32_16x16x32_bf16 v[12:15], v[72:75], a[68:71], v[12:15]
  v_mul_f32 v92, v82, v87
  v_mul_f32 v93, v82, v91
  v_mfma_f32_16x16x32_bf16 v[16:19], v[76:79], a[64:67], v[16:19]
  ds_read_b128 v[68:71], v2 offset:10240
  v_fma_f32 v27, v27, v80, -v92
  v_mfma_f32_16x16x32_bf16 v[20:23], v[76:79], a[68:71], v[20:23]
  v_fma_f32 v35, v35, v80, -v93
  v_mul_f32 v94, 3216550459, v27
  s_waitcnt lgkmcnt(2)
  v_mfma_f32_16x16x32_bf16 v[8:11], v[56:59], a[72:75], v[8:11]
  ds_read_b128 v[72:75], v2 offset:1024
  v_mul_f32 v35, v35, v27
  v_mfma_f32_16x16x32_bf16 v[12:15], v[56:59], a[76:79], v[12:15]
  v_exp_f32 v94, v94
  v_mfma_f32_16x16x32_bf16 v[16:19], v[60:63], a[72:75], v[16:19]
  ds_read_b128 v[76:79], v2 offset:11264
  v_add_f32 v94, 1.0, v94
  v_mfma_f32_16x16x32_bf16 v[20:23], v[60:63], a[76:79], v[20:23]
  v_rcp_f32 v94, v94
  s_waitcnt lgkmcnt(2)
  v_mfma_f32_16x16x32_bf16 v[8:11], v[64:67], a[80:83], v[8:11]
  ds_read_b128 v[56:59], v2 offset:2048
  v_mul_f32 v35, v35, v94
  v_mfma_f32_16x16x32_bf16 v[12:15], v[64:67], a[84:87], v[12:15]
  v_cvt_pk_bf16_f32 v24, v32, v33
  v_cvt_pk_bf16_f32 v25, v34, v35
  v_mfma_f32_16x16x32_bf16 v[16:19], v[68:71], a[80:83], v[16:19]
  ds_read_b128 v[60:63], v2 offset:12288
  buffer_store_dwordx2 v[24:25], v0, s[12:15], s38 offen
  v_mfma_f32_16x16x32_bf16 v[20:23], v[68:71], a[84:87], v[20:23]
  v_mul_f32 v5, v83, v84
  v_mul_f32 v6, v83, v88
  s_waitcnt lgkmcnt(2)
  v_mfma_f32_16x16x32_bf16 v[8:11], v[72:75], a[88:91], v[8:11]
  ds_read_b128 v[64:67], v2 offset:3072
  v_fma_f32 v28, v28, v81, -v5
  v_mfma_f32_16x16x32_bf16 v[12:15], v[72:75], a[92:95], v[12:15]
  v_fma_f32 v36, v36, v81, -v6
  v_mul_f32 v7, 3216550459, v28
  v_mfma_f32_16x16x32_bf16 v[16:19], v[76:79], a[88:91], v[16:19]
  ds_read_b128 v[68:71], v2 offset:13312
  v_mul_f32 v36, v36, v28
  v_mfma_f32_16x16x32_bf16 v[20:23], v[76:79], a[92:95], v[20:23]
  v_exp_f32 v7, v7
  s_waitcnt lgkmcnt(2)
  v_mfma_f32_16x16x32_bf16 v[8:11], v[56:59], a[96:99], v[8:11]
  ds_read_b128 v[72:75], v2 offset:4096
  v_add_f32 v7, 1.0, v7
  v_mfma_f32_16x16x32_bf16 v[12:15], v[56:59], a[100:103], v[12:15]
  v_rcp_f32 v7, v7
  v_mfma_f32_16x16x32_bf16 v[16:19], v[60:63], a[96:99], v[16:19]
  ds_read_b128 v[76:79], v2 offset:14336
  v_mul_f32 v36, v36, v7
  v_mfma_f32_16x16x32_bf16 v[20:23], v[60:63], a[100:103], v[20:23]
  v_mul_f32 v92, v83, v85
  v_mul_f32 v93, v83, v89
  s_waitcnt lgkmcnt(2)
  v_mfma_f32_16x16x32_bf16 v[8:11], v[64:67], a[104:107], v[8:11]
  ds_read_b128 v[56:59], v2 offset:5120
  v_fma_f32 v29, v29, v81, -v92
  v_mfma_f32_16x16x32_bf16 v[12:15], v[64:67], a[108:111], v[12:15]
  v_fma_f32 v37, v37, v81, -v93
  v_mul_f32 v94, 3216550459, v29
  v_mfma_f32_16x16x32_bf16 v[16:19], v[68:71], a[104:107], v[16:19]
  ds_read_b128 v[60:63], v2 offset:15360
  v_mul_f32 v37, v37, v29
  v_mfma_f32_16x16x32_bf16 v[20:23], v[68:71], a[108:111], v[20:23]
  v_exp_f32 v94, v94
  s_waitcnt lgkmcnt(2)
  v_mfma_f32_16x16x32_bf16 v[8:11], v[72:75], a[112:115], v[8:11]
  ds_read_b128 v[64:67], v2 offset:6144
  v_add_f32 v94, 1.0, v94
  v_mfma_f32_16x16x32_bf16 v[12:15], v[72:75], a[116:119], v[12:15]
  v_rcp_f32 v94, v94
  v_mfma_f32_16x16x32_bf16 v[16:19], v[76:79], a[112:115], v[16:19]
  ds_read_b128 v[68:71], v2 offset:16384
  v_mul_f32 v37, v37, v94
  v_mfma_f32_16x16x32_bf16 v[20:23], v[76:79], a[116:119], v[20:23]
  v_mul_f32 v5, v83, v86
  v_mul_f32 v6, v83, v90
  s_waitcnt lgkmcnt(2)
  v_mfma_f32_16x16x32_bf16 v[8:11], v[56:59], a[120:123], v[8:11]
  ds_read_b128 v[72:75], v2 offset:7168
  v_fma_f32 v30, v30, v81, -v5
  v_mfma_f32_16x16x32_bf16 v[12:15], v[56:59], a[124:127], v[12:15]
  v_fma_f32 v38, v38, v81, -v6
  v_mul_f32 v7, 3216550459, v30
  v_mfma_f32_16x16x32_bf16 v[16:19], v[60:63], a[120:123], v[16:19]
  ds_read_b128 v[76:79], v2 offset:17408
  v_mul_f32 v38, v38, v30
  v_mfma_f32_16x16x32_bf16 v[20:23], v[60:63], a[124:127], v[20:23]
  v_exp_f32 v7, v7
  s_waitcnt lgkmcnt(2)
  v_mfma_f32_16x16x32_bf16 v[8:11], v[64:67], a[128:131], v[8:11]
  ds_read_b128 v[56:59], v2 offset:8192
  v_add_f32 v7, 1.0, v7
  v_mfma_f32_16x16x32_bf16 v[12:15], v[64:67], a[132:135], v[12:15]
  v_rcp_f32 v7, v7
  v_mfma_f32_16x16x32_bf16 v[16:19], v[68:71], a[128:131], v[16:19]
  ds_read_b128 v[60:63], v2 offset:18432
  v_mul_f32 v38, v38, v7
  v_mfma_f32_16x16x32_bf16 v[20:23], v[68:71], a[132:135], v[20:23]
  v_mul_f32 v92, v83, v87
  v_mul_f32 v93, v83, v91
  s_waitcnt lgkmcnt(2)
  v_mfma_f32_16x16x32_bf16 v[8:11], v[72:75], a[136:139], v[8:11]
  ds_read_b128 v[64:67], v2 offset:9216
  v_fma_f32 v31, v31, v81, -v92
  v_mfma_f32_16x16x32_bf16 v[12:15], v[72:75], a[140:143], v[12:15]
  v_fma_f32 v39, v39, v81, -v93
  v_mul_f32 v94, 3216550459, v31
  v_mfma_f32_16x16x32_bf16 v[16:19], v[76:79], a[136:139], v[16:19]
  ds_read_b128 v[68:71], v2 offset:19456
  v_mul_f32 v39, v39, v31
  v_mfma_f32_16x16x32_bf16 v[20:23], v[76:79], a[140:143], v[20:23]
  v_exp_f32 v94, v94
  s_waitcnt lgkmcnt(2)
  v_mfma_f32_16x16x32_bf16 v[8:11], v[56:59], a[144:147], v[8:11]
  s_barrier
  v_add_u32 v2, s35, v0
  s_add_u32 s35, s35, 20480
  s_cmp_eq_u32 s35, 143360
  s_cselect_b32 s35, 0, s35
  ds_read_b128 v[72:75], v2 offset:0
  v_add_f32 v94, 1.0, v94
  v_mfma_f32_16x16x32_bf16 v[12:15], v[56:59], a[148:151], v[12:15]
  v_rcp_f32 v94, v94
  v_mfma_f32_16x16x32_bf16 v[16:19], v[60:63], a[144:147], v[16:19]
  ds_read_b128 v[76:79], v2 offset:10240
  v_mul_f32 v39, v39, v94
  v_mfma_f32_16x16x32_bf16 v[20:23], v[60:63], a[148:151], v[20:23]
  v_cvt_pk_bf16_f32 v28, v36, v37
  v_cvt_pk_bf16_f32 v29, v38, v39
  s_waitcnt lgkmcnt(2)
  v_mfma_f32_16x16x32_bf16 v[8:11], v[64:67], a[152:155], v[8:11]
  ds_read_b128 v[56:59], v2 offset:1024
  buffer_store_dwordx2 v[28:29], v0, s[12:15], s39 offen
  v_mfma_f32_16x16x32_bf16 v[12:15], v[64:67], a[156:159], v[12:15]
  v_mfma_f32_16x16x32_bf16 v[16:19], v[68:71], a[152:155], v[16:19]
  ds_read_b128 v[60:63], v2 offset:11264
  v_mfma_f32_16x16x32_bf16 v[20:23], v[68:71], a[156:159], v[20:23]
  s_cmp_eq_u32 s40, 1
  s_cbranch_scc1 L_gu_fin
  s_add_u32 s37, s21, s34
  s_lshr_b32 s38, s37, 1
  s_lshl_b32 s38, s38, 10
  s_and_b32 s37, s37, 1
  s_lshl_b32 s37, s37, 3
  s_add_u32 s38, s38, s37
  s_add_u32 s38, s38, s33
  s_cmp_lt_u32 s34, s22
  s_cselect_b32 s38, s38, 0x7ff00000
  s_add_u32 s39, s38, 55296
  s_lshl_b32 s37, s34, 6
  v_add_u32 v95, s37, v4
  ds_read_b128 v[84:87], v95
  ds_read_b128 v[88:91], v95 offset:448
  s_add_u32 s34, s34, 1
  s_waitcnt lgkmcnt(4)
  v_mfma_f32_16x16x32_bf16 v[24:27], v[72:75], a[0:3], 0
  ds_read_b128 v[64:67], v2 offset:2048
  v_mfma_f32_16x16x32_bf16 v[28:31], v[72:75], a[4:7], 0
  v_mfma_f32_16x16x32_bf16 v[32:35], v[76:79], a[0:3], 0
  ds_read_b128 v[68:71], v2 offset:12288
  v_mfma_f32_16x16x32_bf16 v[36:39], v[76:79], a[4:7], 0
  s_waitcnt lgkmcnt(2)
  v_mfma_f32_16x16x32_bf16 v[24:27], v[56:59], a[8:11], v[24:27]
  ds_read_b128 v[72:75], v2 offset:3072
  v_mfma_f32_16x16x32_bf16 v[28:31], v[56:59], a[12:15], v[28:31]
  v_mfma_f32_16x16x32_bf16 v[32:35], v[60:63], a[8:11], v[32:35]
  ds_read_b128 v[76:79], v2 offset:13312
  v_mfma_f32_16x16x32_bf16 v[36:39], v[60:63], a[12:15], v[36:39]
  s_waitcnt lgkmcnt(2)
  v_mfma_f32_16x16x32_bf16 v[24:27], v[64:67], a[16:19], v[24:27]
  ds_read_b128 v[56:59], v2 offset:4096
  v_mul_f32 v5, v82, v84
  v_mfma_f32_16x16x32_bf16 v[28:31], v[64:67], a[20:23], v[28:31]
  v_mul_f32 v6, v82, v88
  v_fma_f32 v40, v40, v80, -v5
  v_mfma_f32_16x16x32_bf16 v[32:35], v[68:71], a[16:19], v[32:35]
  ds_read_b128 v[60:63], v2 offset:14336
  v_fma_f32 v48, v48, v80, -v6
  v_mfma_f32_16x16x32_bf16 v[36:39], v[68:71], a[20:23], v[36:39]
  v_mul_f32 v7, 3216550459, v40
  v_mul_f32 v48, v48, v40
  s_waitcnt lgkmcnt(2)
  v_mfma_f32_16x16x32_bf16 v[24:27], v[72:75], a[24:27], v[24:27]
  ds_read_b128 v[64:67], v2 offset:5120
  v_mfma_f32_16x16x32_bf16 v[28:31], v[72:75], a[28:31], v[28:31]
  v_exp_f32 v7, v7
  v_mfma_f32_16x16x32_bf16 v[32:35], v[76:79], a[24:27], v[32:35]
  ds_read_b128 v[68:71], v2 offset:15360
  v_add_f32 v7, 1.0, v7
  v_mfma_f32_16x16x32_bf16 v[36:39], v[76:79], a[28:31], v[36:39]
  v_rcp_f32 v7, v7
  s_waitcnt lgkmcnt(2)
  v_mfma_f32_16x16x32_bf16 v[24:27], v[56:59], a[32:35], v[24:27]
  ds_read_b128 v[72:75], v2 offset:6144
  v_mul_f32 v48, v48, v7
  v_mfma_f32_16x16x32_bf16 v[28:31], v[56:59], a[36:39], v[28:31]
  v_mul_f32 v92, v82, v85
  v_mul_f32 v93, v82, v89
  v_mfma_f32_16x16x32_bf16 v[32:35], v[60:63], a[32:35], v[32:35]
  ds_read_b128 v[76:79], v2 offset:16384
  v_fma_f32 v41, v41, v80, -v92
  v_mfma_f32_16x16x32_bf16 v[36:39], v[60:63], a[36:39], v[36:39]
  v_fma_f32 v49, v49, v80, -v93
  v_mul_f32 v94, 3216550459, v41
  s_waitcnt lgkmcnt(2)
  v_mfma_f32_16x16x32_bf16 v[24:27], v[64:67], a[40:43], v[24:27]
  ds_read_b128 v[56:59], v2 offset:7168
  v_mul_f32 v49, v49, v41
  v_mfma_f32_16x16x32_bf16 v[28:31], v[64:67], a[44:47], v[28:31]
  v_exp_f32 v94, v94
  v_mfma_f32_16x16x32_bf16 v[32:35], v[68:71], a[40:43], v[32:35]
  ds_read_b128 v[60:63], v2 offset:17408
  v_add_f32 v94, 1.0, v94
  v_mfma_f32_16x16x32_bf16 v[36:39], v[68:71], a[44:47], v[36:39]
  v_rcp_f32 v94, v94
  s_waitcnt lgkmcnt(2)
  v_mfma_f32_16x16x32_bf16 v[24:27], v[72:75], a[48:51], v[24:27]
  ds_read_b128 v[64:67], v2 offset:8192
  v_mul_f32 v49, v49, v94
  v_mfma_f32_16x16x32_bf16 v[28:31], v[72:75], a[52:55], v[28:31]
  v_mul_f32 v5, v82, v86
  v_mul_f32 v6, v82, v90
  v_mfma_f32_16x16x32_bf16 v[32:35], v[76:79], a[48:51], v[32:35]
  ds_read_b128 v[68:71], v2 offset:18432
  v_fma_f32 v42, v42, v80, -v5
  v_mfma_f32_16x16x32_bf16 v[36:39], v[76:79], a[52:55], v[36:39]
  v_fma_f32 v50, v50, v80, -v6
  v_mul_f32 v7, 3216550459, v42
  s_waitcnt lgkmcnt(2)
  v_mfma_f32_16x16x32_bf16 v[24:27], v[56:59], a[56:59], v[24:27]
  ds_read_b128 v[72:75], v2 offset:9216
  v_mul_f32 v50, v50, v42
  v_mfma_f32_16x16x32_bf16 v[28:31], v[56:59], a[60:63], v[28:31]
  v_exp_f32 v7, v7
  v_mfma_f32_16x16x32_bf16 v[32:35], v[60:63], a[56:59], v[32:35]
  ds_read_b128 v[76:79], v2 offset:19456
  v_add_f32 v7, 1.0, v7
  v_mfma_f32_16x16x32_bf16 v[36:39], v[60:63], a[60:63], v[36:39]
  v_rcp_f32 v7, v7
  s_waitcnt lgkmcnt(2)
  v_mfma_f32_16x16x32_bf16 v[24:27], v[64:67], a[64:67], v[24:27]
  s_barrier
  v_add_u32 v2, s35, v0
  s_add_u32 s35, s35, 20480
  s_cmp_eq_u32 s35, 143360
  s_cselect_b32 s35, 0, s35
  ds_read_b128 v[56:59], v2 offset:0
  v_mul_f32 v50, v50, v7
  v_mfma_f32_16x16x32_bf16 v[28:31], v[64:67], a[68:71], v[28:31]
  v_mul_f32 v92, v82, v87
  v_mul_f32 v93, v82, v91
  v_mfma_f32_16x16x32_bf16 v[32:35], v[68:71], a[64:67], v[32:35]
  ds_read_b128 v[60:63], v2 offset:10240
  v_fma_f32 v43, v43, v80, -v92
  v_mfma_f32_16x16x32_bf16 v[36:39], v[68:71], a[68:71], v[36:39]
  v_fma_f32 v51, v51, v80, -v93
  v_mul_f32 v94, 3216550459, v43
  s_waitcnt lgkmcnt(2)
  v_mfma_f32_16x16x32_bf16 v[24:27], v[72:75], a[72:75], v[24:27]
  ds_read_b128 v[64:67], v2 offset:1024
  v_mul_f32 v51, v51, v43
  v_mfma_f32_16x16x32_bf16 v[28:31], v[72:75], a[76:79], v[28:31]
  v_exp_f32 v94, v94
  v_mfma_f32_16x16x32_bf16 v[32:35], v[76:79], a[72:75], v[32:35]
  ds_read_b128 v[68:71], v2 offset:11264
  v_add_f32 v94, 1.0, v94
  v_mfma_f32_16x16x32_bf16 v[36:39], v[76:79], a[76:79], v[36:39]
  v_rcp_f32 v94, v94
  s_waitcnt lgkmcnt(2)
  v_mfma_f32_16x16x32_bf16 v[24:27], v[56:59], a[80:83], v[24:27]
  ds_read_b128 v[72:75], v2 offset:2048
  v_mul_f32 v51, v51, v94
  v_mfma_f32_16x16x32_bf16 v[28:31], v[56:59], a[84:87], v[28:31]
  v_cvt_pk_bf16_f32 v40, v48, v49
  v_cvt_pk_bf16_f32 v41, v50, v51
  v_mfma_f32_16x16x32_bf16 v[32:35], v[60:63], a[80:83], v[32:35]
  ds_read_b128 v[76:79], v2 offset:12288
  buffer_store_dwordx2 v[40:41], v0, s[12:15], s38 offen
  v_mfma_f32_16x16x32_bf16 v[36:39], v[60:63], a[84:87], v[36:39]
  v_mul_f32 v5, v83, v84
  v_mul_f32 v6, v83, v88
  s_waitcnt lgkmcnt(2)
  v_mfma_f32_16x16x32_bf16 v[24:27], v[64:67], a[88:91], v[24:27]
  ds_read_b128 v[56:59], v2 offset:3072
  v_fma_f32 v44, v44, v81, -v5
  v_mfma_f32_16x16x32_bf16 v[28:31], v[64:67], a[92:95], v[28:31]
  v_fma_f32 v52, v52, v81, -v6
  v_mul_f32 v7, 3216550459, v44
  v_mfma_f32_16x16x32_bf16 v[32:35], v[68:71], a[88:91], v[32:35]
  ds_read_b128 v[60:63], v2 offset:13312
  v_mul_f32 v52, v52, v44
  v_mfma_f32_16x16x32_bf16 v[36:39], v[68:71], a[92:95], v[36:39]
  v_exp_f32 v7, v7
  s_waitcnt lgkmcnt(2)
  v_mfma_f32_16x16x32_bf16 v[24:27], v[72:75], a[96:99], v[24:27]
  ds_read_b128 v[64:67], v2 offset:4096
  v_add_f32 v7, 1.0, v7
  v_mfma_f32_16x16x32_bf16 v[28:31], v[72:75], a[100:103], v[28:31]
  v_rcp_f32 v7, v7
  v_mfma_f32_16x16x32_bf16 v[32:35], v[76:79], a[96:99], v[32:35]
  ds_read_b128 v[68:71], v2 offset:14336
  v_mul_f32 v52, v52, v7
  v_mfma_f32_16x16x32_bf16 v[36:39], v[76:79], a[100:103], v[36:39]
  v_mul_f32 v92, v83, v85
  v_mul_f32 v93, v83, v89
  s_waitcnt lgkmcnt(2)
  v_mfma_f32_16x16x32_bf16 v[24:27], v[56:59], a[104:107], v[24:27]
  ds_read_b128 v[72:75], v2 offset:5120
  v_fma_f32 v45, v45, v81, -v92
  v_mfma_f32_16x16x32_bf16 v[28:31], v[56:59], a[108:111], v[28:31]
  v_fma_f32 v53, v53, v81, -v93
  v_mul_f32 v94, 3216550459, v45
  v_mfma_f32_16x16x32_bf16 v[32:35], v[60:63], a[104:107], v[32:35]
  ds_read_b128 v[76:79], v2 offset:15360
  v_mul_f32 v53, v53, v45
  v_mfma_f32_16x16x32_bf16 v[36:39], v[60:63], a[108:111], v[36:39]
  v_exp_f32 v94, v94
  s_waitcnt lgkmcnt(2)
  v_mfma_f32_16x16x32_bf16 v[24:27], v[64:67], a[112:115], v[24:27]
  ds_read_b128 v[56:59], v2 offset:6144
  v_add_f32 v94, 1.0, v94
  v_mfma_f32_16x16x32_bf16 v[28:31], v[64:67], a[116:119], v[28:31]
  v_rcp_f32 v94, v94
  v_mfma_f32_16x16x32_bf16 v[32:35], v[68:71], a[112:115], v[32:35]
  ds_read_b128 v[60:63], v2 offset:16384
  v_mul_f32 v53, v53, v94
  v_mfma_f32_16x16x32_bf16 v[36:39], v[68:71], a[116:119], v[36:39]
  v_mul_f32 v5, v83, v86
  v_mul_f32 v6, v83, v90
  s_waitcnt lgkmcnt(2)
  v_mfma_f32_16x16x32_bf16 v[24:27], v[72:75], a[120:123], v[24:27]
  ds_read_b128 v[64:67], v2 offset:7168
  v_fma_f32 v46, v46, v81, -v5
  v_mfma_f32_16x16x32_bf16 v[28:31], v[72:75], a[124:127], v[28:31]
  v_fma_f32 v54, v54, v81, -v6
  v_mul_f32 v7, 3216550459, v46
  v_mfma_f32_16x16x32_bf16 v[32:35], v[76:79], a[120:123], v[32:35]
  ds_read_b128 v[68:71], v2 offset:17408
  v_mul_f32 v54, v54, v46
  v_mfma_f32_16x16x32_bf16 v[36:39], v[76:79], a[124:127], v[36:39]
  v_exp_f32 v7, v7
  s_waitcnt lgkmcnt(2)
  v_mfma_f32_16x16x32_bf16 v[24:27], v[56:59], a[128:131], v[24:27]
  ds_read_b128 v[72:75], v2 offset:8192
  v_add_f32 v7, 1.0, v7
  v_mfma_f32_16x16x32_bf16 v[28:31], v[56:59], a[132:135], v[28:31]
  v_rcp_f32 v7, v7
  v_mfma_f32_16x16x32_bf16 v[32:35], v[60:63], a[128:131], v[32:35]
  ds_read_b128 v[76:79], v2 offset:18432
  v_mul_f32 v54, v54, v7
  v_mfma_f32_16x16x32_bf16 v[36:39], v[60:63], a[132:135], v[36:39]
  v_mul_f32 v92, v83, v87
  v_mul_f32 v93, v83, v91
  s_waitcnt lgkmcnt(2)
  v_mfma_f32_16x16x32_bf16 v[24:27], v[64:67], a[136:139], v[24:27]
  ds_read_b128 v[56:59], v2 offset:9216
  v_fma_f32 v47, v47, v81, -v92
  v_mfma_f32_16x16x32_bf16 v[28:31], v[64:67], a[140:143], v[28:31]
  v_fma_f32 v55, v55, v81, -v93
  v_mul_f32 v94, 3216550459, v47
  v_mfma_f32_16x16x32_bf16 v[32:35], v[68:71], a[136:139], v[32:35]
  ds_read_b128 v[60:63], v2 offset:19456
  v_mul_f32 v55, v55, v47
  v_mfma_f32_16x16x32_bf16 v[36:39], v[68:71], a[140:143], v[36:39]
  v_exp_f32 v94, v94
  s_waitcnt lgkmcnt(2)
  v_mfma_f32_16x16x32_bf16 v[24:27], v[72:75], a[144:147], v[24:27]
  s_barrier
  v_add_u32 v2, s35, v0
  s_add_u32 s35, s35, 20480
  s_cmp_eq_u32 s35, 143360
  s_cselect_b32 s35, 0, s35
  ds_read_b128 v[64:67], v2 offset:0
  v_add_f32 v94, 1.0, v94
  v_mfma_f32_16x16x32_bf16 v[28:31], v[72:75], a[148:151], v[28:31]
  v_rcp_f32 v94, v94
  v_mfma_f32_16x16x32_bf16 v[32:35], v[76:79], a[144:147], v[32:35]
  ds_read_b128 v[68:71], v2 offset:10240
  v_mul_f32 v55, v55, v94
  v_mfma_f32_16x16x32_bf16 v[36:39], v[76:79], a[148:151], v[36:39]
  v_cvt_pk_bf16_f32 v44, v52, v53
  v_cvt_pk_bf16_f32 v45, v54, v55
  s_waitcnt lgkmcnt(2)
  v_mfma_f32_16x16x32_bf16 v[24:27], v[56:59], a[152:155], v[24:27]
  ds_read_b128 v[72:75], v2 offset:1024
  buffer_store_dwordx2 v[44:45], v0, s[12:15], s39 offen
  v_mfma_f32_16x16x32_bf16 v[28:31], v[56:59], a[156:159], v[28:31]
  v_mfma_f32_16x16x32_bf16 v[32:35], v[60:63], a[152:155], v[32:35]
  ds_read_b128 v[76:79], v2 offset:11264
  v_mfma_f32_16x16x32_bf16 v[36:39], v[60:63], a[156:159], v[36:39]
  s_mov_b32 s40, 1
  s_branch L_gu_loop
L_gu_fin:
  s_add_u32 s37, s21, s34
  s_lshr_b32 s38, s37, 1
  s_lshl_b32 s38, s38, 10
  s_and_b32 s37, s37, 1
  s_lshl_b32 s37, s37, 3
  s_add_u32 s38, s38, s37
  s_add_u32 s38, s38, s33
  s_cmp_lt_u32 s34, s22
  s_cselect_b32 s38, s38, 0x7ff00000
  s_add_u32 s39, s38, 55296
  s_lshl_b32 s37, s34, 6
  v_add_u32 v95, s37, v4
  ds_read_b128 v[84:87], v95
  ds_read_b128 v[88:91], v95 offset:448
  s_add_u32 s34, s34, 1
  s_mov_b32 s48, s38
  s_mov_b32 s49, s39
  s_add_u32 s37, s21, s34
  s_lshr_b32 s38, s37, 1
  s_lshl_b32 s38, s38, 10
  s_and_b32 s37, s37, 1
  s_lshl_b32 s37, s37, 3
  s_add_u32 s38, s38, s37
  s_add_u32 s38, s38, s33
  s_cmp_lt_u32 s34, s22
  s_cselect_b32 s38, s38, 0x7ff00000
  s_add_u32 s39, s38, 55296
  s_lshl_b32 s37, s34, 6
  v_add_u32 v56, s37, v4
  ds_read_b128 v[24:27], v56
  ds_read_b128 v[28:31], v56 offset:448
  s_add_u32 s34, s34, 1
  s_waitcnt lgkmcnt(0)
  s_nop 4
  v_mul_f32 v5, v82, v84
  v_mul_f32 v32, v82, v24
  v_mul_f32 v6, v82, v88
  v_mul_f32 v33, v82, v28
  v_fma_f32 v40, v40, v80, -v5
  v_fma_f32 v8, v8, v80, -v32
  v_fma_f32 v48, v48, v80, -v6
  v_fma_f32 v16, v16, v80, -v33
  v_mul_f32 v7, 3216550459, v40
  v_mul_f32 v34, 3216550459, v8
  v_mul_f32 v48, v48, v40
  v_mul_f32 v16, v16, v8
  v_exp_f32 v7, v7
  v_exp_f32 v34, v34
  v_add_f32 v7, 1.0, v7
  v_add_f32 v34, 1.0, v34
  v_rcp_f32 v7, v7
  v_rcp_f32 v34, v34
  v_mul_f32 v48, v48, v7
  v_mul_f32 v16, v16, v34
  v_mul_f32 v92, v82, v85
  v_mul_f32 v35, v82, v25
  v_mul_f32 v93, v82, v89
  v_mul_f32 v36, v82, v29
  v_fma_f32 v41, v41, v80, -v92
  v_fma_f32 v9, v9, v80, -v35
  v_fma_f32 v49, v49, v80, -v93
  v_fma_f32 v17, v17, v80, -v36
  v_mul_f32 v94, 3216550459, v41
  v_mul_f32 v37, 3216550459, v9
  v_mul_f32 v49, v49, v41
  v_mul_f32 v17, v17, v9
  v_exp_f32 v94, v94
  v_exp_f32 v37, v37
  v_add_f32 v94, 1.0, v94
  v_add_f32 v37, 1.0, v37
  v_rcp_f32 v94, v94
  v_rcp_f32 v37, v37
  v_mul_f32 v49, v49, v94
  v_mul_f32 v17, v17, v37
  v_mul_f32 v5, v82, v86
  v_mul_f32 v32, v82, v26
  v_mul_f32 v6, v82, v90
  v_mul_f32 v33, v82, v30
  v_fma_f32 v42, v42, v80, -v5
  v_fma_f32 v10, v10, v80, -v32
  v_fma_f32 v50, v50, v80, -v6
  v_fma_f32 v18, v18, v80, -v33
  v_mul_f32 v7, 3216550459, v42
  v_mul_f32 v34, 3216550459, v10
  v_mul_f32 v50, v50, v42
  v_mul_f32 v18, v18, v10
  v_exp_f32 v7, v7
  v_exp_f32 v34, v34
  v_add_f32 v7, 1.0, v7
  v_add_f32 v34, 1.0, v34
  v_rcp_f32 v7, v7
  v_rcp_f32 v34, v34
  v_mul_f32 v50, v50, v7
  v_mul_f32 v18, v18, v34
  v_mul_f32 v92, v82, v87
  v_mul_f32 v35, v82, v27
  v_mul_f32 v93, v82, v91
  v_mul_f32 v36, v82, v31
  v_fma_f32 v43, v43, v80, -v92
  v_fma_f32 v11, v11, v80, -v35
  v_fma_f32 v51, v51, v80, -v93
  v_fma_f32 v19, v19, v80, -v36
  v_mul_f32 v94, 3216550459, v43
  v_mul_f32 v37, 3216550459, v11
  v_mul_f32 v51, v51, v43
  v_mul_f32 v19, v19, v11
  v_exp_f32 v94, v94
  v_exp_f32 v37, v37
  v_add_f32 v94, 1.0, v94
  v_add_f32 v37, 1.0, v37
  v_rcp_f32 v94, v94
  v_rcp_f32 v37, v37
  v_mul_f32 v51, v51, v94
  v_mul_f32 v19, v19, v37
  v_cvt_pk_bf16_f32 v40, v48, v49
  v_cvt_pk_bf16_f32 v8, v16, v17
  v_cvt_pk_bf16_f32 v41, v50, v51
  v_cvt_pk_bf16_f32 v9, v18, v19
  buffer_store_dwordx2 v[40:41], v0, s[12:15], s48 offen
  buffer_store_dwordx2 v[8:9], v0, s[12:15], s38 offen
  v_mul_f32 v5, v83, v84
  v_mul_f32 v32, v83, v24
  v_mul_f32 v6, v83, v88
  v_mul_f32 v33, v83, v28
  v_fma_f32 v44, v44, v81, -v5
  v_fma_f32 v12, v12, v81, -v32
  v_fma_f32 v52, v52, v81, -v6
  v_fma_f32 v20, v20, v81, -v33
  v_mul_f32 v7, 3216550459, v44
  v_mul_f32 v34, 3216550459, v12
  v_mul_f32 v52, v52, v44
  v_mul_f32 v20, v20, v12
  v_exp_f32 v7, v7
  v_exp_f32 v34, v34
  v_add_f32 v7, 1.0, v7
  v_add_f32 v34, 1.0, v34
  v_rcp_f32 v7, v7
  v_rcp_f32 v34, v34
  v_mul_f32 v52, v52, v7
  v_mul_f32 v20, v20, v34
  v_mul_f32 v92, v83, v85
  v_mul_f32 v35, v83, v25
  v_mul_f32 v93, v83, v89
  v_mul_f32 v36, v83, v29
  v_fma_f32 v45, v45, v81, -v92
  v_fma_f32 v13, v13, v81, -v35
  v_fma_f32 v53, v53, v81, -v93
  v_fma_f32 v21, v21, v81, -v36
  v_mul_f32 v94, 3216550459, v45
  v_mul_f32 v37, 3216550459, v13
  v_mul_f32 v53, v53, v45
  v_mul_f32 v21, v21, v13
  v_exp_f32 v94, v94
  v_exp_f32 v37, v37
  v_add_f32 v94, 1.0, v94
  v_add_f32 v37, 1.0, v37
  v_rcp_f32 v94, v94
  v_rcp_f32 v37, v37
  v_mul_f32 v53, v53, v94
  v_mul_f32 v21, v21, v37
  v_mul_f32 v5, v83, v86
  v_mul_f32 v32, v83, v26
  v_mul_f32 v6, v83, v90
  v_mul_f32 v33, v83, v30
  v_fma_f32 v46, v46, v81, -v5
  v_fma_f32 v14, v14, v81, -v32
  v_fma_f32 v54, v54, v81, -v6
  v_fma_f32 v22, v22, v81, -v33
  v_mul_f32 v7, 3216550459, v46
  v_mul_f32 v34, 3216550459, v14
  v_mul_f32 v54, v54, v46
  v_mul_f32 v22, v22, v14
  v_exp_f32 v7, v7
  v_exp_f32 v34, v34
  v_add_f32 v7, 1.0, v7
  v_add_f32 v34, 1.0, v34
  v_rcp_f32 v7, v7
  v_rcp_f32 v34, v34
  v_mul_f32 v54, v54, v7
  v_mul_f32 v22, v22, v34
  v_mul_f32 v92, v83, v87
  v_mul_f32 v35, v83, v27
  v_mul_f32 v93, v83, v91
  v_mul_f32 v36, v83, v31
  v_fma_f32 v47, v47, v81, -v92
  v_fma_f32 v15, v15, v81, -v35
  v_fma_f32 v55, v55, v81, -v93
  v_fma_f32 v23, v23, v81, -v36
  v_mul_f32 v94, 3216550459, v47
  v_mul_f32 v37, 3216550459, v15
  v_mul_f32 v55, v55, v47
  v_mul_f32 v23, v23, v15
  v_exp_f32 v94, v94
  v_exp_f32 v37, v37
  v_add_f32 v94, 1.0, v94
  v_add_f32 v37, 1.0, v37
  v_rcp_f32 v94, v94
  v_rcp_f32 v37, v37
  v_mul_f32 v55, v55, v94
  v_mul_f32 v23, v23, v37
  v_cvt_pk_bf16_f32 v44, v52, v53
  v_cvt_pk_bf16_f32 v12, v20, v21
  v_cvt_pk_bf16_f32 v45, v54, v55
  v_cvt_pk_bf16_f32 v13, v22, v23
  buffer_store_dwordx2 v[44:45], v0, s[12:15], s49 offen
  buffer_store_dwordx2 v[12:13], v0, s[12:15], s39 offen
  s_endpgm
L_gu_end:
  s_endpgm
.globl down_kernel
.p2align 8
.type down_kernel,@function
down_kernel:
  s_cmp_ge_u32 s2, 256
  s_cbranch_scc1 L_down_kernel_end
  s_load_dwordx2 s[12:13], s[0:1], 72
  s_load_dwordx2 s[4:5], s[0:1], 56
  v_lshrrev_b32 v1, 6, v0
  v_and_b32 v2, 63, v0
  s_and_b32 s16, s2, 7
  v_readfirstlane_b32 s3, v1
  s_lshr_b32 s17, s2, 3
  s_and_b32 s18, s17, 7
  s_lshl_b32 s19, s16, 2
  s_lshr_b32 s20, s17, 3
  s_add_u32 s19, s19, s20
  v_lshlrev_b32 v3, 4, v2
  s_and_b32 s50, s17, 3
  s_mul_i32 s50, s50, 0
  s_lshr_b32 s51, s17, 2
  s_mul_i32 s51, s51, 0
  s_add_u32 s50, s50, s51
  s_mul_hi_u32 s51, s50, 159072863
  s_mul_i32 s51, s51, 27
  s_sub_u32 s50, s50, s51
  s_waitcnt lgkmcnt(0)
  s_and_b32 s13, s13, 0xffff
  s_mov_b32 s14, 32751616
  s_mov_b32 s15, 0x00020000
  s_and_b32 s5, s5, 0xffff
  s_mov_b32 s6, 2621440
  s_mov_b32 s7, 0x00020000
  s_cmp_ge_u32 s3, 4
  s_cbranch_scc0 L_down_kernel_loader_else
  s_sub_u32 s20, s3, 4
  s_mul_i32 s24, s18, 270
  s_lshl_b32 s24, s24, 10
  s_add_u32 s24, s24, 7700480
  s_add_u32 s25, s24, 0
  v_add_u32 v8, s25, v3
  s_add_u32 s25, s24, 55296
  v_add_u32 v9, s25, v3
  s_add_u32 s25, s24, 110592
  v_add_u32 v10, s25, v3
  s_add_u32 s25, s24, 165888
  v_add_u32 v11, s25, v3
  s_add_u32 s25, s24, 221184
  v_add_u32 v12, s25, v3
  s_lshl_b32 s26, s20, 10
  s_add_u32 s46, s26, 55296
  s_lshl_b32 s47, s50, 11
  s_add_u32 s26, s26, s47
  s_mul_i32 s27, s20, 5120
  s_add_u32 m0, s27, 0
  s_nop 0
  buffer_load_dwordx4 v8, s[12:15], s26 offen lds
  s_add_u32 m0, s27, 1024
  s_nop 0
  buffer_load_dwordx4 v9, s[12:15], s26 offen lds
  s_add_u32 m0, s27, 2048
  s_nop 0
  buffer_load_dwordx4 v10, s[12:15], s26 offen lds
  s_add_u32 m0, s27, 3072
  s_nop 0
  buffer_load_dwordx4 v11, s[12:15], s26 offen lds
  s_add_u32 m0, s27, 4096
  s_nop 0
  buffer_load_dwordx4 v12, s[12:15], s26 offen lds
  s_add_u32 s26, s26, 2048
  s_sub_u32 s47, s26, 55296
  s_cmp_ge_u32 s26, s46
  s_cselect_b32 s26, s47, s26
  s_add_u32 m0, s27, 10240
  s_nop 0
  buffer_load_dwordx4 v8, s[12:15], s26 offen lds
  s_add_u32 m0, s27, 11264
  s_nop 0
  buffer_load_dwordx4 v9, s[12:15], s26 offen lds
  s_add_u32 m0, s27, 12288
  s_nop 0
  buffer_load_dwordx4 v10, s[12:15], s26 offen lds
  s_add_u32 m0, s27, 13312
  s_nop 0
  buffer_load_dwordx4 v11, s[12:15], s26 offen lds
  s_add_u32 m0, s27, 14336
  s_nop 0
  buffer_load_dwordx4 v12, s[12:15], s26 offen lds
  s_add_u32 s26, s26, 2048
  s_sub_u32 s47, s26, 55296
  s_cmp_ge_u32 s26, s46
  s_cselect_b32 s26, s47, s26
  s_add_u32 m0, s27, 20480
  s_nop 0
  buffer_load_dwordx4 v8, s[12:15], s26 offen lds
  s_add_u32 m0, s27, 21504
  s_nop 0
  buffer_load_dwordx4 v9, s[12:15], s26 offen lds
  s_add_u32 m0, s27, 22528
  s_nop 0
  buffer_load_dwordx4 v10, s[12:15], s26 offen lds
  s_add_u32 m0, s27, 23552
  s_nop 0
  buffer_load_dwordx4 v11, s[12:15], s26 offen lds
  s_add_u32 m0, s27, 24576
  s_nop 0
  buffer_load_dwordx4 v12, s[12:15], s26 offen lds
  s_add_u32 s26, s26, 2048
  s_sub_u32 s47, s26, 55296
  s_cmp_ge_u32 s26, s46
  s_cselect_b32 s26, s47, s26
  s_waitcnt vmcnt(10)
  s_barrier
  s_add_u32 m0, s27, 30720
  s_nop 0
  buffer_load_dwordx4 v8, s[12:15], s26 offen lds
  s_add_u32 m0, s27, 31744
  s_nop 0
  buffer_load_dwordx4 v9, s[12:15], s26 offen lds
  s_add_u32 m0, s27, 32768
  s_nop 0
  buffer_load_dwordx4 v10, s[12:15], s26 offen lds
  s_add_u32 m0, s27, 33792
  s_nop 0
  buffer_load_dwordx4 v11, s[12:15], s26 offen lds
  s_add_u32 m0, s27, 34816
  s_nop 0
  buffer_load_dwordx4 v12, s[12:15], s26 offen lds
  s_add_u32 s26, s26, 2048
  s_sub_u32 s47, s26, 55296
  s_cmp_ge_u32 s26, s46
  s_cselect_b32 s26, s47, s26
  s_add_u32 m0, s27, 40960
  s_nop 0
  buffer_load_dwordx4 v8, s[12:15], s26 offen lds
  s_add_u32 m0, s27, 41984
  s_nop 0
  buffer_load_dwordx4 v9, s[12:15], s26 offen lds
  s_add_u32 m0, s27, 43008
  s_nop 0
  buffer_load_dwordx4 v10, s[12:15], s26 offen lds
  s_add_u32 m0, s27, 44032
  s_nop 0
  buffer_load_dwordx4 v11, s[12:15], s26 offen lds
  s_add_u32 m0, s27, 45056
  s_nop 0
  buffer_load_dwordx4 v12, s[12:15], s26 offen lds
  s_add_u32 s26, s26, 2048
  s_sub_u32 s47, s26, 55296
  s_cmp_ge_u32 s26, s46
  s_cselect_b32 s26, s47, s26
  s_add_u32 m0, s27, 51200
  s_nop 0
  buffer_load_dwordx4 v8, s[12:15], s26 offen lds
  s_add_u32 m0, s27, 52224
  s_nop 0
  buffer_load_dwordx4 v9, s[12:15], s26 offen lds
  s_add_u32 m0, s27, 53248
  s_nop 0
  buffer_load_dwordx4 v10, s[12:15], s26 offen lds
  s_add_u32 m0, s27, 54272
  s_nop 0
  buffer_load_dwordx4 v11, s[12:15], s26 offen lds
  s_add_u32 m0, s27, 55296
  s_nop 0
  buffer_load_dwordx4 v12, s[12:15], s26 offen lds
  s_add_u32 s26, s26, 2048
  s_sub_u32 s47, s26, 55296
  s_cmp_ge_u32 s26, s46
  s_cselect_b32 s26, s47, s26
  s_waitcnt vmcnt(20)
  s_barrier
  s_add_u32 m0, s27, 61440
  s_nop 0
  buffer_load_dwordx4 v8, s[12:15], s26 offen lds
  s_add_u32 m0, s27, 62464
  s_nop 0
  buffer_load_dwordx4 v9, s[12:15], s26 offen lds
  s_add_u32 m0, s27, 63488
  s_nop 0
  buffer_load_dwordx4 v10, s[12:15], s26 offen lds
  s_add_u32 m0, s27, 64512
  s_nop 0
  buffer_load_dwordx4 v11, s[12:15], s26 offen lds
  s_add_u32 m0, s27, 65536
  s_nop 0
  buffer_load_dwordx4 v12, s[12:15], s26 offen lds
  s_add_u32 s26, s26, 2048
  s_sub_u32 s47, s26, 55296
  s_cmp_ge_u32 s26, s46
  s_cselect_b32 s26, s47, s26
  s_add_u32 m0, s27, 71680
  s_nop 0
  buffer_load_dwordx4 v8, s[12:15], s26 offen lds
  s_add_u32 m0, s27, 72704
  s_nop 0
  buffer_load_dwordx4 v9, s[12:15], s26 offen lds
  s_add_u32 m0, s27, 73728
  s_nop 0
  buffer_load_dwordx4 v10, s[12:15], s26 offen lds
  s_add_u32 m0, s27, 74752
  s_nop 0
  buffer_load_dwordx4 v11, s[12:15], s26 offen lds
  s_add_u32 m0, s27, 75776
  s_nop 0
  buffer_load_dwordx4 v12, s[12:15], s26 offen lds
  s_add_u32 s26, s26, 2048
  s_sub_u32 s47, s26, 55296
  s_cmp_ge_u32 s26, s46
  s_cselect_b32 s26, s47, s26
  s_add_u32 m0, s27, 81920
  s_nop 0
  buffer_load_dwordx4 v8, s[12:15], s26 offen lds
  s_add_u32 m0, s27, 82944
  s_nop 0
  buffer_load_dwordx4 v9, s[12:15], s26 offen lds
  s_add_u32 m0, s27, 83968
  s_nop 0
  buffer_load_dwordx4 v10, s[12:15], s26 offen lds
  s_add_u32 m0, s27, 84992
  s_nop 0
  buffer_load_dwordx4 v11, s[12:15], s26 offen lds
  s_add_u32 m0, s27, 86016
  s_nop 0
  buffer_load_dwordx4 v12, s[12:15], s26 offen lds
  s_add_u32 s26, s26, 2048
  s_sub_u32 s47, s26, 55296
  s_cmp_ge_u32 s26, s46
  s_cselect_b32 s26, s47, s26
  s_waitcnt vmcnt(30)
  s_barrier
  s_add_u32 m0, s27, 92160
  s_nop 0
  buffer_load_dwordx4 v8, s[12:15], s26 offen lds
  s_add_u32 m0, s27, 93184
  s_nop 0
  buffer_load_dwordx4 v9, s[12:15], s26 offen lds
  s_add_u32 m0, s27, 94208
  s_nop 0
  buffer_load_dwordx4 v10, s[12:15], s26 offen lds
  s_add_u32 m0, s27, 95232
  s_nop 0
  buffer_load_dwordx4 v11, s[12:15], s26 offen lds
  s_add_u32 m0, s27, 96256
  s_nop 0
  buffer_load_dwordx4 v12, s[12:15], s26 offen lds
  s_add_u32 s26, s26, 2048
  s_sub_u32 s47, s26, 55296
  s_cmp_ge_u32 s26, s46
  s_cselect_b32 s26, s47, s26
  s_add_u32 m0, s27, 102400
  s_nop 0
  buffer_load_dwordx4 v8, s[12:15], s26 offen lds
  s_add_u32 m0, s27, 103424
  s_nop 0
  buffer_load_dwordx4 v9, s[12:15], s26 offen lds
  s_add_u32 m0, s27, 104448
  s_nop 0
  buffer_load_dwordx4 v10, s[12:15], s26 offen lds
  s_add_u32 m0, s27, 105472
  s_nop 0
  buffer_load_dwordx4 v11, s[12:15], s26 offen lds
  s_add_u32 m0, s27, 106496
  s_nop 0
  buffer_load_dwordx4 v12, s[12:15], s26 offen lds
  s_add_u32 s26, s26, 2048
  s_sub_u32 s47, s26, 55296
  s_cmp_ge_u32 s26, s46
  s_cselect_b32 s26, s47, s26
  s_add_u32 m0, s27, 112640
  s_nop 0
  buffer_load_dwordx4 v8, s[12:15], s26 offen lds
  s_add_u32 m0, s27, 113664
  s_nop 0
  buffer_load_dwordx4 v9, s[12:15], s26 offen lds
  s_add_u32 m0, s27, 114688
  s_nop 0
  buffer_load_dwordx4 v10, s[12:15], s26 offen lds
  s_add_u32 m0, s27, 115712
  s_nop 0
  buffer_load_dwordx4 v11, s[12:15], s26 offen lds
  s_add_u32 m0, s27, 116736
  s_nop 0
  buffer_load_dwordx4 v12, s[12:15], s26 offen lds
  s_add_u32 s26, s26, 2048
  s_sub_u32 s47, s26, 55296
  s_cmp_ge_u32 s26, s46
  s_cselect_b32 s26, s47, s26
  s_waitcnt vmcnt(40)
  s_barrier
  s_add_u32 m0, s27, 0
  s_nop 0
  buffer_load_dwordx4 v8, s[12:15], s26 offen lds
  s_add_u32 m0, s27, 1024
  s_nop 0
  buffer_load_dwordx4 v9, s[12:15], s26 offen lds
  s_add_u32 m0, s27, 2048
  s_nop 0
  buffer_load_dwordx4 v10, s[12:15], s26 offen lds
  s_add_u32 m0, s27, 3072
  s_nop 0
  buffer_load_dwordx4 v11, s[12:15], s26 offen lds
  s_add_u32 m0, s27, 4096
  s_nop 0
  buffer_load_dwordx4 v12, s[12:15], s26 offen lds
  s_add_u32 s26, s26, 2048
  s_sub_u32 s47, s26, 55296
  s_cmp_ge_u32 s26, s46
  s_cselect_b32 s26, s47, s26
  s_add_u32 m0, s27, 10240
  s_nop 0
  buffer_load_dwordx4 v8, s[12:15], s26 offen lds
  s_add_u32 m0, s27, 11264
  s_nop 0
  buffer_load_dwordx4 v9, s[12:15], s26 offen lds
  s_add_u32 m0, s27, 12288
  s_nop 0
  buffer_load_dwordx4 v10, s[12:15], s26 offen lds
  s_add_u32 m0, s27, 13312
  s_nop 0
  buffer_load_dwordx4 v11, s[12:15], s26 offen lds
  s_add_u32 m0, s27, 14336
  s_nop 0
  buffer_load_dwordx4 v12, s[12:15], s26 offen lds
  s_add_u32 s26, s26, 2048
  s_sub_u32 s47, s26, 55296
  s_cmp_ge_u32 s26, s46
  s_cselect_b32 s26, s47, s26
  s_add_u32 m0, s27, 20480
  s_nop 0
  buffer_load_dwordx4 v8, s[12:15], s26 offen lds
  s_add_u32 m0, s27, 21504
  s_nop 0
  buffer_load_dwordx4 v9, s[12:15], s26 offen lds
  s_add_u32 m0, s27, 22528
  s_nop 0
  buffer_load_dwordx4 v10, s[12:15], s26 offen lds
  s_add_u32 m0, s27, 23552
  s_nop 0
  buffer_load_dwordx4 v11, s[12:15], s26 offen lds
  s_add_u32 m0, s27, 24576
  s_nop 0
  buffer_load_dwordx4 v12, s[12:15], s26 offen lds
  s_add_u32 s26, s26, 2048
  s_sub_u32 s47, s26, 55296
  s_cmp_ge_u32 s26, s46
  s_cselect_b32 s26, s47, s26
  s_waitcnt vmcnt(50)
  s_barrier
  s_add_u32 m0, s27, 30720
  s_nop 0
  buffer_load_dwordx4 v8, s[12:15], s26 offen lds
  s_add_u32 m0, s27, 31744
  s_nop 0
  buffer_load_dwordx4 v9, s[12:15], s26 offen lds
  s_add_u32 m0, s27, 32768
  s_nop 0
  buffer_load_dwordx4 v10, s[12:15], s26 offen lds
  s_add_u32 m0, s27, 33792
  s_nop 0
  buffer_load_dwordx4 v11, s[12:15], s26 offen lds
  s_add_u32 m0, s27, 34816
  s_nop 0
  buffer_load_dwordx4 v12, s[12:15], s26 offen lds
  s_add_u32 s26, s26, 2048
  s_sub_u32 s47, s26, 55296
  s_cmp_ge_u32 s26, s46
  s_cselect_b32 s26, s47, s26
  s_waitcnt vmcnt(50)
  s_barrier
  s_add_u32 m0, s27, 40960
  s_nop 0
  buffer_load_dwordx4 v8, s[12:15], s26 offen lds
  s_add_u32 m0, s27, 41984
  s_nop 0
  buffer_load_dwordx4 v9, s[12:15], s26 offen lds
  s_add_u32 m0, s27, 43008
  s_nop 0
  buffer_load_dwordx4 v10, s[12:15], s26 offen lds
  s_add_u32 m0, s27, 44032
  s_nop 0
  buffer_load_dwordx4 v11, s[12:15], s26 offen lds
  s_add_u32 m0, s27, 45056
  s_nop 0
  buffer_load_dwordx4 v12, s[12:15], s26 offen lds
  s_add_u32 s26, s26, 2048
  s_sub_u32 s47, s26, 55296
  s_cmp_ge_u32 s26, s46
  s_cselect_b32 s26, s47, s26
  s_waitcnt vmcnt(50)
  s_barrier
  s_add_u32 m0, s27, 51200
  s_nop 0
  buffer_load_dwordx4 v8, s[12:15], s26 offen lds
  s_add_u32 m0, s27, 52224
  s_nop 0
  buffer_load_dwordx4 v9, s[12:15], s26 offen lds
  s_add_u32 m0, s27, 53248
  s_nop 0
  buffer_load_dwordx4 v10, s[12:15], s26 offen lds
  s_add_u32 m0, s27, 54272
  s_nop 0
  buffer_load_dwordx4 v11, s[12:15], s26 offen lds
  s_add_u32 m0, s27, 55296
  s_nop 0
  buffer_load_dwordx4 v12, s[12:15], s26 offen lds
  s_add_u32 s26, s26, 2048
  s_sub_u32 s47, s26, 55296
  s_cmp_ge_u32 s26, s46
  s_cselect_b32 s26, s47, s26
  s_waitcnt vmcnt(50)
  s_barrier
  s_add_u32 m0, s27, 61440
  s_nop 0
  buffer_load_dwordx4 v8, s[12:15], s26 offen lds
  s_add_u32 m0, s27, 62464
  s_nop 0
  buffer_load_dwordx4 v9, s[12:15], s26 offen lds
  s_add_u32 m0, s27, 63488
  s_nop 0
  buffer_load_dwordx4 v10, s[12:15], s26 offen lds
  s_add_u32 m0, s27, 64512
  s_nop 0
  buffer_load_dwordx4 v11, s[12:15], s26 offen lds
  s_add_u32 m0, s27, 65536
  s_nop 0
  buffer_load_dwordx4 v12, s[12:15], s26 offen lds
  s_add_u32 s26, s26, 2048
  s_sub_u32 s47, s26, 55296
  s_cmp_ge_u32 s26, s46
  s_cselect_b32 s26, s47, s26
  s_waitcnt vmcnt(50)
  s_barrier
  s_add_u32 m0, s27, 71680
  s_nop 0
  buffer_load_dwordx4 v8, s[12:15], s26 offen lds
  s_add_u32 m0, s27, 72704
  s_nop 0
  buffer_load_dwordx4 v9, s[12:15], s26 offen lds
  s_add_u32 m0, s27, 73728
  s_nop 0
  buffer_load_dwordx4 v10, s[12:15], s26 offen lds
  s_add_u32 m0, s27, 74752
  s_nop 0
  buffer_load_dwordx4 v11, s[12:15], s26 offen lds
  s_add_u32 m0, s27, 75776
  s_nop 0
  buffer_load_dwordx4 v12, s[12:15], s26 offen lds
  s_add_u32 s26, s26, 2048
  s_sub_u32 s47, s26, 55296
  s_cmp_ge_u32 s26, s46
  s_cselect_b32 s26, s47, s26
  s_waitcnt vmcnt(50)
  s_barrier
  s_add_u32 m0, s27, 81920
  s_nop 0
  buffer_load_dwordx4 v8, s[12:15], s26 offen lds
  s_add_u32 m0, s27, 82944
  s_nop 0
  buffer_load_dwordx4 v9, s[12:15], s26 offen lds
  s_add_u32 m0, s27, 83968
  s_nop 0
  buffer_load_dwordx4 v10, s[12:15], s26 offen lds
  s_add_u32 m0, s27, 84992
  s_nop 0
  buffer_load_dwordx4 v11, s[12:15], s26 offen lds
  s_add_u32 m0, s27, 86016
  s_nop 0
  buffer_load_dwordx4 v12, s[12:15], s26 offen lds
  s_add_u32 s26, s26, 2048
  s_sub_u32 s47, s26, 55296
  s_cmp_ge_u32 s26, s46
  s_cselect_b32 s26, s47, s26
  s_waitcnt vmcnt(50)
  s_barrier
  s_add_u32 m0, s27, 92160
  s_nop 0
  buffer_load_dwordx4 v8, s[12:15], s26 offen lds
  s_add_u32 m0, s27, 93184
  s_nop 0
  buffer_load_dwordx4 v9, s[12:15], s26 offen lds
  s_add_u32 m0, s27, 94208
  s_nop 0
  buffer_load_dwordx4 v10, s[12:15], s26 offen lds
  s_add_u32 m0, s27, 95232
  s_nop 0
  buffer_load_dwordx4 v11, s[12:15], s26 offen lds
  s_add_u32 m0, s27, 96256
  s_nop 0
  buffer_load_dwordx4 v12, s[12:15], s26 offen lds
  s_add_u32 s26, s26, 2048
  s_sub_u32 s47, s26, 55296
  s_cmp_ge_u32 s26, s46
  s_cselect_b32 s26, s47, s26
  s_waitcnt vmcnt(50)
  s_barrier
  s_add_u32 m0, s27, 102400
  s_nop 0
  buffer_load_dwordx4 v8, s[12:15], s26 offen lds
  s_add_u32 m0, s27, 103424
  s_nop 0
  buffer_load_dwordx4 v9, s[12:15], s26 offen lds
  s_add_u32 m0, s27, 104448
  s_nop 0
  buffer_load_dwordx4 v10, s[12:15], s26 offen lds
  s_add_u32 m0, s27, 105472
  s_nop 0
  buffer_load_dwordx4 v11, s[12:15], s26 offen lds
  s_add_u32 m0, s27, 106496
  s_nop 0
  buffer_load_dwordx4 v12, s[12:15], s26 offen lds
  s_add_u32 s26, s26, 2048
  s_sub_u32 s47, s26, 55296
  s_cmp_ge_u32 s26, s46
  s_cselect_b32 s26, s47, s26
  s_waitcnt vmcnt(50)
  s_barrier
  s_add_u32 m0, s27, 112640
  s_nop 0
  buffer_load_dwordx4 v8, s[12:15], s26 offen lds
  s_add_u32 m0, s27, 113664
  s_nop 0
  buffer_load_dwordx4 v9, s[12:15], s26 offen lds
  s_add_u32 m0, s27, 114688
  s_nop 0
  buffer_load_dwordx4 v10, s[12:15], s26 offen lds
  s_add_u32 m0, s27, 115712
  s_nop 0
  buffer_load_dwordx4 v11, s[12:15], s26 offen lds
  s_add_u32 m0, s27, 116736
  s_nop 0
  buffer_load_dwordx4 v12, s[12:15], s26 offen lds
  s_add_u32 s26, s26, 2048
  s_sub_u32 s47, s26, 55296
  s_cmp_ge_u32 s26, s46
  s_cselect_b32 s26, s47, s26
  s_waitcnt vmcnt(50)
  s_barrier
  s_add_u32 m0, s27, 0
  s_nop 0
  buffer_load_dwordx4 v8, s[12:15], s26 offen lds
  s_add_u32 m0, s27, 1024
  s_nop 0
  buffer_load_dwordx4 v9, s[12:15], s26 offen lds
  s_add_u32 m0, s27, 2048
  s_nop 0
  buffer_load_dwordx4 v10, s[12:15], s26 offen lds
  s_add_u32 m0, s27, 3072
  s_nop 0
  buffer_load_dwordx4 v11, s[12:15], s26 offen lds
  s_add_u32 m0, s27, 4096
  s_nop 0
  buffer_load_dwordx4 v12, s[12:15], s26 offen lds
  s_add_u32 s26, s26, 2048
  s_sub_u32 s47, s26, 55296
  s_cmp_ge_u32 s26, s46
  s_cselect_b32 s26, s47, s26
  s_waitcnt vmcnt(50)
  s_barrier
  s_add_u32 m0, s27, 10240
  s_nop 0
  buffer_load_dwordx4 v8, s[12:15], s26 offen lds
  s_add_u32 m0, s27, 11264
  s_nop 0
  buffer_load_dwordx4 v9, s[12:15], s26 offen lds
  s_add_u32 m0, s27, 12288
  s_nop 0
  buffer_load_dwordx4 v10, s[12:15], s26 offen lds
  s_add_u32 m0, s27, 13312
  s_nop 0
  buffer_load_dwordx4 v11, s[12:15], s26 offen lds
  s_add_u32 m0, s27, 14336
  s_nop 0
  buffer_load_dwordx4 v12, s[12:15], s26 offen lds
  s_add_u32 s26, s26, 2048
  s_sub_u32 s47, s26, 55296
  s_cmp_ge_u32 s26, s46
  s_cselect_b32 s26, s47, s26
  s_waitcnt vmcnt(50)
  s_barrier
  s_add_u32 m0, s27, 20480
  s_nop 0
  buffer_load_dwordx4 v8, s[12:15], s26 offen lds
  s_add_u32 m0, s27, 21504
  s_nop 0
  buffer_load_dwordx4 v9, s[12:15], s26 offen lds
  s_add_u32 m0, s27, 22528
  s_nop 0
  buffer_load_dwordx4 v10, s[12:15], s26 offen lds
  s_add_u32 m0, s27, 23552
  s_nop 0
  buffer_load_dwordx4 v11, s[12:15], s26 offen lds
  s_add_u32 m0, s27, 24576
  s_nop 0
  buffer_load_dwordx4 v12, s[12:15], s26 offen lds
  s_add_u32 s26, s26, 2048
  s_sub_u32 s47, s26, 55296
  s_cmp_ge_u32 s26, s46
  s_cselect_b32 s26, s47, s26
  s_waitcnt vmcnt(50)
  s_barrier
  s_waitcnt vmcnt(45)
  s_barrier
  s_waitcnt vmcnt(40)
  s_barrier
  s_waitcnt vmcnt(35)
  s_barrier
  s_waitcnt vmcnt(30)
  s_barrier
  s_waitcnt vmcnt(25)
  s_barrier
  s_waitcnt vmcnt(20)
  s_barrier
  s_waitcnt vmcnt(15)
  s_barrier
  s_waitcnt vmcnt(10)
  s_barrier
  s_waitcnt vmcnt(5)
  s_barrier
  s_waitcnt vmcnt(0)
  s_barrier
  s_endpgm
  s_endpgm
L_down_kernel_loader_else:
  s_and_b32 s20, s3, 1
  s_lshr_b32 s21, s3, 1
  s_lshl_b32 s22, s19, 2
  s_lshl_b32 s23, s20, 1
  s_add_u32 s22, s22, s23
  s_mul_i32 s22, s22, 54
  s_add_u32 s22, s22, s21
  s_lshl_b32 s22, s22, 10
  s_add_u32 s22, s22, 24616960
  s_add_u32 s46, s22, 55296
  s_lshl_b32 s47, s50, 11
  s_add_u32 s22, s22, s47
  v_add_u32 v4, 55296, v3
  buffer_load_dwordx4 v[132:135], v3, s[12:15], s22 offen
  buffer_load_dwordx4 v[136:139], v4, s[12:15], s22 offen
  s_add_u32 s22, s22, 2048
  s_sub_u32 s47, s22, 55296
  s_cmp_ge_u32 s22, s46
  s_cselect_b32 s22, s47, s22
  buffer_load_dwordx4 v[140:143], v3, s[12:15], s22 offen
  buffer_load_dwordx4 v[144:147], v4, s[12:15], s22 offen
  s_add_u32 s22, s22, 2048
  s_sub_u32 s47, s22, 55296
  s_cmp_ge_u32 s22, s46
  s_cselect_b32 s22, s47, s22
  buffer_load_dwordx4 v[148:151], v3, s[12:15], s22 offen
  buffer_load_dwordx4 v[152:155], v4, s[12:15], s22 offen
  s_add_u32 s22, s22, 2048
  s_sub_u32 s47, s22, 55296
  s_cmp_ge_u32 s22, s46
  s_cselect_b32 s22, s47, s22
  buffer_load_dwordx4 v[156:159], v3, s[12:15], s22 offen
  buffer_load_dwordx4 v[160:163], v4, s[12:15], s22 offen
  s_add_u32 s22, s22, 2048
  s_sub_u32 s47, s22, 55296
  s_cmp_ge_u32 s22, s46
  s_cselect_b32 s22, s47, s22
  buffer_load_dwordx4 v[164:167], v3, s[12:15], s22 offen
  buffer_load_dwordx4 v[168:171], v4, s[12:15], s22 offen
  s_add_u32 s22, s22, 2048
  s_sub_u32 s47, s22, 55296
  s_cmp_ge_u32 s22, s46
  s_cselect_b32 s22, s47, s22
  buffer_load_dwordx4 v[172:175], v3, s[12:15], s22 offen
  buffer_load_dwordx4 v[176:179], v4, s[12:15], s22 offen
  s_add_u32 s22, s22, 2048
  s_sub_u32 s47, s22, 55296
  s_cmp_ge_u32 s22, s46
  s_cselect_b32 s22, s47, s22
  buffer_load_dwordx4 v[180:183], v3, s[12:15], s22 offen
  buffer_load_dwordx4 v[184:187], v4, s[12:15], s22 offen
  s_add_u32 s22, s22, 2048
  s_sub_u32 s47, s22, 55296
  s_cmp_ge_u32 s22, s46
  s_cselect_b32 s22, s47, s22
  buffer_load_dwordx4 v[188:191], v3, s[12:15], s22 offen
  buffer_load_dwordx4 v[192:195], v4, s[12:15], s22 offen
  s_add_u32 s22, s22, 2048
  s_sub_u32 s47, s22, 55296
  s_cmp_ge_u32 s22, s46
  s_cselect_b32 s22, s47, s22
  v_and_b32 v5, 15, v2
  v_lshrrev_b32 v6, 4, v2
  s_lshl_b32 s24, s20, 1
  s_add_u32 s24, s24, s21
  s_lshl_b32 s30, s19, 6
  s_lshl_b32 s31, s24, 4
  s_add_u32 s30, s30, s31
  v_add_u32 v7, s30, v5
  v_mul_u32_u24 v36, 1280, v7
  s_mul_i32 s31, s18, 160
  v_lshl_add_u32 v36, v6, 3, v36
  v_add_u32 v36, s31, v36
  s_lshl_b32 s32, s19, 2
  s_add_u32 s32, s32, s24
  s_mul_i32 s32, s32, 20480
  s_add_u32 s32, s32, 21864448
  s_mul_i32 s33, s18, 5
  s_add_u32 s34, s33, 0
  s_lshr_b32 s35, s34, 1
  s_lshl_b32 s35, s35, 10
  s_and_b32 s34, s34, 1
  s_lshl_b32 s34, s34, 3
  s_add_u32 s35, s35, s34
  s_add_u32 s40, s35, s32
  buffer_load_dwordx2 v[40:41], v3, s[12:15], s40 offen
  s_add_u32 s34, s33, 1
  s_lshr_b32 s35, s34, 1
  s_lshl_b32 s35, s35, 10
  s_and_b32 s34, s34, 1
  s_lshl_b32 s34, s34, 3
  s_add_u32 s35, s35, s34
  s_add_u32 s41, s35, s32
  buffer_load_dwordx2 v[42:43], v3, s[12:15], s41 offen
  s_add_u32 s34, s33, 2
  s_lshr_b32 s35, s34, 1
  s_lshl_b32 s35, s35, 10
  s_and_b32 s34, s34, 1
  s_lshl_b32 s34, s34, 3
  s_add_u32 s35, s35, s34
  s_add_u32 s42, s35, s32
  buffer_load_dwordx2 v[44:45], v3, s[12:15], s42 offen
  s_add_u32 s34, s33, 3
  s_lshr_b32 s35, s34, 1
  s_lshl_b32 s35, s35, 10
  s_and_b32 s34, s34, 1
  s_lshl_b32 s34, s34, 3
  s_add_u32 s35, s35, s34
  s_add_u32 s43, s35, s32
  buffer_load_dwordx2 v[46:47], v3, s[12:15], s43 offen
  s_add_u32 s34, s33, 4
  s_lshr_b32 s35, s34, 1
  s_lshl_b32 s35, s35, 10
  s_and_b32 s34, s34, 1
  s_lshl_b32 s34, s34, 3
  s_add_u32 s35, s35, s34
  s_add_u32 s44, s35, s32
  buffer_load_dwordx2 v[48:49], v3, s[12:15], s44 offen
  v_mov_b32 v52, 0
  v_mov_b32 v53, 0
  v_mov_b32 v54, 0
  v_mov_b32 v55, 0
  v_mov_b32 v56, 0
  v_mov_b32 v57, 0
  v_mov_b32 v58, 0
  v_mov_b32 v59, 0
  v_mov_b32 v60, 0
  v_mov_b32 v61, 0
  v_mov_b32 v62, 0
  v_mov_b32 v63, 0
  v_mov_b32 v64, 0
  v_mov_b32 v65, 0
  v_mov_b32 v66, 0
  v_mov_b32 v67, 0
  v_mov_b32 v68, 0
  v_mov_b32 v69, 0
  v_mov_b32 v70, 0
  v_mov_b32 v71, 0
  v_mov_b32 v72, 0
  v_mov_b32 v73, 0
  v_mov_b32 v74, 0
  v_mov_b32 v75, 0
  v_mov_b32 v76, 0
  v_mov_b32 v77, 0
  v_mov_b32 v78, 0
  v_mov_b32 v79, 0
  v_mov_b32 v80, 0
  v_mov_b32 v81, 0
  v_mov_b32 v82, 0
  v_mov_b32 v83, 0
  v_mov_b32 v84, 0
  v_mov_b32 v85, 0
  v_mov_b32 v86, 0
  v_mov_b32 v87, 0
  v_mov_b32 v88, 0
  v_mov_b32 v89, 0
  v_mov_b32 v90, 0
  v_mov_b32 v91, 0
  s_mul_i32 s25, s21, 5120
  v_add_u32 v8, s25, v3
  v_add_u32 v9, 61440, v8
  v_add_u32 v12, 122880, v8
  s_barrier
  ds_read_b128 v[92:95], v8 offset:0
  ds_read_b128 v[96:99], v8 offset:1024
  ds_read_b128 v[100:103], v8 offset:2048
  ds_read_b128 v[104:107], v8 offset:3072
  ds_read_b128 v[108:111], v8 offset:4096
  s_waitcnt lgkmcnt(0)
  s_barrier
  ds_read_b128 v[112:115], v8 offset:10240
  ds_read_b128 v[116:119], v8 offset:11264
  ds_read_b128 v[120:123], v8 offset:12288
  ds_read_b128 v[124:127], v8 offset:13312
  ds_read_b128 v[128:131], v8 offset:14336
  s_waitcnt vmcnt(19)
  v_mfma_f32_16x16x32_bf16 v[52:55], v[92:95], v[132:135], v[52:55]
  v_mfma_f32_16x16x32_bf16 v[56:59], v[96:99], v[132:135], v[56:59]
  v_mfma_f32_16x16x32_bf16 v[60:63], v[100:103], v[132:135], v[60:63]
  v_mfma_f32_16x16x32_bf16 v[64:67], v[104:107], v[132:135], v[64:67]
  v_mfma_f32_16x16x32_bf16 v[68:71], v[108:111], v[132:135], v[68:71]
  v_mfma_f32_16x16x32_bf16 v[72:75], v[92:95], v[136:139], v[72:75]
  v_mfma_f32_16x16x32_bf16 v[76:79], v[96:99], v[136:139], v[76:79]
  v_mfma_f32_16x16x32_bf16 v[80:83], v[100:103], v[136:139], v[80:83]
  v_mfma_f32_16x16x32_bf16 v[84:87], v[104:107], v[136:139], v[84:87]
  v_mfma_f32_16x16x32_bf16 v[88:91], v[108:111], v[136:139], v[88:91]
  buffer_load_dwordx4 v[132:135], v3, s[12:15], s22 offen
  buffer_load_dwordx4 v[136:139], v4, s[12:15], s22 offen
  s_add_u32 s22, s22, 2048
  s_sub_u32 s47, s22, 55296
  s_cmp_ge_u32 s22, s46
  s_cselect_b32 s22, s47, s22
  s_waitcnt lgkmcnt(0)
  s_barrier
  ds_read_b128 v[92:95], v8 offset:20480
  ds_read_b128 v[96:99], v8 offset:21504
  ds_read_b128 v[100:103], v8 offset:22528
  ds_read_b128 v[104:107], v8 offset:23552
  ds_read_b128 v[108:111], v8 offset:24576
  s_waitcnt vmcnt(19)
  v_mfma_f32_16x16x32_bf16 v[52:55], v[112:115], v[140:143], v[52:55]
  v_mfma_f32_16x16x32_bf16 v[56:59], v[116:119], v[140:143], v[56:59]
  v_mfma_f32_16x16x32_bf16 v[60:63], v[120:123], v[140:143], v[60:63]
  v_mfma_f32_16x16x32_bf16 v[64:67], v[124:127], v[140:143], v[64:67]
  v_mfma_f32_16x16x32_bf16 v[68:71], v[128:131], v[140:143], v[68:71]
  v_mfma_f32_16x16x32_bf16 v[72:75], v[112:115], v[144:147], v[72:75]
  v_mfma_f32_16x16x32_bf16 v[76:79], v[116:119], v[144:147], v[76:79]
  v_mfma_f32_16x16x32_bf16 v[80:83], v[120:123], v[144:147], v[80:83]
  v_mfma_f32_16x16x32_bf16 v[84:87], v[124:127], v[144:147], v[84:87]
  v_mfma_f32_16x16x32_bf16 v[88:91], v[128:131], v[144:147], v[88:91]
  buffer_load_dwordx4 v[140:143], v3, s[12:15], s22 offen
  buffer_load_dwordx4 v[144:147], v4, s[12:15], s22 offen
  s_add_u32 s22, s22, 2048
  s_sub_u32 s47, s22, 55296
  s_cmp_ge_u32 s22, s46
  s_cselect_b32 s22, s47, s22
  s_waitcnt lgkmcnt(0)
  s_barrier
  ds_read_b128 v[112:115], v8 offset:30720
  ds_read_b128 v[116:119], v8 offset:31744
  ds_read_b128 v[120:123], v8 offset:32768
  ds_read_b128 v[124:127], v8 offset:33792
  ds_read_b128 v[128:131], v8 offset:34816
  s_waitcnt vmcnt(19)
  v_mfma_f32_16x16x32_bf16 v[52:55], v[92:95], v[148:151], v[52:55]
  v_mfma_f32_16x16x32_bf16 v[56:59], v[96:99], v[148:151], v[56:59]
  v_mfma_f32_16x16x32_bf16 v[60:63], v[100:103], v[148:151], v[60:63]
  v_mfma_f32_16x16x32_bf16 v[64:67], v[104:107], v[148:151], v[64:67]
  v_mfma_f32_16x16x32_bf16 v[68:71], v[108:111], v[148:151], v[68:71]
  v_mfma_f32_16x16x32_bf16 v[72:75], v[92:95], v[152:155], v[72:75]
  v_mfma_f32_16x16x32_bf16 v[76:79], v[96:99], v[152:155], v[76:79]
  v_mfma_f32_16x16x32_bf16 v[80:83], v[100:103], v[152:155], v[80:83]
  v_mfma_f32_16x16x32_bf16 v[84:87], v[104:107], v[152:155], v[84:87]
  v_mfma_f32_16x16x32_bf16 v[88:91], v[108:111], v[152:155], v[88:91]
  buffer_load_dwordx4 v[148:151], v3, s[12:15], s22 offen
  buffer_load_dwordx4 v[152:155], v4, s[12:15], s22 offen
  s_add_u32 s22, s22, 2048
  s_sub_u32 s47, s22, 55296
  s_cmp_ge_u32 s22, s46
  s_cselect_b32 s22, s47, s22
  s_waitcnt lgkmcnt(0)
  s_barrier
  ds_read_b128 v[92:95], v8 offset:40960
  ds_read_b128 v[96:99], v8 offset:41984
  ds_read_b128 v[100:103], v8 offset:43008
  ds_read_b128 v[104:107], v8 offset:44032
  ds_read_b128 v[108:111], v8 offset:45056
  s_waitcnt vmcnt(19)
  v_mfma_f32_16x16x32_bf16 v[52:55], v[112:115], v[156:159], v[52:55]
  v_mfma_f32_16x16x32_bf16 v[56:59], v[116:119], v[156:159], v[56:59]
  v_mfma_f32_16x16x32_bf16 v[60:63], v[120:123], v[156:159], v[60:63]
  v_mfma_f32_16x16x32_bf16 v[64:67], v[124:127], v[156:159], v[64:67]
  v_mfma_f32_16x16x32_bf16 v[68:71], v[128:131], v[156:159], v[68:71]
  v_mfma_f32_16x16x32_bf16 v[72:75], v[112:115], v[160:163], v[72:75]
  v_mfma_f32_16x16x32_bf16 v[76:79], v[116:119], v[160:163], v[76:79]
  v_mfma_f32_16x16x32_bf16 v[80:83], v[120:123], v[160:163], v[80:83]
  v_mfma_f32_16x16x32_bf16 v[84:87], v[124:127], v[160:163], v[84:87]
  v_mfma_f32_16x16x32_bf16 v[88:91], v[128:131], v[160:163], v[88:91]
  buffer_load_dwordx4 v[156:159], v3, s[12:15], s22 offen
  buffer_load_dwordx4 v[160:163], v4, s[12:15], s22 offen
  s_add_u32 s22, s22, 2048
  s_sub_u32 s47, s22, 55296
  s_cmp_ge_u32 s22, s46
  s_cselect_b32 s22, s47, s22
  s_waitcnt lgkmcnt(0)
  s_barrier
  ds_read_b128 v[112:115], v8 offset:51200
  ds_read_b128 v[116:119], v8 offset:52224
  ds_read_b128 v[120:123], v8 offset:53248
  ds_read_b128 v[124:127], v8 offset:54272
  ds_read_b128 v[128:131], v8 offset:55296
  s_waitcnt vmcnt(19)
  v_mfma_f32_16x16x32_bf16 v[52:55], v[92:95], v[164:167], v[52:55]
  v_mfma_f32_16x16x32_bf16 v[56:59], v[96:99], v[164:167], v[56:59]
  v_mfma_f32_16x16x32_bf16 v[60:63], v[100:103], v[164:167], v[60:63]
  v_mfma_f32_16x16x32_bf16 v[64:67], v[104:107], v[164:167], v[64:67]
  v_mfma_f32_16x16x32_bf16 v[68:71], v[108:111], v[164:167], v[68:71]
  v_mfma_f32_16x16x32_bf16 v[72:75], v[92:95], v[168:171], v[72:75]
  v_mfma_f32_16x16x32_bf16 v[76:79], v[96:99], v[168:171], v[76:79]
  v_mfma_f32_16x16x32_bf16 v[80:83], v[100:103], v[168:171], v[80:83]
  v_mfma_f32_16x16x32_bf16 v[84:87], v[104:107], v[168:171], v[84:87]
  v_mfma_f32_16x16x32_bf16 v[88:91], v[108:111], v[168:171], v[88:91]
  buffer_load_dwordx4 v[164:167], v3, s[12:15], s22 offen
  buffer_load_dwordx4 v[168:171], v4, s[12:15], s22 offen
  s_add_u32 s22, s22, 2048
  s_sub_u32 s47, s22, 55296
  s_cmp_ge_u32 s22, s46
  s_cselect_b32 s22, s47, s22
  s_waitcnt lgkmcnt(0)
  s_barrier
  ds_read_b128 v[92:95], v9 offset:0
  ds_read_b128 v[96:99], v9 offset:1024
  ds_read_b128 v[100:103], v9 offset:2048
  ds_read_b128 v[104:107], v9 offset:3072
  ds_read_b128 v[108:111], v9 offset:4096
  s_waitcnt vmcnt(19)
  v_mfma_f32_16x16x32_bf16 v[52:55], v[112:115], v[172:175], v[52:55]
  v_mfma_f32_16x16x32_bf16 v[56:59], v[116:119], v[172:175], v[56:59]
  v_mfma_f32_16x16x32_bf16 v[60:63], v[120:123], v[172:175], v[60:63]
  v_mfma_f32_16x16x32_bf16 v[64:67], v[124:127], v[172:175], v[64:67]
  v_mfma_f32_16x16x32_bf16 v[68:71], v[128:131], v[172:175], v[68:71]
  v_mfma_f32_16x16x32_bf16 v[72:75], v[112:115], v[176:179], v[72:75]
  v_mfma_f32_16x16x32_bf16 v[76:79], v[116:119], v[176:179], v[76:79]
  v_mfma_f32_16x16x32_bf16 v[80:83], v[120:123], v[176:179], v[80:83]
  v_mfma_f32_16x16x32_bf16 v[84:87], v[124:127], v[176:179], v[84:87]
  v_mfma_f32_16x16x32_bf16 v[88:91], v[128:131], v[176:179], v[88:91]
  buffer_load_dwordx4 v[172:175], v3, s[12:15], s22 offen
  buffer_load_dwordx4 v[176:179], v4, s[12:15], s22 offen
  s_add_u32 s22, s22, 2048
  s_sub_u32 s47, s22, 55296
  s_cmp_ge_u32 s22, s46
  s_cselect_b32 s22, s47, s22
  s_waitcnt lgkmcnt(0)
  s_barrier
  ds_read_b128 v[112:115], v9 offset:10240
  ds_read_b128 v[116:119], v9 offset:11264
  ds_read_b128 v[120:123], v9 offset:12288
  ds_read_b128 v[124:127], v9 offset:13312
  ds_read_b128 v[128:131], v9 offset:14336
  s_waitcnt vmcnt(19)
  v_mfma_f32_16x16x32_bf16 v[52:55], v[92:95], v[180:183], v[52:55]
  v_mfma_f32_16x16x32_bf16 v[56:59], v[96:99], v[180:183], v[56:59]
  v_mfma_f32_16x16x32_bf16 v[60:63], v[100:103], v[180:183], v[60:63]
  v_mfma_f32_16x16x32_bf16 v[64:67], v[104:107], v[180:183], v[64:67]
  v_mfma_f32_16x16x32_bf16 v[68:71], v[108:111], v[180:183], v[68:71]
  v_mfma_f32_16x16x32_bf16 v[72:75], v[92:95], v[184:187], v[72:75]
  v_mfma_f32_16x16x32_bf16 v[76:79], v[96:99], v[184:187], v[76:79]
  v_mfma_f32_16x16x32_bf16 v[80:83], v[100:103], v[184:187], v[80:83]
  v_mfma_f32_16x16x32_bf16 v[84:87], v[104:107], v[184:187], v[84:87]
  v_mfma_f32_16x16x32_bf16 v[88:91], v[108:111], v[184:187], v[88:91]
  buffer_load_dwordx4 v[180:183], v3, s[12:15], s22 offen
  buffer_load_dwordx4 v[184:187], v4, s[12:15], s22 offen
  s_add_u32 s22, s22, 2048
  s_sub_u32 s47, s22, 55296
  s_cmp_ge_u32 s22, s46
  s_cselect_b32 s22, s47, s22
  s_waitcnt lgkmcnt(0)
  s_barrier
  ds_read_b128 v[92:95], v9 offset:20480
  ds_read_b128 v[96:99], v9 offset:21504
  ds_read_b128 v[100:103], v9 offset:22528
  ds_read_b128 v[104:107], v9 offset:23552
  ds_read_b128 v[108:111], v9 offset:24576
  s_waitcnt vmcnt(19)
  v_mfma_f32_16x16x32_bf16 v[52:55], v[112:115], v[188:191], v[52:55]
  v_mfma_f32_16x16x32_bf16 v[56:59], v[116:119], v[188:191], v[56:59]
  v_mfma_f32_16x16x32_bf16 v[60:63], v[120:123], v[188:191], v[60:63]
  v_mfma_f32_16x16x32_bf16 v[64:67], v[124:127], v[188:191], v[64:67]
  v_mfma_f32_16x16x32_bf16 v[68:71], v[128:131], v[188:191], v[68:71]
  v_mfma_f32_16x16x32_bf16 v[72:75], v[112:115], v[192:195], v[72:75]
  v_mfma_f32_16x16x32_bf16 v[76:79], v[116:119], v[192:195], v[76:79]
  v_mfma_f32_16x16x32_bf16 v[80:83], v[120:123], v[192:195], v[80:83]
  v_mfma_f32_16x16x32_bf16 v[84:87], v[124:127], v[192:195], v[84:87]
  v_mfma_f32_16x16x32_bf16 v[88:91], v[128:131], v[192:195], v[88:91]
  buffer_load_dwordx4 v[188:191], v3, s[12:15], s22 offen
  buffer_load_dwordx4 v[192:195], v4, s[12:15], s22 offen
  s_add_u32 s22, s22, 2048
  s_sub_u32 s47, s22, 55296
  s_cmp_ge_u32 s22, s46
  s_cselect_b32 s22, s47, s22
  s_waitcnt lgkmcnt(0)
  s_barrier
  ds_read_b128 v[112:115], v9 offset:30720
  ds_read_b128 v[116:119], v9 offset:31744
  ds_read_b128 v[120:123], v9 offset:32768
  ds_read_b128 v[124:127], v9 offset:33792
  ds_read_b128 v[128:131], v9 offset:34816
  s_waitcnt vmcnt(14)
  v_mfma_f32_16x16x32_bf16 v[52:55], v[92:95], v[132:135], v[52:55]
  v_mfma_f32_16x16x32_bf16 v[56:59], v[96:99], v[132:135], v[56:59]
  v_mfma_f32_16x16x32_bf16 v[60:63], v[100:103], v[132:135], v[60:63]
  v_mfma_f32_16x16x32_bf16 v[64:67], v[104:107], v[132:135], v[64:67]
  v_mfma_f32_16x16x32_bf16 v[68:71], v[108:111], v[132:135], v[68:71]
  v_mfma_f32_16x16x32_bf16 v[72:75], v[92:95], v[136:139], v[72:75]
  v_mfma_f32_16x16x32_bf16 v[76:79], v[96:99], v[136:139], v[76:79]
  v_mfma_f32_16x16x32_bf16 v[80:83], v[100:103], v[136:139], v[80:83]
  v_mfma_f32_16x16x32_bf16 v[84:87], v[104:107], v[136:139], v[84:87]
  v_mfma_f32_16x16x32_bf16 v[88:91], v[108:111], v[136:139], v[88:91]
  buffer_load_dwordx4 v[132:135], v3, s[12:15], s22 offen
  buffer_load_dwordx4 v[136:139], v4, s[12:15], s22 offen
  s_add_u32 s22, s22, 2048
  s_sub_u32 s47, s22, 55296
  s_cmp_ge_u32 s22, s46
  s_cselect_b32 s22, s47, s22
  s_waitcnt lgkmcnt(0)
  s_barrier
  ds_read_b128 v[92:95], v9 offset:40960
  ds_read_b128 v[96:99], v9 offset:41984
  ds_read_b128 v[100:103], v9 offset:43008
  ds_read_b128 v[104:107], v9 offset:44032
  ds_read_b128 v[108:111], v9 offset:45056
  s_waitcnt vmcnt(14)
  v_mfma_f32_16x16x32_bf16 v[52:55], v[112:115], v[140:143], v[52:55]
  v_mfma_f32_16x16x32_bf16 v[56:59], v[116:119], v[140:143], v[56:59]
  v_mfma_f32_16x16x32_bf16 v[60:63], v[120:123], v[140:143], v[60:63]
  v_mfma_f32_16x16x32_bf16 v[64:67], v[124:127], v[140:143], v[64:67]
  v_mfma_f32_16x16x32_bf16 v[68:71], v[128:131], v[140:143], v[68:71]
  v_mfma_f32_16x16x32_bf16 v[72:75], v[112:115], v[144:147], v[72:75]
  v_mfma_f32_16x16x32_bf16 v[76:79], v[116:119], v[144:147], v[76:79]
  v_mfma_f32_16x16x32_bf16 v[80:83], v[120:123], v[144:147], v[80:83]
  v_mfma_f32_16x16x32_bf16 v[84:87], v[124:127], v[144:147], v[84:87]
  v_mfma_f32_16x16x32_bf16 v[88:91], v[128:131], v[144:147], v[88:91]
  buffer_load_dwordx4 v[140:143], v3, s[12:15], s22 offen
  buffer_load_dwordx4 v[144:147], v4, s[12:15], s22 offen
  s_add_u32 s22, s22, 2048
  s_sub_u32 s47, s22, 55296
  s_cmp_ge_u32 s22, s46
  s_cselect_b32 s22, s47, s22
  s_waitcnt lgkmcnt(0)
  s_barrier
  ds_read_b128 v[112:115], v9 offset:51200
  ds_read_b128 v[116:119], v9 offset:52224
  ds_read_b128 v[120:123], v9 offset:53248
  ds_read_b128 v[124:127], v9 offset:54272
  ds_read_b128 v[128:131], v9 offset:55296
  s_waitcnt vmcnt(14)
  v_mfma_f32_16x16x32_bf16 v[52:55], v[92:95], v[148:151], v[52:55]
  v_mfma_f32_16x16x32_bf16 v[56:59], v[96:99], v[148:151], v[56:59]
  v_mfma_f32_16x16x32_bf16 v[60:63], v[100:103], v[148:151], v[60:63]
  v_mfma_f32_16x16x32_bf16 v[64:67], v[104:107], v[148:151], v[64:67]
  v_mfma_f32_16x16x32_bf16 v[68:71], v[108:111], v[148:151], v[68:71]
  v_mfma_f32_16x16x32_bf16 v[72:75], v[92:95], v[152:155], v[72:75]
  v_mfma_f32_16x16x32_bf16 v[76:79], v[96:99], v[152:155], v[76:79]
  v_mfma_f32_16x16x32_bf16 v[80:83], v[100:103], v[152:155], v[80:83]
  v_mfma_f32_16x16x32_bf16 v[84:87], v[104:107], v[152:155], v[84:87]
  v_mfma_f32_16x16x32_bf16 v[88:91], v[108:111], v[152:155], v[88:91]
  buffer_load_dwordx4 v[148:151], v3, s[12:15], s22 offen
  buffer_load_dwordx4 v[152:155], v4, s[12:15], s22 offen
  s_add_u32 s22, s22, 2048
  s_sub_u32 s47, s22, 55296
  s_cmp_ge_u32 s22, s46
  s_cselect_b32 s22, s47, s22
  s_waitcnt lgkmcnt(0)
  s_barrier
  ds_read_b128 v[92:95], v8 offset:0
  ds_read_b128 v[96:99], v8 offset:1024
  ds_read_b128 v[100:103], v8 offset:2048
  ds_read_b128 v[104:107], v8 offset:3072
  ds_read_b128 v[108:111], v8 offset:4096
  s_waitcnt vmcnt(14)
  v_mfma_f32_16x16x32_bf16 v[52:55], v[112:115], v[156:159], v[52:55]
  v_mfma_f32_16x16x32_bf16 v[56:59], v[116:119], v[156:159], v[56:59]
  v_mfma_f32_16x16x32_bf16 v[60:63], v[120:123], v[156:159], v[60:63]
  v_mfma_f32_16x16x32_bf16 v[64:67], v[124:127], v[156:159], v[64:67]
  v_mfma_f32_16x16x32_bf16 v[68:71], v[128:131], v[156:159], v[68:71]
  v_mfma_f32_16x16x32_bf16 v[72:75], v[112:115], v[160:163], v[72:75]
  v_mfma_f32_16x16x32_bf16 v[76:79], v[116:119], v[160:163], v[76:79]
  v_mfma_f32_16x16x32_bf16 v[80:83], v[120:123], v[160:163], v[80:83]
  v_mfma_f32_16x16x32_bf16 v[84:87], v[124:127], v[160:163], v[84:87]
  v_mfma_f32_16x16x32_bf16 v[88:91], v[128:131], v[160:163], v[88:91]
  buffer_load_dwordx4 v[156:159], v3, s[12:15], s22 offen
  buffer_load_dwordx4 v[160:163], v4, s[12:15], s22 offen
  s_add_u32 s22, s22, 2048
  s_sub_u32 s47, s22, 55296
  s_cmp_ge_u32 s22, s46
  s_cselect_b32 s22, s47, s22
  s_waitcnt lgkmcnt(0)
  s_barrier
  ds_read_b128 v[112:115], v8 offset:10240
  ds_read_b128 v[116:119], v8 offset:11264
  ds_read_b128 v[120:123], v8 offset:12288
  ds_read_b128 v[124:127], v8 offset:13312
  ds_read_b128 v[128:131], v8 offset:14336
  s_waitcnt vmcnt(14)
  v_mfma_f32_16x16x32_bf16 v[52:55], v[92:95], v[164:167], v[52:55]
  v_mfma_f32_16x16x32_bf16 v[56:59], v[96:99], v[164:167], v[56:59]
  v_mfma_f32_16x16x32_bf16 v[60:63], v[100:103], v[164:167], v[60:63]
  v_mfma_f32_16x16x32_bf16 v[64:67], v[104:107], v[164:167], v[64:67]
  v_mfma_f32_16x16x32_bf16 v[68:71], v[108:111], v[164:167], v[68:71]
  v_mfma_f32_16x16x32_bf16 v[72:75], v[92:95], v[168:171], v[72:75]
  v_mfma_f32_16x16x32_bf16 v[76:79], v[96:99], v[168:171], v[76:79]
  v_mfma_f32_16x16x32_bf16 v[80:83], v[100:103], v[168:171], v[80:83]
  v_mfma_f32_16x16x32_bf16 v[84:87], v[104:107], v[168:171], v[84:87]
  v_mfma_f32_16x16x32_bf16 v[88:91], v[108:111], v[168:171], v[88:91]
  buffer_load_dwordx4 v[164:167], v3, s[12:15], s22 offen
  buffer_load_dwordx4 v[168:171], v4, s[12:15], s22 offen
  s_add_u32 s22, s22, 2048
  s_sub_u32 s47, s22, 55296
  s_cmp_ge_u32 s22, s46
  s_cselect_b32 s22, s47, s22
  s_waitcnt lgkmcnt(0)
  s_barrier
  ds_read_b128 v[92:95], v8 offset:20480
  ds_read_b128 v[96:99], v8 offset:21504
  ds_read_b128 v[100:103], v8 offset:22528
  ds_read_b128 v[104:107], v8 offset:23552
  ds_read_b128 v[108:111], v8 offset:24576
  s_waitcnt vmcnt(14)
  v_mfma_f32_16x16x32_bf16 v[52:55], v[112:115], v[172:175], v[52:55]
  v_mfma_f32_16x16x32_bf16 v[56:59], v[116:119], v[172:175], v[56:59]
  v_mfma_f32_16x16x32_bf16 v[60:63], v[120:123], v[172:175], v[60:63]
  v_mfma_f32_16x16x32_bf16 v[64:67], v[124:127], v[172:175], v[64:67]
  v_mfma_f32_16x16x32_bf16 v[68:71], v[128:131], v[172:175], v[68:71]
  v_mfma_f32_16x16x32_bf16 v[72:75], v[112:115], v[176:179], v[72:75]
  v_mfma_f32_16x16x32_bf16 v[76:79], v[116:119], v[176:179], v[76:79]
  v_mfma_f32_16x16x32_bf16 v[80:83], v[120:123], v[176:179], v[80:83]
  v_mfma_f32_16x16x32_bf16 v[84:87], v[124:127], v[176:179], v[84:87]
  v_mfma_f32_16x16x32_bf16 v[88:91], v[128:131], v[176:179], v[88:91]
  buffer_load_dwordx4 v[172:175], v3, s[12:15], s22 offen
  buffer_load_dwordx4 v[176:179], v4, s[12:15], s22 offen
  s_add_u32 s22, s22, 2048
  s_sub_u32 s47, s22, 55296
  s_cmp_ge_u32 s22, s46
  s_cselect_b32 s22, s47, s22
  s_waitcnt lgkmcnt(0)
  s_barrier
  ds_read_b128 v[112:115], v8 offset:30720
  ds_read_b128 v[116:119], v8 offset:31744
  ds_read_b128 v[120:123], v8 offset:32768
  ds_read_b128 v[124:127], v8 offset:33792
  ds_read_b128 v[128:131], v8 offset:34816
  s_waitcnt vmcnt(14)
  v_mfma_f32_16x16x32_bf16 v[52:55], v[92:95], v[180:183], v[52:55]
  v_mfma_f32_16x16x32_bf16 v[56:59], v[96:99], v[180:183], v[56:59]
  v_mfma_f32_16x16x32_bf16 v[60:63], v[100:103], v[180:183], v[60:63]
  v_mfma_f32_16x16x32_bf16 v[64:67], v[104:107], v[180:183], v[64:67]
  v_mfma_f32_16x16x32_bf16 v[68:71], v[108:111], v[180:183], v[68:71]
  v_mfma_f32_16x16x32_bf16 v[72:75], v[92:95], v[184:187], v[72:75]
  v_mfma_f32_16x16x32_bf16 v[76:79], v[96:99], v[184:187], v[76:79]
  v_mfma_f32_16x16x32_bf16 v[80:83], v[100:103], v[184:187], v[80:83]
  v_mfma_f32_16x16x32_bf16 v[84:87], v[104:107], v[184:187], v[84:87]
  v_mfma_f32_16x16x32_bf16 v[88:91], v[108:111], v[184:187], v[88:91]
  buffer_load_dwordx4 v[180:183], v3, s[12:15], s22 offen
  buffer_load_dwordx4 v[184:187], v4, s[12:15], s22 offen
  s_add_u32 s22, s22, 2048
  s_sub_u32 s47, s22, 55296
  s_cmp_ge_u32 s22, s46
  s_cselect_b32 s22, s47, s22
  s_waitcnt lgkmcnt(0)
  s_barrier
  ds_read_b128 v[92:95], v8 offset:40960
  ds_read_b128 v[96:99], v8 offset:41984
  ds_read_b128 v[100:103], v8 offset:43008
  ds_read_b128 v[104:107], v8 offset:44032
  ds_read_b128 v[108:111], v8 offset:45056
  s_waitcnt vmcnt(14)
  v_mfma_f32_16x16x32_bf16 v[52:55], v[112:115], v[188:191], v[52:55]
  v_mfma_f32_16x16x32_bf16 v[56:59], v[116:119], v[188:191], v[56:59]
  v_mfma_f32_16x16x32_bf16 v[60:63], v[120:123], v[188:191], v[60:63]
  v_mfma_f32_16x16x32_bf16 v[64:67], v[124:127], v[188:191], v[64:67]
  v_mfma_f32_16x16x32_bf16 v[68:71], v[128:131], v[188:191], v[68:71]
  v_mfma_f32_16x16x32_bf16 v[72:75], v[112:115], v[192:195], v[72:75]
  v_mfma_f32_16x16x32_bf16 v[76:79], v[116:119], v[192:195], v[76:79]
  v_mfma_f32_16x16x32_bf16 v[80:83], v[120:123], v[192:195], v[80:83]
  v_mfma_f32_16x16x32_bf16 v[84:87], v[124:127], v[192:195], v[84:87]
  v_mfma_f32_16x16x32_bf16 v[88:91], v[128:131], v[192:195], v[88:91]
  buffer_load_dwordx4 v[188:191], v3, s[12:15], s22 offen
  buffer_load_dwordx4 v[192:195], v4, s[12:15], s22 offen
  s_add_u32 s22, s22, 2048
  s_sub_u32 s47, s22, 55296
  s_cmp_ge_u32 s22, s46
  s_cselect_b32 s22, s47, s22
  s_waitcnt lgkmcnt(0)
  s_barrier
  ds_read_b128 v[112:115], v8 offset:51200
  ds_read_b128 v[116:119], v8 offset:52224
  ds_read_b128 v[120:123], v8 offset:53248
  ds_read_b128 v[124:127], v8 offset:54272
  ds_read_b128 v[128:131], v8 offset:55296
  s_waitcnt vmcnt(14)
  v_mfma_f32_16x16x32_bf16 v[52:55], v[92:95], v[132:135], v[52:55]
  v_mfma_f32_16x16x32_bf16 v[56:59], v[96:99], v[132:135], v[56:59]
  v_mfma_f32_16x16x32_bf16 v[60:63], v[100:103], v[132:135], v[60:63]
  v_mfma_f32_16x16x32_bf16 v[64:67], v[104:107], v[132:135], v[64:67]
  v_mfma_f32_16x16x32_bf16 v[68:71], v[108:111], v[132:135], v[68:71]
  v_mfma_f32_16x16x32_bf16 v[72:75], v[92:95], v[136:139], v[72:75]
  v_mfma_f32_16x16x32_bf16 v[76:79], v[96:99], v[136:139], v[76:79]
  v_mfma_f32_16x16x32_bf16 v[80:83], v[100:103], v[136:139], v[80:83]
  v_mfma_f32_16x16x32_bf16 v[84:87], v[104:107], v[136:139], v[84:87]
  v_mfma_f32_16x16x32_bf16 v[88:91], v[108:111], v[136:139], v[88:91]
  buffer_load_dwordx4 v[132:135], v3, s[12:15], s22 offen
  buffer_load_dwordx4 v[136:139], v4, s[12:15], s22 offen
  s_add_u32 s22, s22, 2048
  s_sub_u32 s47, s22, 55296
  s_cmp_ge_u32 s22, s46
  s_cselect_b32 s22, s47, s22
  s_waitcnt lgkmcnt(0)
  s_barrier
  ds_read_b128 v[92:95], v9 offset:0
  ds_read_b128 v[96:99], v9 offset:1024
  ds_read_b128 v[100:103], v9 offset:2048
  ds_read_b128 v[104:107], v9 offset:3072
  ds_read_b128 v[108:111], v9 offset:4096
  s_waitcnt vmcnt(14)
  v_mfma_f32_16x16x32_bf16 v[52:55], v[112:115], v[140:143], v[52:55]
  v_mfma_f32_16x16x32_bf16 v[56:59], v[116:119], v[140:143], v[56:59]
  v_mfma_f32_16x16x32_bf16 v[60:63], v[120:123], v[140:143], v[60:63]
  v_mfma_f32_16x16x32_bf16 v[64:67], v[124:127], v[140:143], v[64:67]
  v_mfma_f32_16x16x32_bf16 v[68:71], v[128:131], v[140:143], v[68:71]
  v_mfma_f32_16x16x32_bf16 v[72:75], v[112:115], v[144:147], v[72:75]
  v_mfma_f32_16x16x32_bf16 v[76:79], v[116:119], v[144:147], v[76:79]
  v_mfma_f32_16x16x32_bf16 v[80:83], v[120:123], v[144:147], v[80:83]
  v_mfma_f32_16x16x32_bf16 v[84:87], v[124:127], v[144:147], v[84:87]
  v_mfma_f32_16x16x32_bf16 v[88:91], v[128:131], v[144:147], v[88:91]
  buffer_load_dwordx4 v[140:143], v3, s[12:15], s22 offen
  buffer_load_dwordx4 v[144:147], v4, s[12:15], s22 offen
  s_add_u32 s22, s22, 2048
  s_sub_u32 s47, s22, 55296
  s_cmp_ge_u32 s22, s46
  s_cselect_b32 s22, s47, s22
  s_waitcnt lgkmcnt(0)
  s_barrier
  ds_read_b128 v[112:115], v9 offset:10240
  ds_read_b128 v[116:119], v9 offset:11264
  ds_read_b128 v[120:123], v9 offset:12288
  ds_read_b128 v[124:127], v9 offset:13312
  ds_read_b128 v[128:131], v9 offset:14336
  s_waitcnt vmcnt(14)
  v_mfma_f32_16x16x32_bf16 v[52:55], v[92:95], v[148:151], v[52:55]
  v_mfma_f32_16x16x32_bf16 v[56:59], v[96:99], v[148:151], v[56:59]
  v_mfma_f32_16x16x32_bf16 v[60:63], v[100:103], v[148:151], v[60:63]
  v_mfma_f32_16x16x32_bf16 v[64:67], v[104:107], v[148:151], v[64:67]
  v_mfma_f32_16x16x32_bf16 v[68:71], v[108:111], v[148:151], v[68:71]
  v_mfma_f32_16x16x32_bf16 v[72:75], v[92:95], v[152:155], v[72:75]
  v_mfma_f32_16x16x32_bf16 v[76:79], v[96:99], v[152:155], v[76:79]
  v_mfma_f32_16x16x32_bf16 v[80:83], v[100:103], v[152:155], v[80:83]
  v_mfma_f32_16x16x32_bf16 v[84:87], v[104:107], v[152:155], v[84:87]
  v_mfma_f32_16x16x32_bf16 v[88:91], v[108:111], v[152:155], v[88:91]
  buffer_load_dwordx4 v[148:151], v3, s[12:15], s22 offen
  buffer_load_dwordx4 v[152:155], v4, s[12:15], s22 offen
  s_add_u32 s22, s22, 2048
  s_sub_u32 s47, s22, 55296
  s_cmp_ge_u32 s22, s46
  s_cselect_b32 s22, s47, s22
  s_waitcnt lgkmcnt(0)
  s_barrier
  ds_read_b128 v[92:95], v9 offset:20480
  ds_read_b128 v[96:99], v9 offset:21504
  ds_read_b128 v[100:103], v9 offset:22528
  ds_read_b128 v[104:107], v9 offset:23552
  ds_read_b128 v[108:111], v9 offset:24576
  s_waitcnt vmcnt(14)
  v_mfma_f32_16x16x32_bf16 v[52:55], v[112:115], v[156:159], v[52:55]
  v_mfma_f32_16x16x32_bf16 v[56:59], v[116:119], v[156:159], v[56:59]
  v_mfma_f32_16x16x32_bf16 v[60:63], v[120:123], v[156:159], v[60:63]
  v_mfma_f32_16x16x32_bf16 v[64:67], v[124:127], v[156:159], v[64:67]
  v_mfma_f32_16x16x32_bf16 v[68:71], v[128:131], v[156:159], v[68:71]
  v_mfma_f32_16x16x32_bf16 v[72:75], v[112:115], v[160:163], v[72:75]
  v_mfma_f32_16x16x32_bf16 v[76:79], v[116:119], v[160:163], v[76:79]
  v_mfma_f32_16x16x32_bf16 v[80:83], v[120:123], v[160:163], v[80:83]
  v_mfma_f32_16x16x32_bf16 v[84:87], v[124:127], v[160:163], v[84:87]
  v_mfma_f32_16x16x32_bf16 v[88:91], v[128:131], v[160:163], v[88:91]
  s_waitcnt lgkmcnt(0)
  s_barrier
  ds_read_b128 v[112:115], v9 offset:30720
  ds_read_b128 v[116:119], v9 offset:31744
  ds_read_b128 v[120:123], v9 offset:32768
  ds_read_b128 v[124:127], v9 offset:33792
  ds_read_b128 v[128:131], v9 offset:34816
  s_waitcnt vmcnt(12)
  v_mfma_f32_16x16x32_bf16 v[52:55], v[92:95], v[164:167], v[52:55]
  v_mfma_f32_16x16x32_bf16 v[56:59], v[96:99], v[164:167], v[56:59]
  v_mfma_f32_16x16x32_bf16 v[60:63], v[100:103], v[164:167], v[60:63]
  v_mfma_f32_16x16x32_bf16 v[64:67], v[104:107], v[164:167], v[64:67]
  v_mfma_f32_16x16x32_bf16 v[68:71], v[108:111], v[164:167], v[68:71]
  v_mfma_f32_16x16x32_bf16 v[72:75], v[92:95], v[168:171], v[72:75]
  v_mfma_f32_16x16x32_bf16 v[76:79], v[96:99], v[168:171], v[76:79]
  v_mfma_f32_16x16x32_bf16 v[80:83], v[100:103], v[168:171], v[80:83]
  v_mfma_f32_16x16x32_bf16 v[84:87], v[104:107], v[168:171], v[84:87]
  v_mfma_f32_16x16x32_bf16 v[88:91], v[108:111], v[168:171], v[88:91]
  s_waitcnt lgkmcnt(0)
  s_barrier
  ds_read_b128 v[92:95], v9 offset:40960
  ds_read_b128 v[96:99], v9 offset:41984
  ds_read_b128 v[100:103], v9 offset:43008
  ds_read_b128 v[104:107], v9 offset:44032
  ds_read_b128 v[108:111], v9 offset:45056
  s_waitcnt vmcnt(10)
  v_mfma_f32_16x16x32_bf16 v[52:55], v[112:115], v[172:175], v[52:55]
  v_mfma_f32_16x16x32_bf16 v[56:59], v[116:119], v[172:175], v[56:59]
  v_mfma_f32_16x16x32_bf16 v[60:63], v[120:123], v[172:175], v[60:63]
  v_mfma_f32_16x16x32_bf16 v[64:67], v[124:127], v[172:175], v[64:67]
  v_mfma_f32_16x16x32_bf16 v[68:71], v[128:131], v[172:175], v[68:71]
  v_mfma_f32_16x16x32_bf16 v[72:75], v[112:115], v[176:179], v[72:75]
  v_mfma_f32_16x16x32_bf16 v[76:79], v[116:119], v[176:179], v[76:79]
  v_mfma_f32_16x16x32_bf16 v[80:83], v[120:123], v[176:179], v[80:83]
  v_mfma_f32_16x16x32_bf16 v[84:87], v[124:127], v[176:179], v[84:87]
  v_mfma_f32_16x16x32_bf16 v[88:91], v[128:131], v[176:179], v[88:91]
  s_waitcnt lgkmcnt(0)
  s_barrier
  ds_read_b128 v[112:115], v9 offset:51200
  ds_read_b128 v[116:119], v9 offset:52224
  ds_read_b128 v[120:123], v9 offset:53248
  ds_read_b128 v[124:127], v9 offset:54272
  ds_read_b128 v[128:131], v9 offset:55296
  s_waitcnt vmcnt(8)
  v_mfma_f32_16x16x32_bf16 v[52:55], v[92:95], v[180:183], v[52:55]
  v_mfma_f32_16x16x32_bf16 v[56:59], v[96:99], v[180:183], v[56:59]
  v_mfma_f32_16x16x32_bf16 v[60:63], v[100:103], v[180:183], v[60:63]
  v_mfma_f32_16x16x32_bf16 v[64:67], v[104:107], v[180:183], v[64:67]
  v_mfma_f32_16x16x32_bf16 v[68:71], v[108:111], v[180:183], v[68:71]
  v_mfma_f32_16x16x32_bf16 v[72:75], v[92:95], v[184:187], v[72:75]
  v_mfma_f32_16x16x32_bf16 v[76:79], v[96:99], v[184:187], v[76:79]
  v_mfma_f32_16x16x32_bf16 v[80:83], v[100:103], v[184:187], v[80:83]
  v_mfma_f32_16x16x32_bf16 v[84:87], v[104:107], v[184:187], v[84:87]
  v_mfma_f32_16x16x32_bf16 v[88:91], v[108:111], v[184:187], v[88:91]
  s_waitcnt lgkmcnt(0)
  s_barrier
  ds_read_b128 v[92:95], v8 offset:0
  ds_read_b128 v[96:99], v8 offset:1024
  ds_read_b128 v[100:103], v8 offset:2048
  ds_read_b128 v[104:107], v8 offset:3072
  ds_read_b128 v[108:111], v8 offset:4096
  s_waitcnt vmcnt(6)
  v_mfma_f32_16x16x32_bf16 v[52:55], v[112:115], v[188:191], v[52:55]
  v_mfma_f32_16x16x32_bf16 v[56:59], v[116:119], v[188:191], v[56:59]
  v_mfma_f32_16x16x32_bf16 v[60:63], v[120:123], v[188:191], v[60:63]
  v_mfma_f32_16x16x32_bf16 v[64:67], v[124:127], v[188:191], v[64:67]
  v_mfma_f32_16x16x32_bf16 v[68:71], v[128:131], v[188:191], v[68:71]
  v_mfma_f32_16x16x32_bf16 v[72:75], v[112:115], v[192:195], v[72:75]
  v_mfma_f32_16x16x32_bf16 v[76:79], v[116:119], v[192:195], v[76:79]
  v_mfma_f32_16x16x32_bf16 v[80:83], v[120:123], v[192:195], v[80:83]
  v_mfma_f32_16x16x32_bf16 v[84:87], v[124:127], v[192:195], v[84:87]
  v_mfma_f32_16x16x32_bf16 v[88:91], v[128:131], v[192:195], v[88:91]
  s_waitcnt lgkmcnt(0)
  s_barrier
  ds_read_b128 v[112:115], v8 offset:10240
  ds_read_b128 v[116:119], v8 offset:11264
  ds_read_b128 v[120:123], v8 offset:12288
  ds_read_b128 v[124:127], v8 offset:13312
  ds_read_b128 v[128:131], v8 offset:14336
  s_waitcnt vmcnt(4)
  v_mfma_f32_16x16x32_bf16 v[52:55], v[92:95], v[132:135], v[52:55]
  v_mfma_f32_16x16x32_bf16 v[56:59], v[96:99], v[132:135], v[56:59]
  v_mfma_f32_16x16x32_bf16 v[60:63], v[100:103], v[132:135], v[60:63]
  v_mfma_f32_16x16x32_bf16 v[64:67], v[104:107], v[132:135], v[64:67]
  v_mfma_f32_16x16x32_bf16 v[68:71], v[108:111], v[132:135], v[68:71]
  v_mfma_f32_16x16x32_bf16 v[72:75], v[92:95], v[136:139], v[72:75]
  v_mfma_f32_16x16x32_bf16 v[76:79], v[96:99], v[136:139], v[76:79]
  v_mfma_f32_16x16x32_bf16 v[80:83], v[100:103], v[136:139], v[80:83]
  v_mfma_f32_16x16x32_bf16 v[84:87], v[104:107], v[136:139], v[84:87]
  v_mfma_f32_16x16x32_bf16 v[88:91], v[108:111], v[136:139], v[88:91]
  s_waitcnt lgkmcnt(0)
  s_barrier
  ds_read_b128 v[92:95], v8 offset:20480
  ds_read_b128 v[96:99], v8 offset:21504
  ds_read_b128 v[100:103], v8 offset:22528
  ds_read_b128 v[104:107], v8 offset:23552
  ds_read_b128 v[108:111], v8 offset:24576
  s_waitcnt vmcnt(2)
  v_mfma_f32_16x16x32_bf16 v[52:55], v[112:115], v[140:143], v[52:55]
  v_mfma_f32_16x16x32_bf16 v[56:59], v[116:119], v[140:143], v[56:59]
  v_mfma_f32_16x16x32_bf16 v[60:63], v[120:123], v[140:143], v[60:63]
  v_mfma_f32_16x16x32_bf16 v[64:67], v[124:127], v[140:143], v[64:67]
  v_mfma_f32_16x16x32_bf16 v[68:71], v[128:131], v[140:143], v[68:71]
  v_mfma_f32_16x16x32_bf16 v[72:75], v[112:115], v[144:147], v[72:75]
  v_mfma_f32_16x16x32_bf16 v[76:79], v[116:119], v[144:147], v[76:79]
  v_mfma_f32_16x16x32_bf16 v[80:83], v[120:123], v[144:147], v[80:83]
  v_mfma_f32_16x16x32_bf16 v[84:87], v[124:127], v[144:147], v[84:87]
  v_mfma_f32_16x16x32_bf16 v[88:91], v[128:131], v[144:147], v[88:91]
  s_waitcnt lgkmcnt(0)
  s_waitcnt vmcnt(0)
  v_mfma_f32_16x16x32_bf16 v[52:55], v[92:95], v[148:151], v[52:55]
  v_mfma_f32_16x16x32_bf16 v[56:59], v[96:99], v[148:151], v[56:59]
  v_mfma_f32_16x16x32_bf16 v[60:63], v[100:103], v[148:151], v[60:63]
  v_mfma_f32_16x16x32_bf16 v[64:67], v[104:107], v[148:151], v[64:67]
  v_mfma_f32_16x16x32_bf16 v[68:71], v[108:111], v[148:151], v[68:71]
  v_mfma_f32_16x16x32_bf16 v[72:75], v[92:95], v[152:155], v[72:75]
  v_mfma_f32_16x16x32_bf16 v[76:79], v[96:99], v[152:155], v[76:79]
  v_mfma_f32_16x16x32_bf16 v[80:83], v[100:103], v[152:155], v[80:83]
  v_mfma_f32_16x16x32_bf16 v[84:87], v[104:107], v[152:155], v[84:87]
  v_mfma_f32_16x16x32_bf16 v[88:91], v[108:111], v[152:155], v[88:91]
  s_mul_i32 s26, s3, 5120
  s_xor_b32 s27, s3, 2
  s_mul_i32 s27, s27, 5120
  s_add_u32 s26, s26, 122880
  s_add_u32 s27, s27, 122880
  v_add_u32 v10, s26, v3
  v_add_u32 v11, s27, v3
  s_cmp_eq_u32 s21, 0
  s_cbranch_scc0 L_down_kernel_k1
  s_nop 2
  ds_write_b128 v10, v[72:75] offset:0
  ds_write_b128 v10, v[76:79] offset:1024
  ds_write_b128 v10, v[80:83] offset:2048
  ds_write_b128 v10, v[84:87] offset:3072
  ds_write_b128 v10, v[88:91] offset:4096
  s_waitcnt lgkmcnt(0)
  s_barrier
  ds_read_b128 v[72:75], v11 offset:0
  ds_read_b128 v[76:79], v11 offset:1024
  ds_read_b128 v[80:83], v11 offset:2048
  ds_read_b128 v[84:87], v11 offset:3072
  ds_read_b128 v[88:91], v11 offset:4096
  s_waitcnt lgkmcnt(0) vmcnt(0)
  v_add_f32 v16, v52, v72
  v_add_f32 v17, v53, v73
  v_add_f32 v18, v54, v74
  v_add_f32 v19, v55, v75
  v_add_f32 v20, v56, v76
  v_add_f32 v21, v57, v77
  v_add_f32 v22, v58, v78
  v_add_f32 v23, v59, v79
  v_add_f32 v24, v60, v80
  v_add_f32 v25, v61, v81
  v_add_f32 v26, v62, v82
  v_add_f32 v27, v63, v83
  v_add_f32 v28, v64, v84
  v_add_f32 v29, v65, v85
  v_add_f32 v30, v66, v86
  v_add_f32 v31, v67, v87
  v_add_f32 v32, v68, v88
  v_add_f32 v33, v69, v89
  v_add_f32 v34, v70, v90
  v_add_f32 v35, v71, v91
  s_branch L_down_kernel_k2
L_down_kernel_k1:
  s_nop 2
  ds_write_b128 v10, v[52:55] offset:0
  ds_write_b128 v10, v[56:59] offset:1024
  ds_write_b128 v10, v[60:63] offset:2048
  ds_write_b128 v10, v[64:67] offset:3072
  ds_write_b128 v10, v[68:71] offset:4096
  s_waitcnt lgkmcnt(0)
  s_barrier
  ds_read_b128 v[52:55], v11 offset:0
  ds_read_b128 v[56:59], v11 offset:1024
  ds_read_b128 v[60:63], v11 offset:2048
  ds_read_b128 v[64:67], v11 offset:3072
  ds_read_b128 v[68:71], v11 offset:4096
  s_waitcnt lgkmcnt(0) vmcnt(0)
  v_add_f32 v16, v72, v52
  v_add_f32 v17, v73, v53
  v_add_f32 v18, v74, v54
  v_add_f32 v19, v75, v55
  v_add_f32 v20, v76, v56
  v_add_f32 v21, v77, v57
  v_add_f32 v22, v78, v58
  v_add_f32 v23, v79, v59
  v_add_f32 v24, v80, v60
  v_add_f32 v25, v81, v61
  v_add_f32 v26, v82, v62
  v_add_f32 v27, v83, v63
  v_add_f32 v28, v84, v64
  v_add_f32 v29, v85, v65
  v_add_f32 v30, v86, v66
  v_add_f32 v31, v87, v67
  v_add_f32 v32, v88, v68
  v_add_f32 v33, v89, v69
  v_add_f32 v34, v90, v70
  v_add_f32 v35, v91, v71
L_down_kernel_k2:
  v_cvt_pk_bf16_f32 v8, v16, v17
  v_lshlrev_b32 v9, 16, v40
  v_and_b32 v10, 0xffff0000, v40
  v_lshlrev_b32 v16, 16, v8
  v_and_b32 v17, 0xffff0000, v8
  v_add_f32 v16, v16, v9
  v_add_f32 v17, v17, v10
  v_cvt_pk_bf16_f32 v40, v16, v17
  v_cvt_pk_bf16_f32 v8, v18, v19
  v_lshlrev_b32 v9, 16, v41
  v_and_b32 v10, 0xffff0000, v41
  v_lshlrev_b32 v18, 16, v8
  v_and_b32 v19, 0xffff0000, v8
  v_add_f32 v18, v18, v9
  v_add_f32 v19, v19, v10
  v_cvt_pk_bf16_f32 v41, v18, v19
  buffer_store_dwordx2 v[40:41], v36, s[4:7], 0 offen offset:0
  v_cvt_pk_bf16_f32 v8, v20, v21
  v_lshlrev_b32 v9, 16, v42
  v_and_b32 v10, 0xffff0000, v42
  v_lshlrev_b32 v20, 16, v8
  v_and_b32 v21, 0xffff0000, v8
  v_add_f32 v20, v20, v9
  v_add_f32 v21, v21, v10
  v_cvt_pk_bf16_f32 v42, v20, v21
  v_cvt_pk_bf16_f32 v8, v22, v23
  v_lshlrev_b32 v9, 16, v43
  v_and_b32 v10, 0xffff0000, v43
  v_lshlrev_b32 v22, 16, v8
  v_and_b32 v23, 0xffff0000, v8
  v_add_f32 v22, v22, v9
  v_add_f32 v23, v23, v10
  v_cvt_pk_bf16_f32 v43, v22, v23
  buffer_store_dwordx2 v[42:43], v36, s[4:7], 0 offen offset:32
  v_cvt_pk_bf16_f32 v8, v24, v25
  v_lshlrev_b32 v9, 16, v44
  v_and_b32 v10, 0xffff0000, v44
  v_lshlrev_b32 v24, 16, v8
  v_and_b32 v25, 0xffff0000, v8
  v_add_f32 v24, v24, v9
  v_add_f32 v25, v25, v10
  v_cvt_pk_bf16_f32 v44, v24, v25
  v_cvt_pk_bf16_f32 v8, v26, v27
  v_lshlrev_b32 v9, 16, v45
  v_and_b32 v10, 0xffff0000, v45
  v_lshlrev_b32 v26, 16, v8
  v_and_b32 v27, 0xffff0000, v8
  v_add_f32 v26, v26, v9
  v_add_f32 v27, v27, v10
  v_cvt_pk_bf16_f32 v45, v26, v27
  buffer_store_dwordx2 v[44:45], v36, s[4:7], 0 offen offset:64
  v_cvt_pk_bf16_f32 v8, v28, v29
  v_lshlrev_b32 v9, 16, v46
  v_and_b32 v10, 0xffff0000, v46
  v_lshlrev_b32 v28, 16, v8
  v_and_b32 v29, 0xffff0000, v8
  v_add_f32 v28, v28, v9
  v_add_f32 v29, v29, v10
  v_cvt_pk_bf16_f32 v46, v28, v29
  v_cvt_pk_bf16_f32 v8, v30, v31
  v_lshlrev_b32 v9, 16, v47
  v_and_b32 v10, 0xffff0000, v47
  v_lshlrev_b32 v30, 16, v8
  v_and_b32 v31, 0xffff0000, v8
  v_add_f32 v30, v30, v9
  v_add_f32 v31, v31, v10
  v_cvt_pk_bf16_f32 v47, v30, v31
  buffer_store_dwordx2 v[46:47], v36, s[4:7], 0 offen offset:96
  v_cvt_pk_bf16_f32 v8, v32, v33
  v_lshlrev_b32 v9, 16, v48
  v_and_b32 v10, 0xffff0000, v48
  v_lshlrev_b32 v32, 16, v8
  v_and_b32 v33, 0xffff0000, v8
  v_add_f32 v32, v32, v9
  v_add_f32 v33, v33, v10
  v_cvt_pk_bf16_f32 v48, v32, v33
  v_cvt_pk_bf16_f32 v8, v34, v35
  v_lshlrev_b32 v9, 16, v49
  v_and_b32 v10, 0xffff0000, v49
  v_lshlrev_b32 v34, 16, v8
  v_and_b32 v35, 0xffff0000, v8
  v_add_f32 v34, v34, v9
  v_add_f32 v35, v35, v10
  v_cvt_pk_bf16_f32 v49, v34, v35
  buffer_store_dwordx2 v[48:49], v36, s[4:7], 0 offen offset:128
  s_endpgm
L_down_kernel_end:
  s_endpgm
.section .rodata,"a"
.p2align 6
.amdhsa_kernel qkv_kernel
  .amdhsa_next_free_vgpr 200
  .amdhsa_next_free_sgpr 96
  .amdhsa_accum_offset 200
  .amdhsa_group_segment_fixed_size 0
  .amdhsa_kernarg_size 80
  .amdhsa_user_sgpr_count 2
  .amdhsa_user_sgpr_kernarg_segment_ptr 1
  .amdhsa_system_sgpr_workgroup_id_x 1
.end_amdhsa_kernel
.p2align 6
.amdhsa_kernel attn_kernel
  .amdhsa_next_free_vgpr 160
  .amdhsa_next_free_sgpr 96
  .amdhsa_accum_offset 160
  .amdhsa_group_segment_fixed_size 0
  .amdhsa_kernarg_size 80
  .amdhsa_user_sgpr_count 2
  .amdhsa_user_sgpr_kernarg_segment_ptr 1
  .amdhsa_system_sgpr_workgroup_id_x 1
.end_amdhsa_kernel
.p2align 6
.amdhsa_kernel oproj_kernel
  .amdhsa_next_free_vgpr 172
  .amdhsa_next_free_sgpr 96
  .amdhsa_accum_offset 172
  .amdhsa_group_segment_fixed_size 0
  .amdhsa_kernarg_size 80
  .amdhsa_user_sgpr_count 2
  .amdhsa_user_sgpr_kernarg_segment_ptr 1
  .amdhsa_system_sgpr_workgroup_id_x 1
.end_amdhsa_kernel
.p2align 6
.amdhsa_kernel gateup_kernel
  .amdhsa_next_free_vgpr 256
  .amdhsa_next_free_sgpr 96
  .amdhsa_accum_offset 96
  .amdhsa_group_segment_fixed_size 0
  .amdhsa_kernarg_size 80
  .amdhsa_user_sgpr_count 2
  .amdhsa_user_sgpr_kernarg_segment_ptr 1
  .amdhsa_system_sgpr_workgroup_id_x 1
.end_amdhsa_kernel
.p2align 6
.amdhsa_kernel down_kernel
  .amdhsa_next_free_vgpr 196
  .amdhsa_next_free_sgpr 96
  .amdhsa_accum_offset 196
  .amdhsa_group_segment_fixed_size 0
  .amdhsa_kernarg_size 80
  .amdhsa_user_sgpr_count 2
  .amdhsa_user_sgpr_kernarg_segment_ptr 1
  .amdhsa_system_sgpr_workgroup_id_x 1
.end_amdhsa_kernel
```
